```python
import torch

def _softmax(x, axis=-1):
    return torch.softmax(x, dim=axis)

def _gelu(x):
    return torch.nn.functional.gelu(x, approximate='tanh')

def _silu(x):
    return torch.nn.functional.silu(x)

def _sigmoid(x):
    return torch.sigmoid(x)

def _layernorm(x, axis=-1, eps=1e-05):
    m = x.mean(dim=axis, keepdim=True)
    v = x.var(dim=axis, keepdim=True, unbiased=False)
    return (x - m) / torch.sqrt(v + eps)

def _scatter_add(tgt, idx, src, axis=0):
    return tgt.clone().index_add_(axis, idx, src)

def _segment_sum(src, seg, n):
    out = torch.zeros((n,) + src.shape[1:], dtype=src.dtype)
    return out.index_add_(0, seg, src)

def _pad(x, pw):
    flat = tuple((v for pair in reversed(pw) for v in pair))
    return torch.nn.functional.pad(x, flat)
kernel_name = 'gated_mix__ssm_conv_s4__memory_aug_recurrent_mem_tr__prompt'

def setup_inputs():

    _w = lambda a: (lambda t: t.to(torch.bfloat16) if t.is_floating_point() else t)(torch.as_tensor(a))

    def _A_setup():
        B, L, D, N = (1, 2048, 576, 128)
        A_re = -(lambda _x: torch.exp(torch.as_tensor(_x)))((lambda *s: torch.randn(*s, dtype=torch.bfloat16) * 6.4)(D, N))
        A_im = torch.pi * (lambda *s: torch.randn(*s, dtype=torch.bfloat16) * 0.05)(D, N)
        B_re = (lambda *s: torch.randn(*s, dtype=torch.bfloat16) * 0.1)(D, N)
        B_im = (lambda *s: torch.randn(*s, dtype=torch.bfloat16) * 0.1)(D, N)
        C_re = (lambda *s: torch.randn(*s, dtype=torch.bfloat16) * 0.1)(D, N)
        C_im = (lambda *s: torch.randn(*s, dtype=torch.bfloat16) * 0.1)(D, N)
        log_dt = (lambda *s: torch.randn(*s, dtype=torch.bfloat16) * 0.05)(D) * 0.5 - 4.0
        Dskip = (lambda *s: torch.randn(*s, dtype=torch.bfloat16) * 0.05)(D)
        return {'u': _w((lambda *s: torch.randn(*s, dtype=torch.bfloat16) * 0.05)(B, L, D)), 'A_re': _w(A_re), 'A_im': _w(A_im), 'B_re': _w(B_re), 'B_im': _w(B_im), 'C_re': _w(C_re), 'C_im': _w(C_im), 'log_dt': _w(log_dt), 'Dskip': _w(Dskip)}
    _A_in = _A_setup()

    def _B_setup():
        B, S, Dm = (1, 2048, 576)
        H, Dh = (32, 128)
        M, seg = (8, 32)
        seg = min(seg, S)
        S = S // seg * seg
        return {'x': _w((lambda *s: torch.randn(*s, dtype=torch.bfloat16) * 0.05)(B, S, Dm)), 'mem0': _w((lambda *s: torch.randn(*s, dtype=torch.bfloat16) * 0.4)(B, M, Dm)), 'Wq': _w((lambda *s: torch.randn(*s, dtype=torch.bfloat16) * 6.4)(Dm, H, Dh) * Dm ** (-0.5)), 'Wk': _w((lambda *s: torch.randn(*s, dtype=torch.bfloat16) * 6.4)(Dm, H, Dh) * Dm ** (-0.5)), 'Wv': _w((lambda *s: torch.randn(*s, dtype=torch.bfloat16) * 0.4)(Dm, H, Dh) * Dm ** (-0.5)), 'Wo': _w((lambda *s: torch.randn(*s, dtype=torch.bfloat16) * 0.4)(H, Dh, Dm) * (H * Dh) ** (-0.5)), 'seg_len': seg}
    _B_in = _B_setup()
    return {'A_u': _A_in['u'], 'A_A_re': _A_in['A_re'], 'A_A_im': _A_in['A_im'], 'A_B_re': _A_in['B_re'], 'A_B_im': _A_in['B_im'], 'A_C_re': _A_in['C_re'], 'A_C_im': _A_in['C_im'], 'A_log_dt': _A_in['log_dt'], 'A_Dskip': _A_in['Dskip'], 'B_x': _B_in['x'], 'B_mem0': _B_in['mem0'], 'B_Wq': _B_in['Wq'], 'B_Wk': _B_in['Wk'], 'B_Wv': _B_in['Wv'], 'B_Wo': _B_in['Wo'], 'B_seg_len': _B_in['seg_len'], 'gate_w': _w((lambda *s: torch.randn(*s, dtype=torch.bfloat16) * 0.05)(576) * 16.0)}

def reference(A_u, A_A_re, A_A_im, A_B_re, A_B_im, A_C_re, A_C_im, A_log_dt, A_Dskip, B_x, B_mem0, B_Wq, B_Wk, B_Wv, B_Wo, B_seg_len, gate_w):

    def _A_ref(u, A_re, A_im, B_re, B_im, C_re, C_im, log_dt, Dskip):
        Bsz, L, D = u.shape
        dt = torch.exp(log_dt)[:, None]
        A = A_re + 1j * A_im
        Bc = B_re + 1j * B_im
        Cc = C_re + 1j * C_im
        logdA = dt * A
        dB = dt * Bc
        l = (lambda x, dt: x.to(dt))(torch.arange(L), A_re.dtype)
        P = torch.exp(logdA[:, :, None] * l[None, None, :])
        K = torch.einsum('dn,dnl,dn->dl', Cc, P, dB).real
        L2 = 2 * L
        Kp = _pad(K, ((0, 0), (0, L)))
        up = (lambda x, *d: x.permute(*d))(u, 0, 2, 1)
        up = _pad(up, ((0, 0), (0, 0), (0, L)))
        Kf = (lambda x, axes=(-2, -1): torch.fft.rfft2(x.float(), dim=axes))(Kp[:, None, :], axes=(-2, -1))
        Uf = (lambda x, axes=(-2, -1): torch.fft.rfft2(x.float(), dim=axes))(up[:, :, None, :], axes=(-2, -1))
        Yf = Uf * Kf[None, :, :, :]
        y = (lambda x, s, axes=(-2, -1): torch.fft.irfft2(x, s=s, dim=axes).to(torch.bfloat16))(Yf, (1, L2), axes=(-2, -1))[:, :, 0, :L]
        y = (lambda x, *d: x.permute(*d))(y, 0, 2, 1) + u * Dskip[None, None, :]
        return y

    def _B_ref(x, mem0, Wq, Wk, Wv, Wo, seg_len):
        B, S, Dm = x.shape
        H, Dh = (Wq.shape[1], Wq.shape[2])
        M = mem0.shape[1]
        scale = Dh ** (-0.5)
        n_seg = S // seg_len
        L = M + seg_len
        idx = torch.arange(L)
        mask = (idx[:, None] < M) | (idx[:, None] >= idx[None, :])
        mem = mem0
        outs = []
        for s in range(n_seg):
            xs = x[:, s * seg_len:(s + 1) * seg_len, :].clone()
            h = torch.concatenate([mem, xs], axis=1)
            q = torch.einsum('btd,dhe->bhte', h, Wq)
            k = torch.einsum('btd,dhe->bhte', h, Wk)
            v = torch.einsum('btd,dhe->bhte', h, Wv)
            scores = torch.einsum('bhqe,bhke->bhqk', q, k) * scale
            scores = torch.where(mask[None, None], scores, -1000000000.0)
            p = _softmax(scores, axis=-1)
            o = torch.einsum('bhqk,bhke->bhqe', p, v)
            o = torch.einsum('bhte,hed->btd', o, Wo)
            mem = o[:, :M, :].clone()
            outs.append(o[:, M:, :])
        return torch.concatenate(outs, axis=1)
    x = A_u
    g = _sigmoid((x * gate_w).sum(-1, keepdims=True))
    a = _A_ref(x, A_A_re, A_A_im, A_B_re, A_B_im, A_C_re, A_C_im, A_log_dt, A_Dskip)
    b = _B_ref(x, B_mem0, B_Wq, B_Wk, B_Wv, B_Wo, B_seg_len)
    return g * a + (1 - g) * b
```

```asm
; @launch grid=(256,1,1) block=(256,1,1) lds=163840
.amdgcn_target "amdgcn-amd-amdhsa--gfx950"
.text
.globl gated_mix__ssm_conv_s4__memory_aug_recurrent_mem_tr__prompt_kernel
.p2align 8
.type gated_mix__ssm_conv_s4__memory_aug_recurrent_mem_tr__prompt_kernel,@function
gated_mix__ssm_conv_s4__memory_aug_recurrent_mem_tr__prompt_kernel:
    s_cmp_ge_u32 s2, 256
    s_cbranch_scc1 EXIT
    s_load_dwordx2 s[4:5], s[0:1], 152
    s_load_dwordx2 s[8:9], s[0:1], 144
    s_load_dwordx2 s[12:13], s[0:1], 88
    s_load_dwordx2 s[16:17], s[0:1], 96
    s_load_dwordx2 s[20:21], s[0:1], 104
    s_load_dwordx2 s[24:25], s[0:1], 112
    s_load_dwordx2 s[28:29], s[0:1], 136
    v_lshrrev_b32 v1, 6, v0
    s_nop 0
    v_readfirstlane_b32 s32, v1
    s_getreg_b32 s35, hwreg(HW_REG_XCC_ID)
    s_and_b32 s35, s35, 15
    s_waitcnt lgkmcnt(0)
    s_and_b32 s5, s5, 0xffff
    s_mov_b32 s6, 268435456
    s_mov_b32 s7, 0x00020000
    s_and_b32 s9, s9, 0xffff
    s_mov_b32 s10, 256
    s_mov_b32 s11, 0x00020000
    s_and_b32 s13, s13, 0xffff
    s_mov_b32 s14, 4718592
    s_mov_b32 s15, 0x00020000
    s_and_b32 s17, s17, 0xffff
    s_mov_b32 s18, 4718592
    s_mov_b32 s19, 0x00020000
    s_and_b32 s21, s21, 0xffff
    s_mov_b32 s22, 4718592
    s_mov_b32 s23, 0x00020000
    s_and_b32 s25, s25, 0xffff
    s_mov_b32 s26, 4718592
    s_mov_b32 s27, 0x00020000
    s_and_b32 s29, s29, 0xffff
    s_mov_b32 s30, 2359296
    s_mov_b32 s31, 0x00020000
    s_cmp_lg_u32 s2, 0
    s_cbranch_scc1 NOINIT
    s_cmp_lg_u32 s32, 1
    s_cbranch_scc1 NOINIT
    v_mov_b32 v4, 0
    v_mov_b32 v5, 0
    v_mov_b32 v6, 0
    v_mov_b32 v7, 0
    v_and_b32 v1, 63, v0
    v_lshlrev_b32 v1, 4, v1
    s_mov_b32 s36, 0
    buffer_store_dwordx4 v[4:7], v1, s[4:7], s36 offen sc1
    s_mov_b32 s36, 1024
    buffer_store_dwordx4 v[4:7], v1, s[4:7], s36 offen sc1
    s_mov_b32 s36, 2048
    buffer_store_dwordx4 v[4:7], v1, s[4:7], s36 offen sc1
    s_mov_b32 s36, 3072
    buffer_store_dwordx4 v[4:7], v1, s[4:7], s36 offen sc1
    s_mov_b32 s36, 4096
    buffer_store_dwordx4 v[4:7], v1, s[4:7], s36 offen sc1
    s_mov_b32 s36, 5120
    buffer_store_dwordx4 v[4:7], v1, s[4:7], s36 offen sc1
    s_mov_b32 s36, 6144
    buffer_store_dwordx4 v[4:7], v1, s[4:7], s36 offen sc1
    s_mov_b32 s36, 7168
    buffer_store_dwordx4 v[4:7], v1, s[4:7], s36 offen sc1
    s_mov_b32 s36, 8192
    buffer_store_dwordx4 v[4:7], v1, s[4:7], s36 offen sc1
    s_waitcnt vmcnt(0)
    v_mov_b32 v1, 1
    v_mov_b32 v2, 72
    buffer_store_dword v1, v2, s[8:11], 0 offen sc1
NOINIT:
    s_cmp_lg_u32 s32, 0
    s_cbranch_scc1 ROLE_WAIT
    s_mov_b64 exec, 1
    v_mov_b32 v1, 1
    s_lshl_b32 s36, s35, 2
    v_mov_b32 v2, s36
    buffer_atomic_add v1, v2, s[8:11], 0 offen sc0
    s_waitcnt vmcnt(0)
    v_readfirstlane_b32 s33, v1
    s_add_u32 s35, s35, 1
    v_mov_b32 v2, 64
    s_cmp_lg_u32 s33, 31
    s_cbranch_scc1 ROLE_NOCAS
    v_mov_b32 v4, s35
    v_mov_b32 v5, 0
    buffer_atomic_cmpswap v[4:5], v2, s[8:11], 0 offen
ROLE_NOCAS:
ROLE_POLL:
    buffer_load_dwordx4 v[4:7], v2, s[8:11], 0 offen sc1
    s_waitcnt vmcnt(0)
    v_readfirstlane_b32 s36, v4
    v_readfirstlane_b32 s37, v6
    s_cmp_eq_u32 s36, 0
    s_cbranch_scc1 ROLE_POLL
    s_mov_b32 s37, 0
    s_cmp_lg_u32 s36, s35
    s_cbranch_scc1 ROLE_WORKER
    s_cmp_ge_u32 s33, 32
    s_cbranch_scc1 ROLE_WORKER
    s_mov_b32 s37, 1
    s_branch ROLE_SET
ROLE_WORKER:
    v_mov_b32 v2, 0
ROLE_MASK:
    buffer_load_dwordx4 v[4:7], v2, s[8:11], 0 offen sc1
    buffer_load_dwordx4 v[8:11], v2, s[8:11], 0 offen offset:16 sc1
    buffer_load_dwordx4 v[12:15], v2, s[8:11], 0 offen offset:32 sc1
    buffer_load_dwordx4 v[16:19], v2, s[8:11], 0 offen offset:48 sc1
    buffer_load_dword v20, v2, s[8:11], 0 offen offset:72 sc1
    s_waitcnt vmcnt(0)
    v_readfirstlane_b32 s41, v20
    s_nop 0
    s_cmp_eq_u32 s41, 0
    s_cbranch_scc1 ROLE_MASK
    s_mov_b32 s40, 0
    s_mov_b32 s44, 0
    v_readfirstlane_b32 s41, v4
    s_nop 0
    s_add_u32 s40, s40, s41
    s_cmp_eq_u32 s36, 1
    s_cselect_b32 s42, 32, 0
    s_sub_u32 s41, s41, s42
    s_cmp_gt_u32 s35, 1
    s_cselect_b32 s41, s41, 0
    s_add_u32 s44, s44, s41
    v_readfirstlane_b32 s41, v5
    s_nop 0
    s_add_u32 s40, s40, s41
    s_cmp_eq_u32 s36, 2
    s_cselect_b32 s42, 32, 0
    s_sub_u32 s41, s41, s42
    s_cmp_gt_u32 s35, 2
    s_cselect_b32 s41, s41, 0
    s_add_u32 s44, s44, s41
    v_readfirstlane_b32 s41, v6
    s_nop 0
    s_add_u32 s40, s40, s41
    s_cmp_eq_u32 s36, 3
    s_cselect_b32 s42, 32, 0
    s_sub_u32 s41, s41, s42
    s_cmp_gt_u32 s35, 3
    s_cselect_b32 s41, s41, 0
    s_add_u32 s44, s44, s41
    v_readfirstlane_b32 s41, v7
    s_nop 0
    s_add_u32 s40, s40, s41
    s_cmp_eq_u32 s36, 4
    s_cselect_b32 s42, 32, 0
    s_sub_u32 s41, s41, s42
    s_cmp_gt_u32 s35, 4
    s_cselect_b32 s41, s41, 0
    s_add_u32 s44, s44, s41
    v_readfirstlane_b32 s41, v8
    s_nop 0
    s_add_u32 s40, s40, s41
    s_cmp_eq_u32 s36, 5
    s_cselect_b32 s42, 32, 0
    s_sub_u32 s41, s41, s42
    s_cmp_gt_u32 s35, 5
    s_cselect_b32 s41, s41, 0
    s_add_u32 s44, s44, s41
    v_readfirstlane_b32 s41, v9
    s_nop 0
    s_add_u32 s40, s40, s41
    s_cmp_eq_u32 s36, 6
    s_cselect_b32 s42, 32, 0
    s_sub_u32 s41, s41, s42
    s_cmp_gt_u32 s35, 6
    s_cselect_b32 s41, s41, 0
    s_add_u32 s44, s44, s41
    v_readfirstlane_b32 s41, v10
    s_nop 0
    s_add_u32 s40, s40, s41
    s_cmp_eq_u32 s36, 7
    s_cselect_b32 s42, 32, 0
    s_sub_u32 s41, s41, s42
    s_cmp_gt_u32 s35, 7
    s_cselect_b32 s41, s41, 0
    s_add_u32 s44, s44, s41
    v_readfirstlane_b32 s41, v11
    s_nop 0
    s_add_u32 s40, s40, s41
    s_cmp_eq_u32 s36, 8
    s_cselect_b32 s42, 32, 0
    s_sub_u32 s41, s41, s42
    s_cmp_gt_u32 s35, 8
    s_cselect_b32 s41, s41, 0
    s_add_u32 s44, s44, s41
    v_readfirstlane_b32 s41, v12
    s_nop 0
    s_add_u32 s40, s40, s41
    s_cmp_eq_u32 s36, 9
    s_cselect_b32 s42, 32, 0
    s_sub_u32 s41, s41, s42
    s_cmp_gt_u32 s35, 9
    s_cselect_b32 s41, s41, 0
    s_add_u32 s44, s44, s41
    v_readfirstlane_b32 s41, v13
    s_nop 0
    s_add_u32 s40, s40, s41
    s_cmp_eq_u32 s36, 10
    s_cselect_b32 s42, 32, 0
    s_sub_u32 s41, s41, s42
    s_cmp_gt_u32 s35, 10
    s_cselect_b32 s41, s41, 0
    s_add_u32 s44, s44, s41
    v_readfirstlane_b32 s41, v14
    s_nop 0
    s_add_u32 s40, s40, s41
    s_cmp_eq_u32 s36, 11
    s_cselect_b32 s42, 32, 0
    s_sub_u32 s41, s41, s42
    s_cmp_gt_u32 s35, 11
    s_cselect_b32 s41, s41, 0
    s_add_u32 s44, s44, s41
    v_readfirstlane_b32 s41, v15
    s_nop 0
    s_add_u32 s40, s40, s41
    s_cmp_eq_u32 s36, 12
    s_cselect_b32 s42, 32, 0
    s_sub_u32 s41, s41, s42
    s_cmp_gt_u32 s35, 12
    s_cselect_b32 s41, s41, 0
    s_add_u32 s44, s44, s41
    v_readfirstlane_b32 s41, v16
    s_nop 0
    s_add_u32 s40, s40, s41
    s_cmp_eq_u32 s36, 13
    s_cselect_b32 s42, 32, 0
    s_sub_u32 s41, s41, s42
    s_cmp_gt_u32 s35, 13
    s_cselect_b32 s41, s41, 0
    s_add_u32 s44, s44, s41
    v_readfirstlane_b32 s41, v17
    s_nop 0
    s_add_u32 s40, s40, s41
    s_cmp_eq_u32 s36, 14
    s_cselect_b32 s42, 32, 0
    s_sub_u32 s41, s41, s42
    s_cmp_gt_u32 s35, 14
    s_cselect_b32 s41, s41, 0
    s_add_u32 s44, s44, s41
    v_readfirstlane_b32 s41, v18
    s_nop 0
    s_add_u32 s40, s40, s41
    s_cmp_eq_u32 s36, 15
    s_cselect_b32 s42, 32, 0
    s_sub_u32 s41, s41, s42
    s_cmp_gt_u32 s35, 15
    s_cselect_b32 s41, s41, 0
    s_add_u32 s44, s44, s41
    v_readfirstlane_b32 s41, v19
    s_nop 0
    s_add_u32 s40, s40, s41
    s_cmp_eq_u32 s36, 16
    s_cselect_b32 s42, 32, 0
    s_sub_u32 s41, s41, s42
    s_cmp_gt_u32 s35, 16
    s_cselect_b32 s41, s41, 0
    s_add_u32 s44, s44, s41
    s_cmp_lg_u32 s40, 256
    s_cbranch_scc1 ROLE_MASK
    s_cmp_eq_u32 s36, s35
    s_cselect_b32 s42, 32, 0
    s_sub_u32 s33, s33, s42
    s_add_u32 s33, s33, s44
ROLE_SET:
    v_mov_b32 v4, s37
    v_mov_b32 v5, s33
    v_mov_b32 v3, 0
    ds_write_b64 v3, v[4:5]
    s_waitcnt lgkmcnt(0)
    s_mov_b64 exec, -1
ROLE_WAIT:
    s_barrier
    v_mov_b32 v3, 0
    ds_read_b64 v[4:5], v3
    s_waitcnt lgkmcnt(0)
    v_readfirstlane_b32 s37, v4
    v_readfirstlane_b32 s33, v5
    s_barrier
    s_cmp_eq_u32 s37, 1
    s_cbranch_scc1 TEAM
QKV:
    v_mov_b32 v8, v0
    v_and_b32 v1, 63, v0
    s_load_dwordx2 s[48:49], s[0:1], 0
    s_lshr_b32 s35, s32, 1
    s_and_b32 s36, s32, 1
    v_lshrrev_b32 v24, 4, v1
    v_and_b32 v25, 15, v1
    v_lshlrev_b32 v26, 2, v24
    v_xor_b32 v25, v25, v26
    s_lshl_b32 s37, s32, 2
    v_add_u32 v24, s37, v24
    v_lshlrev_b32 v24, 13, v24
    v_lshl_add_u32 v3, v25, 4, v24
    v_bfe_u32 v24, v1, 2, 2
    v_lshrrev_b32 v25, 5, v1
    v_lshl_add_u32 v25, v25, 3, v24
    v_bfe_u32 v26, v1, 4, 1
    v_bfe_u32 v27, v1, 1, 1
    v_lshl_add_u32 v26, v26, 1, v27
    s_lshl_b32 s37, s36, 3
    v_add_u32 v26, s37, v26
    v_lshlrev_b32 v24, 2, v24
    v_xor_b32 v26, v26, v24
    v_lshlrev_b32 v26, 4, v26
    v_lshl_add_u32 v26, v25, 8, v26
    v_and_b32 v27, 1, v1
    v_lshl_add_u32 v4, v27, 3, v26
    v_xor_b32 v5, 64, v4
    v_add_u32 v6, 65536, v4
    v_add_u32 v7, 65536, v5
    v_lshrrev_b32 v24, 3, v1
    v_and_b32 v25, 7, v1
    v_xor_b32 v25, v25, v24
    s_lshl_b32 s37, s32, 3
    v_add_u32 v24, s37, v24
    v_mul_u32_u24 v24, 1152, v24
    v_lshl_add_u32 v2, v25, 4, v24
    v_and_b32 v24, 31, v1
    v_lshrrev_b32 v25, 5, v1
    v_and_b32 v26, 7, v1
    v_xor_b32 v25, v25, v26
    v_lshlrev_b32 v25, 4, v25
    v_lshl_add_u32 v25, v24, 7, v25
    s_lshl_b32 s37, s35, 13
    s_add_u32 s37, s37, 49152
    v_add_u32 v144, s37, v25
    v_xor_b32 v145, 32, v144
    v_xor_b32 v146, 64, v144
    v_xor_b32 v147, 96, v144
    v_add_u32 v148, 65536, v144
    v_add_u32 v149, 65536, v145
    v_add_u32 v150, 65536, v146
    v_add_u32 v151, 65536, v147
    s_lshl_b32 s53, s32, 10
    v_and_b32 v24, 31, v1
    v_and_b32 v25, 15, v1
    s_lshl_b32 s37, s36, 3
    v_xor_b32 v25, s37, v25
    v_lshlrev_b32 v25, 4, v25
    v_lshl_add_u32 v25, v24, 8, v25
    v_lshrrev_b32 v26, 5, v1
    v_lshl_add_u32 v25, v26, 3, v25
    s_mul_i32 s37, s35, 49152
    v_add_u32 v10, s37, v25
    v_xor_b32 v11, 16, v10
    v_xor_b32 v12, 32, v10
    v_xor_b32 v13, 48, v10
    v_xor_b32 v14, 64, v10
    v_xor_b32 v15, 80, v10
    v_xor_b32 v16, 96, v10
    v_xor_b32 v17, 112, v10
    s_lshl_b32 s38, s36, 12
    s_add_u32 s37, s37, s38
    s_add_u32 s37, s37, 16384
    v_lshlrev_b32 v24, 6, v24
    v_lshl_add_u32 v24, v26, 4, v24
    v_add_u32 v18, s37, v24
    v_lshlrev_b32 v19, 4, v8
    v_lshrrev_b32 v24, 4, v8
    v_and_b32 v25, 15, v8
    v_xor_b32 v25, v25, v24
    v_lshlrev_b32 v25, 4, v25
    v_lshl_add_u32 v20, v24, 8, v25
    s_waitcnt lgkmcnt(0)
    s_and_b32 s49, s49, 0xffff
    s_mov_b32 s50, 2359296
    s_mov_b32 s51, 0x00020000
    s_mov_b32 s40, 0
QKV_TILE:
    s_cmp_ge_u32 s40, 4
    s_cbranch_scc1 QKV_DONE
    s_mul_i32 s42, s33, 9363
    s_lshr_b32 s42, s42, 16
    s_mul_i32 s35, s42, 7
    s_sub_u32 s41, s33, s35
    s_cmp_eq_u32 s40, 1
    s_cselect_b32 s35, 7, 0
    s_add_u32 s41, s41, s35
    s_cmp_lg_u32 s40, 3
    s_cbranch_scc1 QKV_GO
    s_cmp_ge_u32 s33, 64
    s_cbranch_scc1 QKV_DONE
    s_lshr_b32 s42, s33, 1
    s_and_b32 s41, s33, 1
    s_add_u32 s41, s41, 14
QKV_GO:
    s_mul_i32 s46, s41, 147456
    s_lshl_b32 s47, s42, 8
    s_mul_i32 s52, s41, 4
    s_mul_i32 s35, s52, 7282
    s_lshr_b32 s35, s35, 16
    s_mul_i32 s35, s35, 9
    s_sub_u32 s52, s52, s35
    s_cmp_eq_u32 s40, 0
    s_cbranch_scc1 QKV_BODY_KV
    s_cmp_eq_u32 s40, 2
    s_cbranch_scc1 QKV_BODY_Q
QKV_BODY_ALL:
    s_lshl_b32 s43, s52, 7
    s_add_u32 s43, s43, s46
    s_lshl_b32 s44, s52, 19
    s_add_u32 s44, s44, s47
    s_add_u32 s52, s52, 1
    s_cmp_eq_u32 s52, 9
    s_cselect_b32 s52, 0, s52
    s_add_u32 m0, s53, 49152
    s_add_u32 s36, s43, 0
    buffer_load_dwordx4 v2, s[48:51], s36 offen lds
    s_add_u32 m0, s53, 53248
    s_add_u32 s36, s43, 36864
    buffer_load_dwordx4 v2, s[48:51], s36 offen lds
    s_add_u32 m0, s53, 57344
    s_add_u32 s36, s43, 73728
    buffer_load_dwordx4 v2, s[48:51], s36 offen lds
    s_add_u32 m0, s53, 61440
    s_add_u32 s36, s43, 110592
    buffer_load_dwordx4 v2, s[48:51], s36 offen lds
    s_add_u32 m0, s53, 0
    s_add_u32 s36, s44, 0
    buffer_load_dwordx4 v3, s[12:15], s36 offen lds
    s_add_u32 m0, s53, 4096
    s_add_u32 s36, s44, 131072
    buffer_load_dwordx4 v3, s[12:15], s36 offen lds
    s_add_u32 m0, s53, 8192
    s_add_u32 s36, s44, 262144
    buffer_load_dwordx4 v3, s[12:15], s36 offen lds
    s_add_u32 m0, s53, 12288
    s_add_u32 s36, s44, 393216
    buffer_load_dwordx4 v3, s[12:15], s36 offen lds
    s_add_u32 m0, s53, 16384
    s_add_u32 s36, s44, 0
    buffer_load_dwordx4 v3, s[16:19], s36 offen lds
    s_add_u32 m0, s53, 20480
    s_add_u32 s36, s44, 131072
    buffer_load_dwordx4 v3, s[16:19], s36 offen lds
    s_add_u32 m0, s53, 24576
    s_add_u32 s36, s44, 262144
    buffer_load_dwordx4 v3, s[16:19], s36 offen lds
    s_add_u32 m0, s53, 28672
    s_add_u32 s36, s44, 393216
    buffer_load_dwordx4 v3, s[16:19], s36 offen lds
    s_add_u32 m0, s53, 32768
    s_add_u32 s36, s44, 0
    buffer_load_dwordx4 v3, s[20:23], s36 offen lds
    s_add_u32 m0, s53, 36864
    s_add_u32 s36, s44, 131072
    buffer_load_dwordx4 v3, s[20:23], s36 offen lds
    s_add_u32 m0, s53, 40960
    s_add_u32 s36, s44, 262144
    buffer_load_dwordx4 v3, s[20:23], s36 offen lds
    s_add_u32 m0, s53, 45056
    s_add_u32 s36, s44, 393216
    buffer_load_dwordx4 v3, s[20:23], s36 offen lds
    s_waitcnt vmcnt(0)
    s_barrier
    ds_read_b128 v[32:35], v144 offset:0
    ds_read_b128 v[36:39], v144 offset:4096
    ds_read_b64_tr_b16 v[96:97], v4 offset:0
    ds_read_b64_tr_b16 v[98:99], v4 offset:1024
    ds_read_b64_tr_b16 v[100:101], v5 offset:0
    ds_read_b64_tr_b16 v[102:103], v5 offset:1024
    ds_read_b64_tr_b16 v[104:105], v4 offset:16384
    ds_read_b64_tr_b16 v[106:107], v4 offset:17408
    ds_read_b64_tr_b16 v[108:109], v5 offset:16384
    ds_read_b64_tr_b16 v[110:111], v5 offset:17408
    ds_read_b64_tr_b16 v[112:113], v4 offset:32768
    ds_read_b64_tr_b16 v[114:115], v4 offset:33792
    ds_read_b64_tr_b16 v[116:117], v5 offset:32768
    ds_read_b64_tr_b16 v[118:119], v5 offset:33792
    s_lshl_b32 s43, s52, 7
    s_add_u32 s43, s43, s46
    s_lshl_b32 s44, s52, 19
    s_add_u32 s44, s44, s47
    s_add_u32 s52, s52, 1
    s_cmp_eq_u32 s52, 9
    s_cselect_b32 s52, 0, s52
    ds_read_b128 v[40:43], v145 offset:0
    ds_read_b128 v[44:47], v145 offset:4096
    ds_read_b64_tr_b16 v[120:121], v4 offset:4096
    ds_read_b64_tr_b16 v[122:123], v4 offset:5120
    ds_read_b64_tr_b16 v[124:125], v5 offset:4096
    ds_read_b64_tr_b16 v[126:127], v5 offset:5120
    ds_read_b64_tr_b16 v[128:129], v4 offset:20480
    ds_read_b64_tr_b16 v[130:131], v4 offset:21504
    ds_read_b64_tr_b16 v[132:133], v5 offset:20480
    ds_read_b64_tr_b16 v[134:135], v5 offset:21504
    ds_read_b64_tr_b16 v[136:137], v4 offset:36864
    ds_read_b64_tr_b16 v[138:139], v4 offset:37888
    ds_read_b64_tr_b16 v[140:141], v5 offset:36864
    ds_read_b64_tr_b16 v[142:143], v5 offset:37888
    s_waitcnt lgkmcnt(14)
    v_mfma_f32_32x32x16_bf16 a[0:15], v[96:99], v[32:35], 0
    s_add_u32 m0, s53, 114688
    s_add_u32 s36, s43, 0
    buffer_load_dwordx4 v2, s[48:51], s36 offen lds
    v_mfma_f32_32x32x16_bf16 a[32:47], v[96:99], v[36:39], 0
    s_add_u32 m0, s53, 118784
    s_add_u32 s36, s43, 36864
    buffer_load_dwordx4 v2, s[48:51], s36 offen lds
    v_mfma_f32_32x32x16_bf16 a[16:31], v[100:103], v[32:35], 0
    s_add_u32 m0, s53, 122880
    s_add_u32 s36, s43, 73728
    buffer_load_dwordx4 v2, s[48:51], s36 offen lds
    v_mfma_f32_32x32x16_bf16 a[48:63], v[100:103], v[36:39], 0
    s_add_u32 m0, s53, 126976
    s_add_u32 s36, s43, 110592
    buffer_load_dwordx4 v2, s[48:51], s36 offen lds
    v_mfma_f32_32x32x16_bf16 a[64:79], v[104:107], v[32:35], 0
    s_add_u32 m0, s53, 65536
    s_add_u32 s36, s44, 0
    buffer_load_dwordx4 v3, s[12:15], s36 offen lds
    v_mfma_f32_32x32x16_bf16 a[96:111], v[104:107], v[36:39], 0
    s_add_u32 m0, s53, 69632
    s_add_u32 s36, s44, 131072
    buffer_load_dwordx4 v3, s[12:15], s36 offen lds
    v_mfma_f32_32x32x16_bf16 a[80:95], v[108:111], v[32:35], 0
    s_add_u32 m0, s53, 73728
    s_add_u32 s36, s44, 262144
    buffer_load_dwordx4 v3, s[12:15], s36 offen lds
    v_mfma_f32_32x32x16_bf16 a[112:127], v[108:111], v[36:39], 0
    s_add_u32 m0, s53, 77824
    s_add_u32 s36, s44, 393216
    buffer_load_dwordx4 v3, s[12:15], s36 offen lds
    v_mfma_f32_32x32x16_bf16 a[128:143], v[32:35], v[112:115], 0
    s_add_u32 m0, s53, 81920
    s_add_u32 s36, s44, 0
    buffer_load_dwordx4 v3, s[16:19], s36 offen lds
    v_mfma_f32_32x32x16_bf16 a[160:175], v[36:39], v[112:115], 0
    s_add_u32 m0, s53, 86016
    s_add_u32 s36, s44, 131072
    buffer_load_dwordx4 v3, s[16:19], s36 offen lds
    v_mfma_f32_32x32x16_bf16 a[144:159], v[32:35], v[116:119], 0
    s_add_u32 m0, s53, 90112
    s_add_u32 s36, s44, 262144
    buffer_load_dwordx4 v3, s[16:19], s36 offen lds
    v_mfma_f32_32x32x16_bf16 a[176:191], v[36:39], v[116:119], 0
    s_add_u32 m0, s53, 94208
    s_add_u32 s36, s44, 393216
    buffer_load_dwordx4 v3, s[16:19], s36 offen lds
    ds_read_b128 v[32:35], v146 offset:0
    ds_read_b128 v[36:39], v146 offset:4096
    ds_read_b64_tr_b16 v[96:97], v4 offset:8192
    ds_read_b64_tr_b16 v[98:99], v4 offset:9216
    ds_read_b64_tr_b16 v[100:101], v5 offset:8192
    ds_read_b64_tr_b16 v[102:103], v5 offset:9216
    ds_read_b64_tr_b16 v[104:105], v4 offset:24576
    ds_read_b64_tr_b16 v[106:107], v4 offset:25600
    ds_read_b64_tr_b16 v[108:109], v5 offset:24576
    ds_read_b64_tr_b16 v[110:111], v5 offset:25600
    ds_read_b64_tr_b16 v[112:113], v4 offset:40960
    ds_read_b64_tr_b16 v[114:115], v4 offset:41984
    ds_read_b64_tr_b16 v[116:117], v5 offset:40960
    ds_read_b64_tr_b16 v[118:119], v5 offset:41984
    s_waitcnt lgkmcnt(14)
    v_mfma_f32_32x32x16_bf16 a[0:15], v[120:123], v[40:43], a[0:15]
    s_add_u32 m0, s53, 98304
    s_add_u32 s36, s44, 0
    buffer_load_dwordx4 v3, s[20:23], s36 offen lds
    v_mfma_f32_32x32x16_bf16 a[32:47], v[120:123], v[44:47], a[32:47]
    s_add_u32 m0, s53, 102400
    s_add_u32 s36, s44, 131072
    buffer_load_dwordx4 v3, s[20:23], s36 offen lds
    v_mfma_f32_32x32x16_bf16 a[16:31], v[124:127], v[40:43], a[16:31]
    s_add_u32 m0, s53, 106496
    s_add_u32 s36, s44, 262144
    buffer_load_dwordx4 v3, s[20:23], s36 offen lds
    v_mfma_f32_32x32x16_bf16 a[48:63], v[124:127], v[44:47], a[48:63]
    s_add_u32 m0, s53, 110592
    s_add_u32 s36, s44, 393216
    buffer_load_dwordx4 v3, s[20:23], s36 offen lds
    v_mfma_f32_32x32x16_bf16 a[64:79], v[128:131], v[40:43], a[64:79]
    v_mfma_f32_32x32x16_bf16 a[96:111], v[128:131], v[44:47], a[96:111]
    v_mfma_f32_32x32x16_bf16 a[80:95], v[132:135], v[40:43], a[80:95]
    v_mfma_f32_32x32x16_bf16 a[112:127], v[132:135], v[44:47], a[112:127]
    v_mfma_f32_32x32x16_bf16 a[128:143], v[40:43], v[136:139], a[128:143]
    v_mfma_f32_32x32x16_bf16 a[160:175], v[44:47], v[136:139], a[160:175]
    v_mfma_f32_32x32x16_bf16 a[144:159], v[40:43], v[140:143], a[144:159]
    v_mfma_f32_32x32x16_bf16 a[176:191], v[44:47], v[140:143], a[176:191]
    ds_read_b128 v[40:43], v147 offset:0
    ds_read_b128 v[44:47], v147 offset:4096
    ds_read_b64_tr_b16 v[120:121], v4 offset:12288
    ds_read_b64_tr_b16 v[122:123], v4 offset:13312
    ds_read_b64_tr_b16 v[124:125], v5 offset:12288
    ds_read_b64_tr_b16 v[126:127], v5 offset:13312
    ds_read_b64_tr_b16 v[128:129], v4 offset:28672
    ds_read_b64_tr_b16 v[130:131], v4 offset:29696
    ds_read_b64_tr_b16 v[132:133], v5 offset:28672
    ds_read_b64_tr_b16 v[134:135], v5 offset:29696
    ds_read_b64_tr_b16 v[136:137], v4 offset:45056
    ds_read_b64_tr_b16 v[138:139], v4 offset:46080
    ds_read_b64_tr_b16 v[140:141], v5 offset:45056
    ds_read_b64_tr_b16 v[142:143], v5 offset:46080
    s_waitcnt lgkmcnt(14)
    v_mfma_f32_32x32x16_bf16 a[0:15], v[96:99], v[32:35], a[0:15]
    v_mfma_f32_32x32x16_bf16 a[32:47], v[96:99], v[36:39], a[32:47]
    v_mfma_f32_32x32x16_bf16 a[16:31], v[100:103], v[32:35], a[16:31]
    v_mfma_f32_32x32x16_bf16 a[48:63], v[100:103], v[36:39], a[48:63]
    v_mfma_f32_32x32x16_bf16 a[64:79], v[104:107], v[32:35], a[64:79]
    v_mfma_f32_32x32x16_bf16 a[96:111], v[104:107], v[36:39], a[96:111]
    v_mfma_f32_32x32x16_bf16 a[80:95], v[108:111], v[32:35], a[80:95]
    v_mfma_f32_32x32x16_bf16 a[112:127], v[108:111], v[36:39], a[112:127]
    v_mfma_f32_32x32x16_bf16 a[128:143], v[32:35], v[112:115], a[128:143]
    v_mfma_f32_32x32x16_bf16 a[160:175], v[36:39], v[112:115], a[160:175]
    v_mfma_f32_32x32x16_bf16 a[144:159], v[32:35], v[116:119], a[144:159]
    v_mfma_f32_32x32x16_bf16 a[176:191], v[36:39], v[116:119], a[176:191]
    s_waitcnt lgkmcnt(0)
    v_mfma_f32_32x32x16_bf16 a[0:15], v[120:123], v[40:43], a[0:15]
    v_mfma_f32_32x32x16_bf16 a[32:47], v[120:123], v[44:47], a[32:47]
    v_mfma_f32_32x32x16_bf16 a[16:31], v[124:127], v[40:43], a[16:31]
    v_mfma_f32_32x32x16_bf16 a[48:63], v[124:127], v[44:47], a[48:63]
    v_mfma_f32_32x32x16_bf16 a[64:79], v[128:131], v[40:43], a[64:79]
    v_mfma_f32_32x32x16_bf16 a[96:111], v[128:131], v[44:47], a[96:111]
    v_mfma_f32_32x32x16_bf16 a[80:95], v[132:135], v[40:43], a[80:95]
    v_mfma_f32_32x32x16_bf16 a[112:127], v[132:135], v[44:47], a[112:127]
    v_mfma_f32_32x32x16_bf16 a[128:143], v[40:43], v[136:139], a[128:143]
    v_mfma_f32_32x32x16_bf16 a[160:175], v[44:47], v[136:139], a[160:175]
    v_mfma_f32_32x32x16_bf16 a[144:159], v[40:43], v[140:143], a[144:159]
    v_mfma_f32_32x32x16_bf16 a[176:191], v[44:47], v[140:143], a[176:191]
    s_mov_b32 s45, 0
QKV_LOOP_ALL:
    s_waitcnt vmcnt(0)
    s_barrier
    ds_read_b128 v[32:35], v148 offset:0
    ds_read_b128 v[36:39], v148 offset:4096
    ds_read_b64_tr_b16 v[96:97], v6 offset:0
    ds_read_b64_tr_b16 v[98:99], v6 offset:1024
    ds_read_b64_tr_b16 v[100:101], v7 offset:0
    ds_read_b64_tr_b16 v[102:103], v7 offset:1024
    ds_read_b64_tr_b16 v[104:105], v6 offset:16384
    ds_read_b64_tr_b16 v[106:107], v6 offset:17408
    ds_read_b64_tr_b16 v[108:109], v7 offset:16384
    ds_read_b64_tr_b16 v[110:111], v7 offset:17408
    ds_read_b64_tr_b16 v[112:113], v6 offset:32768
    ds_read_b64_tr_b16 v[114:115], v6 offset:33792
    ds_read_b64_tr_b16 v[116:117], v7 offset:32768
    ds_read_b64_tr_b16 v[118:119], v7 offset:33792
    s_lshl_b32 s43, s52, 7
    s_add_u32 s43, s43, s46
    s_lshl_b32 s44, s52, 19
    s_add_u32 s44, s44, s47
    s_add_u32 s52, s52, 1
    s_cmp_eq_u32 s52, 9
    s_cselect_b32 s52, 0, s52
    ds_read_b128 v[40:43], v149 offset:0
    ds_read_b128 v[44:47], v149 offset:4096
    ds_read_b64_tr_b16 v[120:121], v6 offset:4096
    ds_read_b64_tr_b16 v[122:123], v6 offset:5120
    ds_read_b64_tr_b16 v[124:125], v7 offset:4096
    ds_read_b64_tr_b16 v[126:127], v7 offset:5120
    ds_read_b64_tr_b16 v[128:129], v6 offset:20480
    ds_read_b64_tr_b16 v[130:131], v6 offset:21504
    ds_read_b64_tr_b16 v[132:133], v7 offset:20480
    ds_read_b64_tr_b16 v[134:135], v7 offset:21504
    ds_read_b64_tr_b16 v[136:137], v6 offset:36864
    ds_read_b64_tr_b16 v[138:139], v6 offset:37888
    ds_read_b64_tr_b16 v[140:141], v7 offset:36864
    ds_read_b64_tr_b16 v[142:143], v7 offset:37888
    s_waitcnt lgkmcnt(14)
    v_mfma_f32_32x32x16_bf16 a[0:15], v[96:99], v[32:35], a[0:15]
    s_add_u32 m0, s53, 49152
    s_add_u32 s36, s43, 0
    buffer_load_dwordx4 v2, s[48:51], s36 offen lds
    v_mfma_f32_32x32x16_bf16 a[32:47], v[96:99], v[36:39], a[32:47]
    s_add_u32 m0, s53, 53248
    s_add_u32 s36, s43, 36864
    buffer_load_dwordx4 v2, s[48:51], s36 offen lds
    v_mfma_f32_32x32x16_bf16 a[16:31], v[100:103], v[32:35], a[16:31]
    s_add_u32 m0, s53, 57344
    s_add_u32 s36, s43, 73728
    buffer_load_dwordx4 v2, s[48:51], s36 offen lds
    v_mfma_f32_32x32x16_bf16 a[48:63], v[100:103], v[36:39], a[48:63]
    s_add_u32 m0, s53, 61440
    s_add_u32 s36, s43, 110592
    buffer_load_dwordx4 v2, s[48:51], s36 offen lds
    v_mfma_f32_32x32x16_bf16 a[64:79], v[104:107], v[32:35], a[64:79]
    s_add_u32 m0, s53, 0
    s_add_u32 s36, s44, 0
    buffer_load_dwordx4 v3, s[12:15], s36 offen lds
    v_mfma_f32_32x32x16_bf16 a[96:111], v[104:107], v[36:39], a[96:111]
    s_add_u32 m0, s53, 4096
    s_add_u32 s36, s44, 131072
    buffer_load_dwordx4 v3, s[12:15], s36 offen lds
    v_mfma_f32_32x32x16_bf16 a[80:95], v[108:111], v[32:35], a[80:95]
    s_add_u32 m0, s53, 8192
    s_add_u32 s36, s44, 262144
    buffer_load_dwordx4 v3, s[12:15], s36 offen lds
    v_mfma_f32_32x32x16_bf16 a[112:127], v[108:111], v[36:39], a[112:127]
    s_add_u32 m0, s53, 12288
    s_add_u32 s36, s44, 393216
    buffer_load_dwordx4 v3, s[12:15], s36 offen lds
    v_mfma_f32_32x32x16_bf16 a[128:143], v[32:35], v[112:115], a[128:143]
    s_add_u32 m0, s53, 16384
    s_add_u32 s36, s44, 0
    buffer_load_dwordx4 v3, s[16:19], s36 offen lds
    v_mfma_f32_32x32x16_bf16 a[160:175], v[36:39], v[112:115], a[160:175]
    s_add_u32 m0, s53, 20480
    s_add_u32 s36, s44, 131072
    buffer_load_dwordx4 v3, s[16:19], s36 offen lds
    v_mfma_f32_32x32x16_bf16 a[144:159], v[32:35], v[116:119], a[144:159]
    s_add_u32 m0, s53, 24576
    s_add_u32 s36, s44, 262144
    buffer_load_dwordx4 v3, s[16:19], s36 offen lds
    v_mfma_f32_32x32x16_bf16 a[176:191], v[36:39], v[116:119], a[176:191]
    s_add_u32 m0, s53, 28672
    s_add_u32 s36, s44, 393216
    buffer_load_dwordx4 v3, s[16:19], s36 offen lds
    ds_read_b128 v[32:35], v150 offset:0
    ds_read_b128 v[36:39], v150 offset:4096
    ds_read_b64_tr_b16 v[96:97], v6 offset:8192
    ds_read_b64_tr_b16 v[98:99], v6 offset:9216
    ds_read_b64_tr_b16 v[100:101], v7 offset:8192
    ds_read_b64_tr_b16 v[102:103], v7 offset:9216
    ds_read_b64_tr_b16 v[104:105], v6 offset:24576
    ds_read_b64_tr_b16 v[106:107], v6 offset:25600
    ds_read_b64_tr_b16 v[108:109], v7 offset:24576
    ds_read_b64_tr_b16 v[110:111], v7 offset:25600
    ds_read_b64_tr_b16 v[112:113], v6 offset:40960
    ds_read_b64_tr_b16 v[114:115], v6 offset:41984
    ds_read_b64_tr_b16 v[116:117], v7 offset:40960
    ds_read_b64_tr_b16 v[118:119], v7 offset:41984
    s_waitcnt lgkmcnt(14)
    v_mfma_f32_32x32x16_bf16 a[0:15], v[120:123], v[40:43], a[0:15]
    s_add_u32 m0, s53, 32768
    s_add_u32 s36, s44, 0
    buffer_load_dwordx4 v3, s[20:23], s36 offen lds
    v_mfma_f32_32x32x16_bf16 a[32:47], v[120:123], v[44:47], a[32:47]
    s_add_u32 m0, s53, 36864
    s_add_u32 s36, s44, 131072
    buffer_load_dwordx4 v3, s[20:23], s36 offen lds
    v_mfma_f32_32x32x16_bf16 a[16:31], v[124:127], v[40:43], a[16:31]
    s_add_u32 m0, s53, 40960
    s_add_u32 s36, s44, 262144
    buffer_load_dwordx4 v3, s[20:23], s36 offen lds
    v_mfma_f32_32x32x16_bf16 a[48:63], v[124:127], v[44:47], a[48:63]
    s_add_u32 m0, s53, 45056
    s_add_u32 s36, s44, 393216
    buffer_load_dwordx4 v3, s[20:23], s36 offen lds
    v_mfma_f32_32x32x16_bf16 a[64:79], v[128:131], v[40:43], a[64:79]
    v_mfma_f32_32x32x16_bf16 a[96:111], v[128:131], v[44:47], a[96:111]
    v_mfma_f32_32x32x16_bf16 a[80:95], v[132:135], v[40:43], a[80:95]
    v_mfma_f32_32x32x16_bf16 a[112:127], v[132:135], v[44:47], a[112:127]
    v_mfma_f32_32x32x16_bf16 a[128:143], v[40:43], v[136:139], a[128:143]
    v_mfma_f32_32x32x16_bf16 a[160:175], v[44:47], v[136:139], a[160:175]
    v_mfma_f32_32x32x16_bf16 a[144:159], v[40:43], v[140:143], a[144:159]
    v_mfma_f32_32x32x16_bf16 a[176:191], v[44:47], v[140:143], a[176:191]
    ds_read_b128 v[40:43], v151 offset:0
    ds_read_b128 v[44:47], v151 offset:4096
    ds_read_b64_tr_b16 v[120:121], v6 offset:12288
    ds_read_b64_tr_b16 v[122:123], v6 offset:13312
    ds_read_b64_tr_b16 v[124:125], v7 offset:12288
    ds_read_b64_tr_b16 v[126:127], v7 offset:13312
    ds_read_b64_tr_b16 v[128:129], v6 offset:28672
    ds_read_b64_tr_b16 v[130:131], v6 offset:29696
    ds_read_b64_tr_b16 v[132:133], v7 offset:28672
    ds_read_b64_tr_b16 v[134:135], v7 offset:29696
    ds_read_b64_tr_b16 v[136:137], v6 offset:45056
    ds_read_b64_tr_b16 v[138:139], v6 offset:46080
    ds_read_b64_tr_b16 v[140:141], v7 offset:45056
    ds_read_b64_tr_b16 v[142:143], v7 offset:46080
    s_waitcnt lgkmcnt(14)
    v_mfma_f32_32x32x16_bf16 a[0:15], v[96:99], v[32:35], a[0:15]
    v_mfma_f32_32x32x16_bf16 a[32:47], v[96:99], v[36:39], a[32:47]
    v_mfma_f32_32x32x16_bf16 a[16:31], v[100:103], v[32:35], a[16:31]
    v_mfma_f32_32x32x16_bf16 a[48:63], v[100:103], v[36:39], a[48:63]
    v_mfma_f32_32x32x16_bf16 a[64:79], v[104:107], v[32:35], a[64:79]
    v_mfma_f32_32x32x16_bf16 a[96:111], v[104:107], v[36:39], a[96:111]
    v_mfma_f32_32x32x16_bf16 a[80:95], v[108:111], v[32:35], a[80:95]
    v_mfma_f32_32x32x16_bf16 a[112:127], v[108:111], v[36:39], a[112:127]
    v_mfma_f32_32x32x16_bf16 a[128:143], v[32:35], v[112:115], a[128:143]
    v_mfma_f32_32x32x16_bf16 a[160:175], v[36:39], v[112:115], a[160:175]
    v_mfma_f32_32x32x16_bf16 a[144:159], v[32:35], v[116:119], a[144:159]
    v_mfma_f32_32x32x16_bf16 a[176:191], v[36:39], v[116:119], a[176:191]
    s_waitcnt lgkmcnt(0)
    v_mfma_f32_32x32x16_bf16 a[0:15], v[120:123], v[40:43], a[0:15]
    v_mfma_f32_32x32x16_bf16 a[32:47], v[120:123], v[44:47], a[32:47]
    v_mfma_f32_32x32x16_bf16 a[16:31], v[124:127], v[40:43], a[16:31]
    v_mfma_f32_32x32x16_bf16 a[48:63], v[124:127], v[44:47], a[48:63]
    v_mfma_f32_32x32x16_bf16 a[64:79], v[128:131], v[40:43], a[64:79]
    v_mfma_f32_32x32x16_bf16 a[96:111], v[128:131], v[44:47], a[96:111]
    v_mfma_f32_32x32x16_bf16 a[80:95], v[132:135], v[40:43], a[80:95]
    v_mfma_f32_32x32x16_bf16 a[112:127], v[132:135], v[44:47], a[112:127]
    v_mfma_f32_32x32x16_bf16 a[128:143], v[40:43], v[136:139], a[128:143]
    v_mfma_f32_32x32x16_bf16 a[160:175], v[44:47], v[136:139], a[160:175]
    v_mfma_f32_32x32x16_bf16 a[144:159], v[40:43], v[140:143], a[144:159]
    v_mfma_f32_32x32x16_bf16 a[176:191], v[44:47], v[140:143], a[176:191]
    s_waitcnt vmcnt(0)
    s_barrier
    s_cmp_eq_u32 s45, 3
    s_cbranch_scc1 QKV_LASTC_ALL
    ds_read_b128 v[32:35], v144 offset:0
    ds_read_b128 v[36:39], v144 offset:4096
    ds_read_b64_tr_b16 v[96:97], v4 offset:0
    ds_read_b64_tr_b16 v[98:99], v4 offset:1024
    ds_read_b64_tr_b16 v[100:101], v5 offset:0
    ds_read_b64_tr_b16 v[102:103], v5 offset:1024
    ds_read_b64_tr_b16 v[104:105], v4 offset:16384
    ds_read_b64_tr_b16 v[106:107], v4 offset:17408
    ds_read_b64_tr_b16 v[108:109], v5 offset:16384
    ds_read_b64_tr_b16 v[110:111], v5 offset:17408
    ds_read_b64_tr_b16 v[112:113], v4 offset:32768
    ds_read_b64_tr_b16 v[114:115], v4 offset:33792
    ds_read_b64_tr_b16 v[116:117], v5 offset:32768
    ds_read_b64_tr_b16 v[118:119], v5 offset:33792
    s_lshl_b32 s43, s52, 7
    s_add_u32 s43, s43, s46
    s_lshl_b32 s44, s52, 19
    s_add_u32 s44, s44, s47
    s_add_u32 s52, s52, 1
    s_cmp_eq_u32 s52, 9
    s_cselect_b32 s52, 0, s52
    ds_read_b128 v[40:43], v145 offset:0
    ds_read_b128 v[44:47], v145 offset:4096
    ds_read_b64_tr_b16 v[120:121], v4 offset:4096
    ds_read_b64_tr_b16 v[122:123], v4 offset:5120
    ds_read_b64_tr_b16 v[124:125], v5 offset:4096
    ds_read_b64_tr_b16 v[126:127], v5 offset:5120
    ds_read_b64_tr_b16 v[128:129], v4 offset:20480
    ds_read_b64_tr_b16 v[130:131], v4 offset:21504
    ds_read_b64_tr_b16 v[132:133], v5 offset:20480
    ds_read_b64_tr_b16 v[134:135], v5 offset:21504
    ds_read_b64_tr_b16 v[136:137], v4 offset:36864
    ds_read_b64_tr_b16 v[138:139], v4 offset:37888
    ds_read_b64_tr_b16 v[140:141], v5 offset:36864
    ds_read_b64_tr_b16 v[142:143], v5 offset:37888
    s_waitcnt lgkmcnt(14)
    v_mfma_f32_32x32x16_bf16 a[0:15], v[96:99], v[32:35], a[0:15]
    s_add_u32 m0, s53, 114688
    s_add_u32 s36, s43, 0
    buffer_load_dwordx4 v2, s[48:51], s36 offen lds
    v_mfma_f32_32x32x16_bf16 a[32:47], v[96:99], v[36:39], a[32:47]
    s_add_u32 m0, s53, 118784
    s_add_u32 s36, s43, 36864
    buffer_load_dwordx4 v2, s[48:51], s36 offen lds
    v_mfma_f32_32x32x16_bf16 a[16:31], v[100:103], v[32:35], a[16:31]
    s_add_u32 m0, s53, 122880
    s_add_u32 s36, s43, 73728
    buffer_load_dwordx4 v2, s[48:51], s36 offen lds
    v_mfma_f32_32x32x16_bf16 a[48:63], v[100:103], v[36:39], a[48:63]
    s_add_u32 m0, s53, 126976
    s_add_u32 s36, s43, 110592
    buffer_load_dwordx4 v2, s[48:51], s36 offen lds
    v_mfma_f32_32x32x16_bf16 a[64:79], v[104:107], v[32:35], a[64:79]
    s_add_u32 m0, s53, 65536
    s_add_u32 s36, s44, 0
    buffer_load_dwordx4 v3, s[12:15], s36 offen lds
    v_mfma_f32_32x32x16_bf16 a[96:111], v[104:107], v[36:39], a[96:111]
    s_add_u32 m0, s53, 69632
    s_add_u32 s36, s44, 131072
    buffer_load_dwordx4 v3, s[12:15], s36 offen lds
    v_mfma_f32_32x32x16_bf16 a[80:95], v[108:111], v[32:35], a[80:95]
    s_add_u32 m0, s53, 73728
    s_add_u32 s36, s44, 262144
    buffer_load_dwordx4 v3, s[12:15], s36 offen lds
    v_mfma_f32_32x32x16_bf16 a[112:127], v[108:111], v[36:39], a[112:127]
    s_add_u32 m0, s53, 77824
    s_add_u32 s36, s44, 393216
    buffer_load_dwordx4 v3, s[12:15], s36 offen lds
    v_mfma_f32_32x32x16_bf16 a[128:143], v[32:35], v[112:115], a[128:143]
    s_add_u32 m0, s53, 81920
    s_add_u32 s36, s44, 0
    buffer_load_dwordx4 v3, s[16:19], s36 offen lds
    v_mfma_f32_32x32x16_bf16 a[160:175], v[36:39], v[112:115], a[160:175]
    s_add_u32 m0, s53, 86016
    s_add_u32 s36, s44, 131072
    buffer_load_dwordx4 v3, s[16:19], s36 offen lds
    v_mfma_f32_32x32x16_bf16 a[144:159], v[32:35], v[116:119], a[144:159]
    s_add_u32 m0, s53, 90112
    s_add_u32 s36, s44, 262144
    buffer_load_dwordx4 v3, s[16:19], s36 offen lds
    v_mfma_f32_32x32x16_bf16 a[176:191], v[36:39], v[116:119], a[176:191]
    s_add_u32 m0, s53, 94208
    s_add_u32 s36, s44, 393216
    buffer_load_dwordx4 v3, s[16:19], s36 offen lds
    ds_read_b128 v[32:35], v146 offset:0
    ds_read_b128 v[36:39], v146 offset:4096
    ds_read_b64_tr_b16 v[96:97], v4 offset:8192
    ds_read_b64_tr_b16 v[98:99], v4 offset:9216
    ds_read_b64_tr_b16 v[100:101], v5 offset:8192
    ds_read_b64_tr_b16 v[102:103], v5 offset:9216
    ds_read_b64_tr_b16 v[104:105], v4 offset:24576
    ds_read_b64_tr_b16 v[106:107], v4 offset:25600
    ds_read_b64_tr_b16 v[108:109], v5 offset:24576
    ds_read_b64_tr_b16 v[110:111], v5 offset:25600
    ds_read_b64_tr_b16 v[112:113], v4 offset:40960
    ds_read_b64_tr_b16 v[114:115], v4 offset:41984
    ds_read_b64_tr_b16 v[116:117], v5 offset:40960
    ds_read_b64_tr_b16 v[118:119], v5 offset:41984
    s_waitcnt lgkmcnt(14)
    v_mfma_f32_32x32x16_bf16 a[0:15], v[120:123], v[40:43], a[0:15]
    s_add_u32 m0, s53, 98304
    s_add_u32 s36, s44, 0
    buffer_load_dwordx4 v3, s[20:23], s36 offen lds
    v_mfma_f32_32x32x16_bf16 a[32:47], v[120:123], v[44:47], a[32:47]
    s_add_u32 m0, s53, 102400
    s_add_u32 s36, s44, 131072
    buffer_load_dwordx4 v3, s[20:23], s36 offen lds
    v_mfma_f32_32x32x16_bf16 a[16:31], v[124:127], v[40:43], a[16:31]
    s_add_u32 m0, s53, 106496
    s_add_u32 s36, s44, 262144
    buffer_load_dwordx4 v3, s[20:23], s36 offen lds
    v_mfma_f32_32x32x16_bf16 a[48:63], v[124:127], v[44:47], a[48:63]
    s_add_u32 m0, s53, 110592
    s_add_u32 s36, s44, 393216
    buffer_load_dwordx4 v3, s[20:23], s36 offen lds
    v_mfma_f32_32x32x16_bf16 a[64:79], v[128:131], v[40:43], a[64:79]
    v_mfma_f32_32x32x16_bf16 a[96:111], v[128:131], v[44:47], a[96:111]
    v_mfma_f32_32x32x16_bf16 a[80:95], v[132:135], v[40:43], a[80:95]
    v_mfma_f32_32x32x16_bf16 a[112:127], v[132:135], v[44:47], a[112:127]
    v_mfma_f32_32x32x16_bf16 a[128:143], v[40:43], v[136:139], a[128:143]
    v_mfma_f32_32x32x16_bf16 a[160:175], v[44:47], v[136:139], a[160:175]
    v_mfma_f32_32x32x16_bf16 a[144:159], v[40:43], v[140:143], a[144:159]
    v_mfma_f32_32x32x16_bf16 a[176:191], v[44:47], v[140:143], a[176:191]
    ds_read_b128 v[40:43], v147 offset:0
    ds_read_b128 v[44:47], v147 offset:4096
    ds_read_b64_tr_b16 v[120:121], v4 offset:12288
    ds_read_b64_tr_b16 v[122:123], v4 offset:13312
    ds_read_b64_tr_b16 v[124:125], v5 offset:12288
    ds_read_b64_tr_b16 v[126:127], v5 offset:13312
    ds_read_b64_tr_b16 v[128:129], v4 offset:28672
    ds_read_b64_tr_b16 v[130:131], v4 offset:29696
    ds_read_b64_tr_b16 v[132:133], v5 offset:28672
    ds_read_b64_tr_b16 v[134:135], v5 offset:29696
    ds_read_b64_tr_b16 v[136:137], v4 offset:45056
    ds_read_b64_tr_b16 v[138:139], v4 offset:46080
    ds_read_b64_tr_b16 v[140:141], v5 offset:45056
    ds_read_b64_tr_b16 v[142:143], v5 offset:46080
    s_waitcnt lgkmcnt(14)
    v_mfma_f32_32x32x16_bf16 a[0:15], v[96:99], v[32:35], a[0:15]
    v_mfma_f32_32x32x16_bf16 a[32:47], v[96:99], v[36:39], a[32:47]
    v_mfma_f32_32x32x16_bf16 a[16:31], v[100:103], v[32:35], a[16:31]
    v_mfma_f32_32x32x16_bf16 a[48:63], v[100:103], v[36:39], a[48:63]
    v_mfma_f32_32x32x16_bf16 a[64:79], v[104:107], v[32:35], a[64:79]
    v_mfma_f32_32x32x16_bf16 a[96:111], v[104:107], v[36:39], a[96:111]
    v_mfma_f32_32x32x16_bf16 a[80:95], v[108:111], v[32:35], a[80:95]
    v_mfma_f32_32x32x16_bf16 a[112:127], v[108:111], v[36:39], a[112:127]
    v_mfma_f32_32x32x16_bf16 a[128:143], v[32:35], v[112:115], a[128:143]
    v_mfma_f32_32x32x16_bf16 a[160:175], v[36:39], v[112:115], a[160:175]
    v_mfma_f32_32x32x16_bf16 a[144:159], v[32:35], v[116:119], a[144:159]
    v_mfma_f32_32x32x16_bf16 a[176:191], v[36:39], v[116:119], a[176:191]
    s_waitcnt lgkmcnt(0)
    v_mfma_f32_32x32x16_bf16 a[0:15], v[120:123], v[40:43], a[0:15]
    v_mfma_f32_32x32x16_bf16 a[32:47], v[120:123], v[44:47], a[32:47]
    v_mfma_f32_32x32x16_bf16 a[16:31], v[124:127], v[40:43], a[16:31]
    v_mfma_f32_32x32x16_bf16 a[48:63], v[124:127], v[44:47], a[48:63]
    v_mfma_f32_32x32x16_bf16 a[64:79], v[128:131], v[40:43], a[64:79]
    v_mfma_f32_32x32x16_bf16 a[96:111], v[128:131], v[44:47], a[96:111]
    v_mfma_f32_32x32x16_bf16 a[80:95], v[132:135], v[40:43], a[80:95]
    v_mfma_f32_32x32x16_bf16 a[112:127], v[132:135], v[44:47], a[112:127]
    v_mfma_f32_32x32x16_bf16 a[128:143], v[40:43], v[136:139], a[128:143]
    v_mfma_f32_32x32x16_bf16 a[160:175], v[44:47], v[136:139], a[160:175]
    v_mfma_f32_32x32x16_bf16 a[144:159], v[40:43], v[140:143], a[144:159]
    v_mfma_f32_32x32x16_bf16 a[176:191], v[44:47], v[140:143], a[176:191]
    s_add_u32 s45, s45, 1
    s_branch QKV_LOOP_ALL
QKV_LASTC_ALL:
    ds_read_b128 v[32:35], v144 offset:0
    ds_read_b128 v[36:39], v144 offset:4096
    ds_read_b64_tr_b16 v[96:97], v4 offset:0
    ds_read_b64_tr_b16 v[98:99], v4 offset:1024
    ds_read_b64_tr_b16 v[100:101], v5 offset:0
    ds_read_b64_tr_b16 v[102:103], v5 offset:1024
    ds_read_b64_tr_b16 v[104:105], v4 offset:16384
    ds_read_b64_tr_b16 v[106:107], v4 offset:17408
    ds_read_b64_tr_b16 v[108:109], v5 offset:16384
    ds_read_b64_tr_b16 v[110:111], v5 offset:17408
    ds_read_b64_tr_b16 v[112:113], v4 offset:32768
    ds_read_b64_tr_b16 v[114:115], v4 offset:33792
    ds_read_b64_tr_b16 v[116:117], v5 offset:32768
    ds_read_b64_tr_b16 v[118:119], v5 offset:33792
    ds_read_b128 v[40:43], v145 offset:0
    ds_read_b128 v[44:47], v145 offset:4096
    ds_read_b64_tr_b16 v[120:121], v4 offset:4096
    ds_read_b64_tr_b16 v[122:123], v4 offset:5120
    ds_read_b64_tr_b16 v[124:125], v5 offset:4096
    ds_read_b64_tr_b16 v[126:127], v5 offset:5120
    ds_read_b64_tr_b16 v[128:129], v4 offset:20480
    ds_read_b64_tr_b16 v[130:131], v4 offset:21504
    ds_read_b64_tr_b16 v[132:133], v5 offset:20480
    ds_read_b64_tr_b16 v[134:135], v5 offset:21504
    ds_read_b64_tr_b16 v[136:137], v4 offset:36864
    ds_read_b64_tr_b16 v[138:139], v4 offset:37888
    ds_read_b64_tr_b16 v[140:141], v5 offset:36864
    ds_read_b64_tr_b16 v[142:143], v5 offset:37888
    s_waitcnt lgkmcnt(14)
    v_mfma_f32_32x32x16_bf16 a[0:15], v[96:99], v[32:35], a[0:15]
    v_mfma_f32_32x32x16_bf16 a[32:47], v[96:99], v[36:39], a[32:47]
    v_mfma_f32_32x32x16_bf16 a[16:31], v[100:103], v[32:35], a[16:31]
    v_mfma_f32_32x32x16_bf16 a[48:63], v[100:103], v[36:39], a[48:63]
    v_mfma_f32_32x32x16_bf16 a[64:79], v[104:107], v[32:35], a[64:79]
    v_mfma_f32_32x32x16_bf16 a[96:111], v[104:107], v[36:39], a[96:111]
    v_mfma_f32_32x32x16_bf16 a[80:95], v[108:111], v[32:35], a[80:95]
    v_mfma_f32_32x32x16_bf16 a[112:127], v[108:111], v[36:39], a[112:127]
    v_mfma_f32_32x32x16_bf16 a[128:143], v[32:35], v[112:115], a[128:143]
    v_mfma_f32_32x32x16_bf16 a[160:175], v[36:39], v[112:115], a[160:175]
    v_mfma_f32_32x32x16_bf16 a[144:159], v[32:35], v[116:119], a[144:159]
    v_mfma_f32_32x32x16_bf16 a[176:191], v[36:39], v[116:119], a[176:191]
    ds_read_b128 v[32:35], v146 offset:0
    ds_read_b128 v[36:39], v146 offset:4096
    ds_read_b64_tr_b16 v[96:97], v4 offset:8192
    ds_read_b64_tr_b16 v[98:99], v4 offset:9216
    ds_read_b64_tr_b16 v[100:101], v5 offset:8192
    ds_read_b64_tr_b16 v[102:103], v5 offset:9216
    ds_read_b64_tr_b16 v[104:105], v4 offset:24576
    ds_read_b64_tr_b16 v[106:107], v4 offset:25600
    ds_read_b64_tr_b16 v[108:109], v5 offset:24576
    ds_read_b64_tr_b16 v[110:111], v5 offset:25600
    ds_read_b64_tr_b16 v[112:113], v4 offset:40960
    ds_read_b64_tr_b16 v[114:115], v4 offset:41984
    ds_read_b64_tr_b16 v[116:117], v5 offset:40960
    ds_read_b64_tr_b16 v[118:119], v5 offset:41984
    s_waitcnt lgkmcnt(14)
    v_mfma_f32_32x32x16_bf16 a[0:15], v[120:123], v[40:43], a[0:15]
    v_mfma_f32_32x32x16_bf16 a[32:47], v[120:123], v[44:47], a[32:47]
    v_mfma_f32_32x32x16_bf16 a[16:31], v[124:127], v[40:43], a[16:31]
    v_mfma_f32_32x32x16_bf16 a[48:63], v[124:127], v[44:47], a[48:63]
    v_mfma_f32_32x32x16_bf16 a[64:79], v[128:131], v[40:43], a[64:79]
    v_mfma_f32_32x32x16_bf16 a[96:111], v[128:131], v[44:47], a[96:111]
    v_mfma_f32_32x32x16_bf16 a[80:95], v[132:135], v[40:43], a[80:95]
    v_mfma_f32_32x32x16_bf16 a[112:127], v[132:135], v[44:47], a[112:127]
    v_mfma_f32_32x32x16_bf16 a[128:143], v[40:43], v[136:139], a[128:143]
    v_mfma_f32_32x32x16_bf16 a[160:175], v[44:47], v[136:139], a[160:175]
    v_mfma_f32_32x32x16_bf16 a[144:159], v[40:43], v[140:143], a[144:159]
    v_mfma_f32_32x32x16_bf16 a[176:191], v[44:47], v[140:143], a[176:191]
    ds_read_b128 v[40:43], v147 offset:0
    ds_read_b128 v[44:47], v147 offset:4096
    ds_read_b64_tr_b16 v[120:121], v4 offset:12288
    ds_read_b64_tr_b16 v[122:123], v4 offset:13312
    ds_read_b64_tr_b16 v[124:125], v5 offset:12288
    ds_read_b64_tr_b16 v[126:127], v5 offset:13312
    ds_read_b64_tr_b16 v[128:129], v4 offset:28672
    ds_read_b64_tr_b16 v[130:131], v4 offset:29696
    ds_read_b64_tr_b16 v[132:133], v5 offset:28672
    ds_read_b64_tr_b16 v[134:135], v5 offset:29696
    ds_read_b64_tr_b16 v[136:137], v4 offset:45056
    ds_read_b64_tr_b16 v[138:139], v4 offset:46080
    ds_read_b64_tr_b16 v[140:141], v5 offset:45056
    ds_read_b64_tr_b16 v[142:143], v5 offset:46080
    s_waitcnt lgkmcnt(14)
    v_mfma_f32_32x32x16_bf16 a[0:15], v[96:99], v[32:35], a[0:15]
    v_mfma_f32_32x32x16_bf16 a[32:47], v[96:99], v[36:39], a[32:47]
    v_mfma_f32_32x32x16_bf16 a[16:31], v[100:103], v[32:35], a[16:31]
    v_mfma_f32_32x32x16_bf16 a[48:63], v[100:103], v[36:39], a[48:63]
    v_mfma_f32_32x32x16_bf16 a[64:79], v[104:107], v[32:35], a[64:79]
    v_mfma_f32_32x32x16_bf16 a[96:111], v[104:107], v[36:39], a[96:111]
    v_mfma_f32_32x32x16_bf16 a[80:95], v[108:111], v[32:35], a[80:95]
    v_mfma_f32_32x32x16_bf16 a[112:127], v[108:111], v[36:39], a[112:127]
    v_mfma_f32_32x32x16_bf16 a[128:143], v[32:35], v[112:115], a[128:143]
    v_mfma_f32_32x32x16_bf16 a[160:175], v[36:39], v[112:115], a[160:175]
    v_mfma_f32_32x32x16_bf16 a[144:159], v[32:35], v[116:119], a[144:159]
    v_mfma_f32_32x32x16_bf16 a[176:191], v[36:39], v[116:119], a[176:191]
    s_waitcnt lgkmcnt(0)
    v_mfma_f32_32x32x16_bf16 a[0:15], v[120:123], v[40:43], a[0:15]
    v_mfma_f32_32x32x16_bf16 a[32:47], v[120:123], v[44:47], a[32:47]
    v_mfma_f32_32x32x16_bf16 a[16:31], v[124:127], v[40:43], a[16:31]
    v_mfma_f32_32x32x16_bf16 a[48:63], v[124:127], v[44:47], a[48:63]
    v_mfma_f32_32x32x16_bf16 a[64:79], v[128:131], v[40:43], a[64:79]
    v_mfma_f32_32x32x16_bf16 a[96:111], v[128:131], v[44:47], a[96:111]
    v_mfma_f32_32x32x16_bf16 a[80:95], v[132:135], v[40:43], a[80:95]
    v_mfma_f32_32x32x16_bf16 a[112:127], v[132:135], v[44:47], a[112:127]
    v_mfma_f32_32x32x16_bf16 a[128:143], v[40:43], v[136:139], a[128:143]
    v_mfma_f32_32x32x16_bf16 a[160:175], v[44:47], v[136:139], a[160:175]
    v_mfma_f32_32x32x16_bf16 a[144:159], v[40:43], v[140:143], a[144:159]
    v_mfma_f32_32x32x16_bf16 a[176:191], v[44:47], v[140:143], a[176:191]
    s_nop 15
    s_barrier
    v_accvgpr_read_b32 v32, a0
    v_accvgpr_read_b32 v33, a1
    v_accvgpr_read_b32 v34, a2
    v_accvgpr_read_b32 v35, a3
    v_accvgpr_read_b32 v36, a4
    v_accvgpr_read_b32 v37, a5
    v_accvgpr_read_b32 v38, a6
    v_accvgpr_read_b32 v39, a7
    v_accvgpr_read_b32 v40, a8
    v_accvgpr_read_b32 v41, a9
    v_accvgpr_read_b32 v42, a10
    v_accvgpr_read_b32 v43, a11
    v_accvgpr_read_b32 v44, a12
    v_accvgpr_read_b32 v45, a13
    v_accvgpr_read_b32 v46, a14
    v_accvgpr_read_b32 v47, a15
    v_cvt_pk_bf16_f32 v48, v32, v33
    v_cvt_pk_bf16_f32 v49, v34, v35
    v_cvt_pk_bf16_f32 v50, v36, v37
    v_cvt_pk_bf16_f32 v51, v38, v39
    v_cvt_pk_bf16_f32 v52, v40, v41
    v_cvt_pk_bf16_f32 v53, v42, v43
    v_cvt_pk_bf16_f32 v54, v44, v45
    v_cvt_pk_bf16_f32 v55, v46, v47
    ds_write_b64 v10, v[48:49] offset:0
    ds_write_b64 v11, v[50:51] offset:0
    ds_write_b64 v12, v[52:53] offset:0
    ds_write_b64 v13, v[54:55] offset:0
    v_accvgpr_read_b32 v64, a16
    v_accvgpr_read_b32 v65, a17
    v_accvgpr_read_b32 v66, a18
    v_accvgpr_read_b32 v67, a19
    v_accvgpr_read_b32 v68, a20
    v_accvgpr_read_b32 v69, a21
    v_accvgpr_read_b32 v70, a22
    v_accvgpr_read_b32 v71, a23
    v_accvgpr_read_b32 v72, a24
    v_accvgpr_read_b32 v73, a25
    v_accvgpr_read_b32 v74, a26
    v_accvgpr_read_b32 v75, a27
    v_accvgpr_read_b32 v76, a28
    v_accvgpr_read_b32 v77, a29
    v_accvgpr_read_b32 v78, a30
    v_accvgpr_read_b32 v79, a31
    v_cvt_pk_bf16_f32 v80, v64, v65
    v_cvt_pk_bf16_f32 v81, v66, v67
    v_cvt_pk_bf16_f32 v82, v68, v69
    v_cvt_pk_bf16_f32 v83, v70, v71
    v_cvt_pk_bf16_f32 v84, v72, v73
    v_cvt_pk_bf16_f32 v85, v74, v75
    v_cvt_pk_bf16_f32 v86, v76, v77
    v_cvt_pk_bf16_f32 v87, v78, v79
    ds_write_b64 v14, v[80:81] offset:0
    ds_write_b64 v15, v[82:83] offset:0
    ds_write_b64 v16, v[84:85] offset:0
    ds_write_b64 v17, v[86:87] offset:0
    v_accvgpr_read_b32 v32, a32
    v_accvgpr_read_b32 v33, a33
    v_accvgpr_read_b32 v34, a34
    v_accvgpr_read_b32 v35, a35
    v_accvgpr_read_b32 v36, a36
    v_accvgpr_read_b32 v37, a37
    v_accvgpr_read_b32 v38, a38
    v_accvgpr_read_b32 v39, a39
    v_accvgpr_read_b32 v40, a40
    v_accvgpr_read_b32 v41, a41
    v_accvgpr_read_b32 v42, a42
    v_accvgpr_read_b32 v43, a43
    v_accvgpr_read_b32 v44, a44
    v_accvgpr_read_b32 v45, a45
    v_accvgpr_read_b32 v46, a46
    v_accvgpr_read_b32 v47, a47
    v_cvt_pk_bf16_f32 v48, v32, v33
    v_cvt_pk_bf16_f32 v49, v34, v35
    v_cvt_pk_bf16_f32 v50, v36, v37
    v_cvt_pk_bf16_f32 v51, v38, v39
    v_cvt_pk_bf16_f32 v52, v40, v41
    v_cvt_pk_bf16_f32 v53, v42, v43
    v_cvt_pk_bf16_f32 v54, v44, v45
    v_cvt_pk_bf16_f32 v55, v46, v47
    ds_write_b64 v10, v[48:49] offset:24576
    ds_write_b64 v11, v[50:51] offset:24576
    ds_write_b64 v12, v[52:53] offset:24576
    ds_write_b64 v13, v[54:55] offset:24576
    v_accvgpr_read_b32 v64, a48
    v_accvgpr_read_b32 v65, a49
    v_accvgpr_read_b32 v66, a50
    v_accvgpr_read_b32 v67, a51
    v_accvgpr_read_b32 v68, a52
    v_accvgpr_read_b32 v69, a53
    v_accvgpr_read_b32 v70, a54
    v_accvgpr_read_b32 v71, a55
    v_accvgpr_read_b32 v72, a56
    v_accvgpr_read_b32 v73, a57
    v_accvgpr_read_b32 v74, a58
    v_accvgpr_read_b32 v75, a59
    v_accvgpr_read_b32 v76, a60
    v_accvgpr_read_b32 v77, a61
    v_accvgpr_read_b32 v78, a62
    v_accvgpr_read_b32 v79, a63
    v_cvt_pk_bf16_f32 v80, v64, v65
    v_cvt_pk_bf16_f32 v81, v66, v67
    v_cvt_pk_bf16_f32 v82, v68, v69
    v_cvt_pk_bf16_f32 v83, v70, v71
    v_cvt_pk_bf16_f32 v84, v72, v73
    v_cvt_pk_bf16_f32 v85, v74, v75
    v_cvt_pk_bf16_f32 v86, v76, v77
    v_cvt_pk_bf16_f32 v87, v78, v79
    ds_write_b64 v14, v[80:81] offset:24576
    ds_write_b64 v15, v[82:83] offset:24576
    ds_write_b64 v16, v[84:85] offset:24576
    ds_write_b64 v17, v[86:87] offset:24576
    v_accvgpr_read_b32 v32, a64
    v_accvgpr_read_b32 v33, a65
    v_accvgpr_read_b32 v34, a66
    v_accvgpr_read_b32 v35, a67
    v_accvgpr_read_b32 v36, a68
    v_accvgpr_read_b32 v37, a69
    v_accvgpr_read_b32 v38, a70
    v_accvgpr_read_b32 v39, a71
    v_accvgpr_read_b32 v40, a72
    v_accvgpr_read_b32 v41, a73
    v_accvgpr_read_b32 v42, a74
    v_accvgpr_read_b32 v43, a75
    v_accvgpr_read_b32 v44, a76
    v_accvgpr_read_b32 v45, a77
    v_accvgpr_read_b32 v46, a78
    v_accvgpr_read_b32 v47, a79
    v_cvt_pk_bf16_f32 v48, v32, v33
    v_cvt_pk_bf16_f32 v49, v34, v35
    v_cvt_pk_bf16_f32 v50, v36, v37
    v_cvt_pk_bf16_f32 v51, v38, v39
    v_cvt_pk_bf16_f32 v52, v40, v41
    v_cvt_pk_bf16_f32 v53, v42, v43
    v_cvt_pk_bf16_f32 v54, v44, v45
    v_cvt_pk_bf16_f32 v55, v46, v47
    ds_write_b64 v10, v[48:49] offset:8192
    ds_write_b64 v11, v[50:51] offset:8192
    ds_write_b64 v12, v[52:53] offset:8192
    ds_write_b64 v13, v[54:55] offset:8192
    v_accvgpr_read_b32 v64, a80
    v_accvgpr_read_b32 v65, a81
    v_accvgpr_read_b32 v66, a82
    v_accvgpr_read_b32 v67, a83
    v_accvgpr_read_b32 v68, a84
    v_accvgpr_read_b32 v69, a85
    v_accvgpr_read_b32 v70, a86
    v_accvgpr_read_b32 v71, a87
    v_accvgpr_read_b32 v72, a88
    v_accvgpr_read_b32 v73, a89
    v_accvgpr_read_b32 v74, a90
    v_accvgpr_read_b32 v75, a91
    v_accvgpr_read_b32 v76, a92
    v_accvgpr_read_b32 v77, a93
    v_accvgpr_read_b32 v78, a94
    v_accvgpr_read_b32 v79, a95
    v_cvt_pk_bf16_f32 v80, v64, v65
    v_cvt_pk_bf16_f32 v81, v66, v67
    v_cvt_pk_bf16_f32 v82, v68, v69
    v_cvt_pk_bf16_f32 v83, v70, v71
    v_cvt_pk_bf16_f32 v84, v72, v73
    v_cvt_pk_bf16_f32 v85, v74, v75
    v_cvt_pk_bf16_f32 v86, v76, v77
    v_cvt_pk_bf16_f32 v87, v78, v79
    ds_write_b64 v14, v[80:81] offset:8192
    ds_write_b64 v15, v[82:83] offset:8192
    ds_write_b64 v16, v[84:85] offset:8192
    ds_write_b64 v17, v[86:87] offset:8192
    v_accvgpr_read_b32 v32, a96
    v_accvgpr_read_b32 v33, a97
    v_accvgpr_read_b32 v34, a98
    v_accvgpr_read_b32 v35, a99
    v_accvgpr_read_b32 v36, a100
    v_accvgpr_read_b32 v37, a101
    v_accvgpr_read_b32 v38, a102
    v_accvgpr_read_b32 v39, a103
    v_accvgpr_read_b32 v40, a104
    v_accvgpr_read_b32 v41, a105
    v_accvgpr_read_b32 v42, a106
    v_accvgpr_read_b32 v43, a107
    v_accvgpr_read_b32 v44, a108
    v_accvgpr_read_b32 v45, a109
    v_accvgpr_read_b32 v46, a110
    v_accvgpr_read_b32 v47, a111
    v_cvt_pk_bf16_f32 v48, v32, v33
    v_cvt_pk_bf16_f32 v49, v34, v35
    v_cvt_pk_bf16_f32 v50, v36, v37
    v_cvt_pk_bf16_f32 v51, v38, v39
    v_cvt_pk_bf16_f32 v52, v40, v41
    v_cvt_pk_bf16_f32 v53, v42, v43
    v_cvt_pk_bf16_f32 v54, v44, v45
    v_cvt_pk_bf16_f32 v55, v46, v47
    ds_write_b64 v10, v[48:49] offset:32768
    ds_write_b64 v11, v[50:51] offset:32768
    ds_write_b64 v12, v[52:53] offset:32768
    ds_write_b64 v13, v[54:55] offset:32768
    v_accvgpr_read_b32 v64, a112
    v_accvgpr_read_b32 v65, a113
    v_accvgpr_read_b32 v66, a114
    v_accvgpr_read_b32 v67, a115
    v_accvgpr_read_b32 v68, a116
    v_accvgpr_read_b32 v69, a117
    v_accvgpr_read_b32 v70, a118
    v_accvgpr_read_b32 v71, a119
    v_accvgpr_read_b32 v72, a120
    v_accvgpr_read_b32 v73, a121
    v_accvgpr_read_b32 v74, a122
    v_accvgpr_read_b32 v75, a123
    v_accvgpr_read_b32 v76, a124
    v_accvgpr_read_b32 v77, a125
    v_accvgpr_read_b32 v78, a126
    v_accvgpr_read_b32 v79, a127
    v_cvt_pk_bf16_f32 v80, v64, v65
    v_cvt_pk_bf16_f32 v81, v66, v67
    v_cvt_pk_bf16_f32 v82, v68, v69
    v_cvt_pk_bf16_f32 v83, v70, v71
    v_cvt_pk_bf16_f32 v84, v72, v73
    v_cvt_pk_bf16_f32 v85, v74, v75
    v_cvt_pk_bf16_f32 v86, v76, v77
    v_cvt_pk_bf16_f32 v87, v78, v79
    ds_write_b64 v14, v[80:81] offset:32768
    ds_write_b64 v15, v[82:83] offset:32768
    ds_write_b64 v16, v[84:85] offset:32768
    ds_write_b64 v17, v[86:87] offset:32768
    v_accvgpr_read_b32 v32, a128
    v_accvgpr_read_b32 v33, a129
    v_accvgpr_read_b32 v34, a130
    v_accvgpr_read_b32 v35, a131
    v_accvgpr_read_b32 v36, a132
    v_accvgpr_read_b32 v37, a133
    v_accvgpr_read_b32 v38, a134
    v_accvgpr_read_b32 v39, a135
    v_accvgpr_read_b32 v40, a136
    v_accvgpr_read_b32 v41, a137
    v_accvgpr_read_b32 v42, a138
    v_accvgpr_read_b32 v43, a139
    v_accvgpr_read_b32 v44, a140
    v_accvgpr_read_b32 v45, a141
    v_accvgpr_read_b32 v46, a142
    v_accvgpr_read_b32 v47, a143
    v_cvt_pk_bf16_f32 v48, v32, v33
    v_cvt_pk_bf16_f32 v49, v34, v35
    v_cvt_pk_bf16_f32 v50, v40, v41
    v_cvt_pk_bf16_f32 v51, v42, v43
    v_cvt_pk_bf16_f32 v52, v36, v37
    v_cvt_pk_bf16_f32 v53, v38, v39
    v_cvt_pk_bf16_f32 v54, v44, v45
    v_cvt_pk_bf16_f32 v55, v46, v47
    ds_write_b128 v18, v[48:51] offset:0
    ds_write_b128 v18, v[52:55] offset:32
    v_accvgpr_read_b32 v64, a144
    v_accvgpr_read_b32 v65, a145
    v_accvgpr_read_b32 v66, a146
    v_accvgpr_read_b32 v67, a147
    v_accvgpr_read_b32 v68, a148
    v_accvgpr_read_b32 v69, a149
    v_accvgpr_read_b32 v70, a150
    v_accvgpr_read_b32 v71, a151
    v_accvgpr_read_b32 v72, a152
    v_accvgpr_read_b32 v73, a153
    v_accvgpr_read_b32 v74, a154
    v_accvgpr_read_b32 v75, a155
    v_accvgpr_read_b32 v76, a156
    v_accvgpr_read_b32 v77, a157
    v_accvgpr_read_b32 v78, a158
    v_accvgpr_read_b32 v79, a159
    v_cvt_pk_bf16_f32 v80, v64, v65
    v_cvt_pk_bf16_f32 v81, v66, v67
    v_cvt_pk_bf16_f32 v82, v72, v73
    v_cvt_pk_bf16_f32 v83, v74, v75
    v_cvt_pk_bf16_f32 v84, v68, v69
    v_cvt_pk_bf16_f32 v85, v70, v71
    v_cvt_pk_bf16_f32 v86, v76, v77
    v_cvt_pk_bf16_f32 v87, v78, v79
    ds_write_b128 v18, v[80:83] offset:2048
    ds_write_b128 v18, v[84:87] offset:2080
    v_accvgpr_read_b32 v32, a160
    v_accvgpr_read_b32 v33, a161
    v_accvgpr_read_b32 v34, a162
    v_accvgpr_read_b32 v35, a163
    v_accvgpr_read_b32 v36, a164
    v_accvgpr_read_b32 v37, a165
    v_accvgpr_read_b32 v38, a166
    v_accvgpr_read_b32 v39, a167
    v_accvgpr_read_b32 v40, a168
    v_accvgpr_read_b32 v41, a169
    v_accvgpr_read_b32 v42, a170
    v_accvgpr_read_b32 v43, a171
    v_accvgpr_read_b32 v44, a172
    v_accvgpr_read_b32 v45, a173
    v_accvgpr_read_b32 v46, a174
    v_accvgpr_read_b32 v47, a175
    v_cvt_pk_bf16_f32 v48, v32, v33
    v_cvt_pk_bf16_f32 v49, v34, v35
    v_cvt_pk_bf16_f32 v50, v40, v41
    v_cvt_pk_bf16_f32 v51, v42, v43
    v_cvt_pk_bf16_f32 v52, v36, v37
    v_cvt_pk_bf16_f32 v53, v38, v39
    v_cvt_pk_bf16_f32 v54, v44, v45
    v_cvt_pk_bf16_f32 v55, v46, v47
    ds_write_b128 v18, v[48:51] offset:24576
    ds_write_b128 v18, v[52:55] offset:24608
    v_accvgpr_read_b32 v64, a176
    v_accvgpr_read_b32 v65, a177
    v_accvgpr_read_b32 v66, a178
    v_accvgpr_read_b32 v67, a179
    v_accvgpr_read_b32 v68, a180
    v_accvgpr_read_b32 v69, a181
    v_accvgpr_read_b32 v70, a182
    v_accvgpr_read_b32 v71, a183
    v_accvgpr_read_b32 v72, a184
    v_accvgpr_read_b32 v73, a185
    v_accvgpr_read_b32 v74, a186
    v_accvgpr_read_b32 v75, a187
    v_accvgpr_read_b32 v76, a188
    v_accvgpr_read_b32 v77, a189
    v_accvgpr_read_b32 v78, a190
    v_accvgpr_read_b32 v79, a191
    v_cvt_pk_bf16_f32 v80, v64, v65
    v_cvt_pk_bf16_f32 v81, v66, v67
    v_cvt_pk_bf16_f32 v82, v72, v73
    v_cvt_pk_bf16_f32 v83, v74, v75
    v_cvt_pk_bf16_f32 v84, v68, v69
    v_cvt_pk_bf16_f32 v85, v70, v71
    v_cvt_pk_bf16_f32 v86, v76, v77
    v_cvt_pk_bf16_f32 v87, v78, v79
    ds_write_b128 v18, v[80:83] offset:26624
    ds_write_b128 v18, v[84:87] offset:26656
    s_waitcnt lgkmcnt(0)
    s_barrier
    s_lshl_b32 s35, s41, 2
    s_lshl_b32 s36, s42, 6
    s_add_u32 s35, s35, s36
    s_lshl_b32 s35, s35, 13
    v_add_u32 v24, 65536, v19
    ds_read_b128 v[32:35], v19 offset:8192
    ds_read_b128 v[36:39], v19 offset:12288
    ds_read_b128 v[40:43], v19 offset:32768
    ds_read_b128 v[44:47], v19 offset:36864
    ds_read_b128 v[48:51], v19 offset:57344
    ds_read_b128 v[52:55], v19 offset:61440
    ds_read_b128 v[56:59], v24 offset:16384
    ds_read_b128 v[60:63], v24 offset:20480
    ds_read_b128 v[64:67], v19 offset:16384
    ds_read_b128 v[68:71], v19 offset:20480
    ds_read_b128 v[72:75], v19 offset:40960
    ds_read_b128 v[76:79], v19 offset:45056
    ds_read_b128 v[80:83], v24 offset:0
    ds_read_b128 v[84:87], v24 offset:4096
    ds_read_b128 v[88:91], v24 offset:24576
    ds_read_b128 v[92:95], v24 offset:28672
    ds_read_b128 v[96:99], v19 offset:0
    ds_read_b128 v[100:103], v19 offset:4096
    ds_read_b128 v[104:107], v19 offset:24576
    ds_read_b128 v[108:111], v19 offset:28672
    ds_read_b128 v[112:115], v19 offset:49152
    ds_read_b128 v[116:119], v19 offset:53248
    ds_read_b128 v[120:123], v24 offset:8192
    ds_read_b128 v[124:127], v24 offset:12288
    s_waitcnt lgkmcnt(15)
    s_add_u32 s36, s35, 33554432
    buffer_store_dwordx4 v[32:35], v20, s[4:7], s36 offen sc1
    s_add_u32 s36, s35, 33558528
    buffer_store_dwordx4 v[36:39], v20, s[4:7], s36 offen sc1
    s_add_u32 s36, s35, 33562624
    buffer_store_dwordx4 v[40:43], v20, s[4:7], s36 offen sc1
    s_add_u32 s36, s35, 33566720
    buffer_store_dwordx4 v[44:47], v20, s[4:7], s36 offen sc1
    s_waitcnt lgkmcnt(15)
    s_add_u32 s36, s35, 33570816
    buffer_store_dwordx4 v[48:51], v20, s[4:7], s36 offen sc1
    s_add_u32 s36, s35, 33574912
    buffer_store_dwordx4 v[52:55], v20, s[4:7], s36 offen sc1
    s_add_u32 s36, s35, 33579008
    buffer_store_dwordx4 v[56:59], v20, s[4:7], s36 offen sc1
    s_add_u32 s36, s35, 33583104
    buffer_store_dwordx4 v[60:63], v20, s[4:7], s36 offen sc1
    s_waitcnt lgkmcnt(12)
    s_add_u32 s36, s35, 50331648
    buffer_store_dwordx4 v[64:67], v19, s[4:7], s36 offen sc1
    s_add_u32 s36, s35, 50335744
    buffer_store_dwordx4 v[68:71], v19, s[4:7], s36 offen sc1
    s_add_u32 s36, s35, 50339840
    buffer_store_dwordx4 v[72:75], v19, s[4:7], s36 offen sc1
    s_add_u32 s36, s35, 50343936
    buffer_store_dwordx4 v[76:79], v19, s[4:7], s36 offen sc1
    s_waitcnt lgkmcnt(8)
    s_add_u32 s36, s35, 50348032
    buffer_store_dwordx4 v[80:83], v19, s[4:7], s36 offen sc1
    s_add_u32 s36, s35, 50352128
    buffer_store_dwordx4 v[84:87], v19, s[4:7], s36 offen sc1
    s_add_u32 s36, s35, 50356224
    buffer_store_dwordx4 v[88:91], v19, s[4:7], s36 offen sc1
    s_add_u32 s36, s35, 50360320
    buffer_store_dwordx4 v[92:95], v19, s[4:7], s36 offen sc1
    s_waitcnt lgkmcnt(4)
    s_add_u32 s36, s35, 16777216
    buffer_store_dwordx4 v[96:99], v20, s[4:7], s36 offen sc1
    s_add_u32 s36, s35, 16781312
    buffer_store_dwordx4 v[100:103], v20, s[4:7], s36 offen sc1
    s_add_u32 s36, s35, 16785408
    buffer_store_dwordx4 v[104:107], v20, s[4:7], s36 offen sc1
    s_add_u32 s36, s35, 16789504
    buffer_store_dwordx4 v[108:111], v20, s[4:7], s36 offen sc1
    s_waitcnt lgkmcnt(0)
    s_add_u32 s36, s35, 16793600
    buffer_store_dwordx4 v[112:115], v20, s[4:7], s36 offen sc1
    s_add_u32 s36, s35, 16797696
    buffer_store_dwordx4 v[116:119], v20, s[4:7], s36 offen sc1
    s_add_u32 s36, s35, 16801792
    buffer_store_dwordx4 v[120:123], v20, s[4:7], s36 offen sc1
    s_add_u32 s36, s35, 16805888
    buffer_store_dwordx4 v[124:127], v20, s[4:7], s36 offen sc1
    s_waitcnt vmcnt(0)
    s_barrier
    s_cmp_lg_u32 s32, 0
    s_cbranch_scc1 QKV_NEXT
    s_lshl_b32 s35, 1, s42
    s_lshl_b32 s36, s41, 6
    s_add_u32 s36, s36, 1024
    v_mov_b32 v24, s35
    v_mov_b32 v25, s36
    s_mov_b64 exec, 1
    buffer_atomic_or v24, v25, s[4:7], 0 offen
    buffer_atomic_or v24, v25, s[4:7], 0 offen offset:4
    s_mov_b64 exec, -1
    s_branch QKV_NEXT
QKV_BODY_KV:
    s_lshl_b32 s43, s52, 7
    s_add_u32 s43, s43, s46
    s_lshl_b32 s44, s52, 19
    s_add_u32 s44, s44, s47
    s_add_u32 s52, s52, 1
    s_cmp_eq_u32 s52, 9
    s_cselect_b32 s52, 0, s52
    s_add_u32 m0, s53, 49152
    s_add_u32 s36, s43, 0
    buffer_load_dwordx4 v2, s[48:51], s36 offen lds
    s_add_u32 m0, s53, 53248
    s_add_u32 s36, s43, 36864
    buffer_load_dwordx4 v2, s[48:51], s36 offen lds
    s_add_u32 m0, s53, 57344
    s_add_u32 s36, s43, 73728
    buffer_load_dwordx4 v2, s[48:51], s36 offen lds
    s_add_u32 m0, s53, 61440
    s_add_u32 s36, s43, 110592
    buffer_load_dwordx4 v2, s[48:51], s36 offen lds
    s_add_u32 m0, s53, 16384
    s_add_u32 s36, s44, 0
    buffer_load_dwordx4 v3, s[16:19], s36 offen lds
    s_add_u32 m0, s53, 20480
    s_add_u32 s36, s44, 131072
    buffer_load_dwordx4 v3, s[16:19], s36 offen lds
    s_add_u32 m0, s53, 24576
    s_add_u32 s36, s44, 262144
    buffer_load_dwordx4 v3, s[16:19], s36 offen lds
    s_add_u32 m0, s53, 28672
    s_add_u32 s36, s44, 393216
    buffer_load_dwordx4 v3, s[16:19], s36 offen lds
    s_add_u32 m0, s53, 32768
    s_add_u32 s36, s44, 0
    buffer_load_dwordx4 v3, s[20:23], s36 offen lds
    s_add_u32 m0, s53, 36864
    s_add_u32 s36, s44, 131072
    buffer_load_dwordx4 v3, s[20:23], s36 offen lds
    s_add_u32 m0, s53, 40960
    s_add_u32 s36, s44, 262144
    buffer_load_dwordx4 v3, s[20:23], s36 offen lds
    s_add_u32 m0, s53, 45056
    s_add_u32 s36, s44, 393216
    buffer_load_dwordx4 v3, s[20:23], s36 offen lds
    s_waitcnt vmcnt(0)
    s_barrier
    ds_read_b128 v[32:35], v144 offset:0
    ds_read_b128 v[36:39], v144 offset:4096
    ds_read_b64_tr_b16 v[104:105], v4 offset:16384
    ds_read_b64_tr_b16 v[106:107], v4 offset:17408
    ds_read_b64_tr_b16 v[108:109], v5 offset:16384
    ds_read_b64_tr_b16 v[110:111], v5 offset:17408
    ds_read_b64_tr_b16 v[112:113], v4 offset:32768
    ds_read_b64_tr_b16 v[114:115], v4 offset:33792
    ds_read_b64_tr_b16 v[116:117], v5 offset:32768
    ds_read_b64_tr_b16 v[118:119], v5 offset:33792
    s_lshl_b32 s43, s52, 7
    s_add_u32 s43, s43, s46
    s_lshl_b32 s44, s52, 19
    s_add_u32 s44, s44, s47
    s_add_u32 s52, s52, 1
    s_cmp_eq_u32 s52, 9
    s_cselect_b32 s52, 0, s52
    ds_read_b128 v[40:43], v145 offset:0
    ds_read_b128 v[44:47], v145 offset:4096
    ds_read_b64_tr_b16 v[128:129], v4 offset:20480
    ds_read_b64_tr_b16 v[130:131], v4 offset:21504
    ds_read_b64_tr_b16 v[132:133], v5 offset:20480
    ds_read_b64_tr_b16 v[134:135], v5 offset:21504
    ds_read_b64_tr_b16 v[136:137], v4 offset:36864
    ds_read_b64_tr_b16 v[138:139], v4 offset:37888
    ds_read_b64_tr_b16 v[140:141], v5 offset:36864
    ds_read_b64_tr_b16 v[142:143], v5 offset:37888
    s_waitcnt lgkmcnt(10)
    v_mfma_f32_32x32x16_bf16 a[64:79], v[104:107], v[32:35], 0
    s_add_u32 m0, s53, 114688
    s_add_u32 s36, s43, 0
    buffer_load_dwordx4 v2, s[48:51], s36 offen lds
    v_mfma_f32_32x32x16_bf16 a[96:111], v[104:107], v[36:39], 0
    s_add_u32 m0, s53, 118784
    s_add_u32 s36, s43, 36864
    buffer_load_dwordx4 v2, s[48:51], s36 offen lds
    v_mfma_f32_32x32x16_bf16 a[80:95], v[108:111], v[32:35], 0
    s_add_u32 m0, s53, 122880
    s_add_u32 s36, s43, 73728
    buffer_load_dwordx4 v2, s[48:51], s36 offen lds
    v_mfma_f32_32x32x16_bf16 a[112:127], v[108:111], v[36:39], 0
    s_add_u32 m0, s53, 126976
    s_add_u32 s36, s43, 110592
    buffer_load_dwordx4 v2, s[48:51], s36 offen lds
    v_mfma_f32_32x32x16_bf16 a[128:143], v[32:35], v[112:115], 0
    s_add_u32 m0, s53, 81920
    s_add_u32 s36, s44, 0
    buffer_load_dwordx4 v3, s[16:19], s36 offen lds
    v_mfma_f32_32x32x16_bf16 a[160:175], v[36:39], v[112:115], 0
    s_add_u32 m0, s53, 86016
    s_add_u32 s36, s44, 131072
    buffer_load_dwordx4 v3, s[16:19], s36 offen lds
    v_mfma_f32_32x32x16_bf16 a[144:159], v[32:35], v[116:119], 0
    s_add_u32 m0, s53, 90112
    s_add_u32 s36, s44, 262144
    buffer_load_dwordx4 v3, s[16:19], s36 offen lds
    v_mfma_f32_32x32x16_bf16 a[176:191], v[36:39], v[116:119], 0
    s_add_u32 m0, s53, 94208
    s_add_u32 s36, s44, 393216
    buffer_load_dwordx4 v3, s[16:19], s36 offen lds
    ds_read_b128 v[32:35], v146 offset:0
    ds_read_b128 v[36:39], v146 offset:4096
    ds_read_b64_tr_b16 v[104:105], v4 offset:24576
    ds_read_b64_tr_b16 v[106:107], v4 offset:25600
    ds_read_b64_tr_b16 v[108:109], v5 offset:24576
    ds_read_b64_tr_b16 v[110:111], v5 offset:25600
    ds_read_b64_tr_b16 v[112:113], v4 offset:40960
    ds_read_b64_tr_b16 v[114:115], v4 offset:41984
    ds_read_b64_tr_b16 v[116:117], v5 offset:40960
    ds_read_b64_tr_b16 v[118:119], v5 offset:41984
    s_waitcnt lgkmcnt(10)
    v_mfma_f32_32x32x16_bf16 a[64:79], v[128:131], v[40:43], a[64:79]
    s_add_u32 m0, s53, 98304
    s_add_u32 s36, s44, 0
    buffer_load_dwordx4 v3, s[20:23], s36 offen lds
    v_mfma_f32_32x32x16_bf16 a[96:111], v[128:131], v[44:47], a[96:111]
    s_add_u32 m0, s53, 102400
    s_add_u32 s36, s44, 131072
    buffer_load_dwordx4 v3, s[20:23], s36 offen lds
    v_mfma_f32_32x32x16_bf16 a[80:95], v[132:135], v[40:43], a[80:95]
    s_add_u32 m0, s53, 106496
    s_add_u32 s36, s44, 262144
    buffer_load_dwordx4 v3, s[20:23], s36 offen lds
    v_mfma_f32_32x32x16_bf16 a[112:127], v[132:135], v[44:47], a[112:127]
    s_add_u32 m0, s53, 110592
    s_add_u32 s36, s44, 393216
    buffer_load_dwordx4 v3, s[20:23], s36 offen lds
    v_mfma_f32_32x32x16_bf16 a[128:143], v[40:43], v[136:139], a[128:143]
    v_mfma_f32_32x32x16_bf16 a[160:175], v[44:47], v[136:139], a[160:175]
    v_mfma_f32_32x32x16_bf16 a[144:159], v[40:43], v[140:143], a[144:159]
    v_mfma_f32_32x32x16_bf16 a[176:191], v[44:47], v[140:143], a[176:191]
    ds_read_b128 v[40:43], v147 offset:0
    ds_read_b128 v[44:47], v147 offset:4096
    ds_read_b64_tr_b16 v[128:129], v4 offset:28672
    ds_read_b64_tr_b16 v[130:131], v4 offset:29696
    ds_read_b64_tr_b16 v[132:133], v5 offset:28672
    ds_read_b64_tr_b16 v[134:135], v5 offset:29696
    ds_read_b64_tr_b16 v[136:137], v4 offset:45056
    ds_read_b64_tr_b16 v[138:139], v4 offset:46080
    ds_read_b64_tr_b16 v[140:141], v5 offset:45056
    ds_read_b64_tr_b16 v[142:143], v5 offset:46080
    s_waitcnt lgkmcnt(10)
    v_mfma_f32_32x32x16_bf16 a[64:79], v[104:107], v[32:35], a[64:79]
    v_mfma_f32_32x32x16_bf16 a[96:111], v[104:107], v[36:39], a[96:111]
    v_mfma_f32_32x32x16_bf16 a[80:95], v[108:111], v[32:35], a[80:95]
    v_mfma_f32_32x32x16_bf16 a[112:127], v[108:111], v[36:39], a[112:127]
    v_mfma_f32_32x32x16_bf16 a[128:143], v[32:35], v[112:115], a[128:143]
    v_mfma_f32_32x32x16_bf16 a[160:175], v[36:39], v[112:115], a[160:175]
    v_mfma_f32_32x32x16_bf16 a[144:159], v[32:35], v[116:119], a[144:159]
    v_mfma_f32_32x32x16_bf16 a[176:191], v[36:39], v[116:119], a[176:191]
    s_waitcnt lgkmcnt(0)
    v_mfma_f32_32x32x16_bf16 a[64:79], v[128:131], v[40:43], a[64:79]
    v_mfma_f32_32x32x16_bf16 a[96:111], v[128:131], v[44:47], a[96:111]
    v_mfma_f32_32x32x16_bf16 a[80:95], v[132:135], v[40:43], a[80:95]
    v_mfma_f32_32x32x16_bf16 a[112:127], v[132:135], v[44:47], a[112:127]
    v_mfma_f32_32x32x16_bf16 a[128:143], v[40:43], v[136:139], a[128:143]
    v_mfma_f32_32x32x16_bf16 a[160:175], v[44:47], v[136:139], a[160:175]
    v_mfma_f32_32x32x16_bf16 a[144:159], v[40:43], v[140:143], a[144:159]
    v_mfma_f32_32x32x16_bf16 a[176:191], v[44:47], v[140:143], a[176:191]
    s_mov_b32 s45, 0
QKV_LOOP_KV:
    s_waitcnt vmcnt(0)
    s_barrier
    ds_read_b128 v[32:35], v148 offset:0
    ds_read_b128 v[36:39], v148 offset:4096
    ds_read_b64_tr_b16 v[104:105], v6 offset:16384
    ds_read_b64_tr_b16 v[106:107], v6 offset:17408
    ds_read_b64_tr_b16 v[108:109], v7 offset:16384
    ds_read_b64_tr_b16 v[110:111], v7 offset:17408
    ds_read_b64_tr_b16 v[112:113], v6 offset:32768
    ds_read_b64_tr_b16 v[114:115], v6 offset:33792
    ds_read_b64_tr_b16 v[116:117], v7 offset:32768
    ds_read_b64_tr_b16 v[118:119], v7 offset:33792
    s_lshl_b32 s43, s52, 7
    s_add_u32 s43, s43, s46
    s_lshl_b32 s44, s52, 19
    s_add_u32 s44, s44, s47
    s_add_u32 s52, s52, 1
    s_cmp_eq_u32 s52, 9
    s_cselect_b32 s52, 0, s52
    ds_read_b128 v[40:43], v149 offset:0
    ds_read_b128 v[44:47], v149 offset:4096
    ds_read_b64_tr_b16 v[128:129], v6 offset:20480
    ds_read_b64_tr_b16 v[130:131], v6 offset:21504
    ds_read_b64_tr_b16 v[132:133], v7 offset:20480
    ds_read_b64_tr_b16 v[134:135], v7 offset:21504
    ds_read_b64_tr_b16 v[136:137], v6 offset:36864
    ds_read_b64_tr_b16 v[138:139], v6 offset:37888
    ds_read_b64_tr_b16 v[140:141], v7 offset:36864
    ds_read_b64_tr_b16 v[142:143], v7 offset:37888
    s_waitcnt lgkmcnt(10)
    v_mfma_f32_32x32x16_bf16 a[64:79], v[104:107], v[32:35], a[64:79]
    s_add_u32 m0, s53, 49152
    s_add_u32 s36, s43, 0
    buffer_load_dwordx4 v2, s[48:51], s36 offen lds
    v_mfma_f32_32x32x16_bf16 a[96:111], v[104:107], v[36:39], a[96:111]
    s_add_u32 m0, s53, 53248
    s_add_u32 s36, s43, 36864
    buffer_load_dwordx4 v2, s[48:51], s36 offen lds
    v_mfma_f32_32x32x16_bf16 a[80:95], v[108:111], v[32:35], a[80:95]
    s_add_u32 m0, s53, 57344
    s_add_u32 s36, s43, 73728
    buffer_load_dwordx4 v2, s[48:51], s36 offen lds
    v_mfma_f32_32x32x16_bf16 a[112:127], v[108:111], v[36:39], a[112:127]
    s_add_u32 m0, s53, 61440
    s_add_u32 s36, s43, 110592
    buffer_load_dwordx4 v2, s[48:51], s36 offen lds
    v_mfma_f32_32x32x16_bf16 a[128:143], v[32:35], v[112:115], a[128:143]
    s_add_u32 m0, s53, 16384
    s_add_u32 s36, s44, 0
    buffer_load_dwordx4 v3, s[16:19], s36 offen lds
    v_mfma_f32_32x32x16_bf16 a[160:175], v[36:39], v[112:115], a[160:175]
    s_add_u32 m0, s53, 20480
    s_add_u32 s36, s44, 131072
    buffer_load_dwordx4 v3, s[16:19], s36 offen lds
    v_mfma_f32_32x32x16_bf16 a[144:159], v[32:35], v[116:119], a[144:159]
    s_add_u32 m0, s53, 24576
    s_add_u32 s36, s44, 262144
    buffer_load_dwordx4 v3, s[16:19], s36 offen lds
    v_mfma_f32_32x32x16_bf16 a[176:191], v[36:39], v[116:119], a[176:191]
    s_add_u32 m0, s53, 28672
    s_add_u32 s36, s44, 393216
    buffer_load_dwordx4 v3, s[16:19], s36 offen lds
    ds_read_b128 v[32:35], v150 offset:0
    ds_read_b128 v[36:39], v150 offset:4096
    ds_read_b64_tr_b16 v[104:105], v6 offset:24576
    ds_read_b64_tr_b16 v[106:107], v6 offset:25600
    ds_read_b64_tr_b16 v[108:109], v7 offset:24576
    ds_read_b64_tr_b16 v[110:111], v7 offset:25600
    ds_read_b64_tr_b16 v[112:113], v6 offset:40960
    ds_read_b64_tr_b16 v[114:115], v6 offset:41984
    ds_read_b64_tr_b16 v[116:117], v7 offset:40960
    ds_read_b64_tr_b16 v[118:119], v7 offset:41984
    s_waitcnt lgkmcnt(10)
    v_mfma_f32_32x32x16_bf16 a[64:79], v[128:131], v[40:43], a[64:79]
    s_add_u32 m0, s53, 32768
    s_add_u32 s36, s44, 0
    buffer_load_dwordx4 v3, s[20:23], s36 offen lds
    v_mfma_f32_32x32x16_bf16 a[96:111], v[128:131], v[44:47], a[96:111]
    s_add_u32 m0, s53, 36864
    s_add_u32 s36, s44, 131072
    buffer_load_dwordx4 v3, s[20:23], s36 offen lds
    v_mfma_f32_32x32x16_bf16 a[80:95], v[132:135], v[40:43], a[80:95]
    s_add_u32 m0, s53, 40960
    s_add_u32 s36, s44, 262144
    buffer_load_dwordx4 v3, s[20:23], s36 offen lds
    v_mfma_f32_32x32x16_bf16 a[112:127], v[132:135], v[44:47], a[112:127]
    s_add_u32 m0, s53, 45056
    s_add_u32 s36, s44, 393216
    buffer_load_dwordx4 v3, s[20:23], s36 offen lds
    v_mfma_f32_32x32x16_bf16 a[128:143], v[40:43], v[136:139], a[128:143]
    v_mfma_f32_32x32x16_bf16 a[160:175], v[44:47], v[136:139], a[160:175]
    v_mfma_f32_32x32x16_bf16 a[144:159], v[40:43], v[140:143], a[144:159]
    v_mfma_f32_32x32x16_bf16 a[176:191], v[44:47], v[140:143], a[176:191]
    ds_read_b128 v[40:43], v151 offset:0
    ds_read_b128 v[44:47], v151 offset:4096
    ds_read_b64_tr_b16 v[128:129], v6 offset:28672
    ds_read_b64_tr_b16 v[130:131], v6 offset:29696
    ds_read_b64_tr_b16 v[132:133], v7 offset:28672
    ds_read_b64_tr_b16 v[134:135], v7 offset:29696
    ds_read_b64_tr_b16 v[136:137], v6 offset:45056
    ds_read_b64_tr_b16 v[138:139], v6 offset:46080
    ds_read_b64_tr_b16 v[140:141], v7 offset:45056
    ds_read_b64_tr_b16 v[142:143], v7 offset:46080
    s_waitcnt lgkmcnt(10)
    v_mfma_f32_32x32x16_bf16 a[64:79], v[104:107], v[32:35], a[64:79]
    v_mfma_f32_32x32x16_bf16 a[96:111], v[104:107], v[36:39], a[96:111]
    v_mfma_f32_32x32x16_bf16 a[80:95], v[108:111], v[32:35], a[80:95]
    v_mfma_f32_32x32x16_bf16 a[112:127], v[108:111], v[36:39], a[112:127]
    v_mfma_f32_32x32x16_bf16 a[128:143], v[32:35], v[112:115], a[128:143]
    v_mfma_f32_32x32x16_bf16 a[160:175], v[36:39], v[112:115], a[160:175]
    v_mfma_f32_32x32x16_bf16 a[144:159], v[32:35], v[116:119], a[144:159]
    v_mfma_f32_32x32x16_bf16 a[176:191], v[36:39], v[116:119], a[176:191]
    s_waitcnt lgkmcnt(0)
    v_mfma_f32_32x32x16_bf16 a[64:79], v[128:131], v[40:43], a[64:79]
    v_mfma_f32_32x32x16_bf16 a[96:111], v[128:131], v[44:47], a[96:111]
    v_mfma_f32_32x32x16_bf16 a[80:95], v[132:135], v[40:43], a[80:95]
    v_mfma_f32_32x32x16_bf16 a[112:127], v[132:135], v[44:47], a[112:127]
    v_mfma_f32_32x32x16_bf16 a[128:143], v[40:43], v[136:139], a[128:143]
    v_mfma_f32_32x32x16_bf16 a[160:175], v[44:47], v[136:139], a[160:175]
    v_mfma_f32_32x32x16_bf16 a[144:159], v[40:43], v[140:143], a[144:159]
    v_mfma_f32_32x32x16_bf16 a[176:191], v[44:47], v[140:143], a[176:191]
    s_waitcnt vmcnt(0)
    s_barrier
    s_cmp_eq_u32 s45, 3
    s_cbranch_scc1 QKV_LASTC_KV
    ds_read_b128 v[32:35], v144 offset:0
    ds_read_b128 v[36:39], v144 offset:4096
    ds_read_b64_tr_b16 v[104:105], v4 offset:16384
    ds_read_b64_tr_b16 v[106:107], v4 offset:17408
    ds_read_b64_tr_b16 v[108:109], v5 offset:16384
    ds_read_b64_tr_b16 v[110:111], v5 offset:17408
    ds_read_b64_tr_b16 v[112:113], v4 offset:32768
    ds_read_b64_tr_b16 v[114:115], v4 offset:33792
    ds_read_b64_tr_b16 v[116:117], v5 offset:32768
    ds_read_b64_tr_b16 v[118:119], v5 offset:33792
    s_lshl_b32 s43, s52, 7
    s_add_u32 s43, s43, s46
    s_lshl_b32 s44, s52, 19
    s_add_u32 s44, s44, s47
    s_add_u32 s52, s52, 1
    s_cmp_eq_u32 s52, 9
    s_cselect_b32 s52, 0, s52
    ds_read_b128 v[40:43], v145 offset:0
    ds_read_b128 v[44:47], v145 offset:4096
    ds_read_b64_tr_b16 v[128:129], v4 offset:20480
    ds_read_b64_tr_b16 v[130:131], v4 offset:21504
    ds_read_b64_tr_b16 v[132:133], v5 offset:20480
    ds_read_b64_tr_b16 v[134:135], v5 offset:21504
    ds_read_b64_tr_b16 v[136:137], v4 offset:36864
    ds_read_b64_tr_b16 v[138:139], v4 offset:37888
    ds_read_b64_tr_b16 v[140:141], v5 offset:36864
    ds_read_b64_tr_b16 v[142:143], v5 offset:37888
    s_waitcnt lgkmcnt(10)
    v_mfma_f32_32x32x16_bf16 a[64:79], v[104:107], v[32:35], a[64:79]
    s_add_u32 m0, s53, 114688
    s_add_u32 s36, s43, 0
    buffer_load_dwordx4 v2, s[48:51], s36 offen lds
    v_mfma_f32_32x32x16_bf16 a[96:111], v[104:107], v[36:39], a[96:111]
    s_add_u32 m0, s53, 118784
    s_add_u32 s36, s43, 36864
    buffer_load_dwordx4 v2, s[48:51], s36 offen lds
    v_mfma_f32_32x32x16_bf16 a[80:95], v[108:111], v[32:35], a[80:95]
    s_add_u32 m0, s53, 122880
    s_add_u32 s36, s43, 73728
    buffer_load_dwordx4 v2, s[48:51], s36 offen lds
    v_mfma_f32_32x32x16_bf16 a[112:127], v[108:111], v[36:39], a[112:127]
    s_add_u32 m0, s53, 126976
    s_add_u32 s36, s43, 110592
    buffer_load_dwordx4 v2, s[48:51], s36 offen lds
    v_mfma_f32_32x32x16_bf16 a[128:143], v[32:35], v[112:115], a[128:143]
    s_add_u32 m0, s53, 81920
    s_add_u32 s36, s44, 0
    buffer_load_dwordx4 v3, s[16:19], s36 offen lds
    v_mfma_f32_32x32x16_bf16 a[160:175], v[36:39], v[112:115], a[160:175]
    s_add_u32 m0, s53, 86016
    s_add_u32 s36, s44, 131072
    buffer_load_dwordx4 v3, s[16:19], s36 offen lds
    v_mfma_f32_32x32x16_bf16 a[144:159], v[32:35], v[116:119], a[144:159]
    s_add_u32 m0, s53, 90112
    s_add_u32 s36, s44, 262144
    buffer_load_dwordx4 v3, s[16:19], s36 offen lds
    v_mfma_f32_32x32x16_bf16 a[176:191], v[36:39], v[116:119], a[176:191]
    s_add_u32 m0, s53, 94208
    s_add_u32 s36, s44, 393216
    buffer_load_dwordx4 v3, s[16:19], s36 offen lds
    ds_read_b128 v[32:35], v146 offset:0
    ds_read_b128 v[36:39], v146 offset:4096
    ds_read_b64_tr_b16 v[104:105], v4 offset:24576
    ds_read_b64_tr_b16 v[106:107], v4 offset:25600
    ds_read_b64_tr_b16 v[108:109], v5 offset:24576
    ds_read_b64_tr_b16 v[110:111], v5 offset:25600
    ds_read_b64_tr_b16 v[112:113], v4 offset:40960
    ds_read_b64_tr_b16 v[114:115], v4 offset:41984
    ds_read_b64_tr_b16 v[116:117], v5 offset:40960
    ds_read_b64_tr_b16 v[118:119], v5 offset:41984
    s_waitcnt lgkmcnt(10)
    v_mfma_f32_32x32x16_bf16 a[64:79], v[128:131], v[40:43], a[64:79]
    s_add_u32 m0, s53, 98304
    s_add_u32 s36, s44, 0
    buffer_load_dwordx4 v3, s[20:23], s36 offen lds
    v_mfma_f32_32x32x16_bf16 a[96:111], v[128:131], v[44:47], a[96:111]
    s_add_u32 m0, s53, 102400
    s_add_u32 s36, s44, 131072
    buffer_load_dwordx4 v3, s[20:23], s36 offen lds
    v_mfma_f32_32x32x16_bf16 a[80:95], v[132:135], v[40:43], a[80:95]
    s_add_u32 m0, s53, 106496
    s_add_u32 s36, s44, 262144
    buffer_load_dwordx4 v3, s[20:23], s36 offen lds
    v_mfma_f32_32x32x16_bf16 a[112:127], v[132:135], v[44:47], a[112:127]
    s_add_u32 m0, s53, 110592
    s_add_u32 s36, s44, 393216
    buffer_load_dwordx4 v3, s[20:23], s36 offen lds
    v_mfma_f32_32x32x16_bf16 a[128:143], v[40:43], v[136:139], a[128:143]
    v_mfma_f32_32x32x16_bf16 a[160:175], v[44:47], v[136:139], a[160:175]
    v_mfma_f32_32x32x16_bf16 a[144:159], v[40:43], v[140:143], a[144:159]
    v_mfma_f32_32x32x16_bf16 a[176:191], v[44:47], v[140:143], a[176:191]
    ds_read_b128 v[40:43], v147 offset:0
    ds_read_b128 v[44:47], v147 offset:4096
    ds_read_b64_tr_b16 v[128:129], v4 offset:28672
    ds_read_b64_tr_b16 v[130:131], v4 offset:29696
    ds_read_b64_tr_b16 v[132:133], v5 offset:28672
    ds_read_b64_tr_b16 v[134:135], v5 offset:29696
    ds_read_b64_tr_b16 v[136:137], v4 offset:45056
    ds_read_b64_tr_b16 v[138:139], v4 offset:46080
    ds_read_b64_tr_b16 v[140:141], v5 offset:45056
    ds_read_b64_tr_b16 v[142:143], v5 offset:46080
    s_waitcnt lgkmcnt(10)
    v_mfma_f32_32x32x16_bf16 a[64:79], v[104:107], v[32:35], a[64:79]
    v_mfma_f32_32x32x16_bf16 a[96:111], v[104:107], v[36:39], a[96:111]
    v_mfma_f32_32x32x16_bf16 a[80:95], v[108:111], v[32:35], a[80:95]
    v_mfma_f32_32x32x16_bf16 a[112:127], v[108:111], v[36:39], a[112:127]
    v_mfma_f32_32x32x16_bf16 a[128:143], v[32:35], v[112:115], a[128:143]
    v_mfma_f32_32x32x16_bf16 a[160:175], v[36:39], v[112:115], a[160:175]
    v_mfma_f32_32x32x16_bf16 a[144:159], v[32:35], v[116:119], a[144:159]
    v_mfma_f32_32x32x16_bf16 a[176:191], v[36:39], v[116:119], a[176:191]
    s_waitcnt lgkmcnt(0)
    v_mfma_f32_32x32x16_bf16 a[64:79], v[128:131], v[40:43], a[64:79]
    v_mfma_f32_32x32x16_bf16 a[96:111], v[128:131], v[44:47], a[96:111]
    v_mfma_f32_32x32x16_bf16 a[80:95], v[132:135], v[40:43], a[80:95]
    v_mfma_f32_32x32x16_bf16 a[112:127], v[132:135], v[44:47], a[112:127]
    v_mfma_f32_32x32x16_bf16 a[128:143], v[40:43], v[136:139], a[128:143]
    v_mfma_f32_32x32x16_bf16 a[160:175], v[44:47], v[136:139], a[160:175]
    v_mfma_f32_32x32x16_bf16 a[144:159], v[40:43], v[140:143], a[144:159]
    v_mfma_f32_32x32x16_bf16 a[176:191], v[44:47], v[140:143], a[176:191]
    s_add_u32 s45, s45, 1
    s_branch QKV_LOOP_KV
QKV_LASTC_KV:
    ds_read_b128 v[32:35], v144 offset:0
    ds_read_b128 v[36:39], v144 offset:4096
    ds_read_b64_tr_b16 v[104:105], v4 offset:16384
    ds_read_b64_tr_b16 v[106:107], v4 offset:17408
    ds_read_b64_tr_b16 v[108:109], v5 offset:16384
    ds_read_b64_tr_b16 v[110:111], v5 offset:17408
    ds_read_b64_tr_b16 v[112:113], v4 offset:32768
    ds_read_b64_tr_b16 v[114:115], v4 offset:33792
    ds_read_b64_tr_b16 v[116:117], v5 offset:32768
    ds_read_b64_tr_b16 v[118:119], v5 offset:33792
    ds_read_b128 v[40:43], v145 offset:0
    ds_read_b128 v[44:47], v145 offset:4096
    ds_read_b64_tr_b16 v[128:129], v4 offset:20480
    ds_read_b64_tr_b16 v[130:131], v4 offset:21504
    ds_read_b64_tr_b16 v[132:133], v5 offset:20480
    ds_read_b64_tr_b16 v[134:135], v5 offset:21504
    ds_read_b64_tr_b16 v[136:137], v4 offset:36864
    ds_read_b64_tr_b16 v[138:139], v4 offset:37888
    ds_read_b64_tr_b16 v[140:141], v5 offset:36864
    ds_read_b64_tr_b16 v[142:143], v5 offset:37888
    s_waitcnt lgkmcnt(10)
    v_mfma_f32_32x32x16_bf16 a[64:79], v[104:107], v[32:35], a[64:79]
    v_mfma_f32_32x32x16_bf16 a[96:111], v[104:107], v[36:39], a[96:111]
    v_mfma_f32_32x32x16_bf16 a[80:95], v[108:111], v[32:35], a[80:95]
    v_mfma_f32_32x32x16_bf16 a[112:127], v[108:111], v[36:39], a[112:127]
    v_mfma_f32_32x32x16_bf16 a[128:143], v[32:35], v[112:115], a[128:143]
    v_mfma_f32_32x32x16_bf16 a[160:175], v[36:39], v[112:115], a[160:175]
    v_mfma_f32_32x32x16_bf16 a[144:159], v[32:35], v[116:119], a[144:159]
    v_mfma_f32_32x32x16_bf16 a[176:191], v[36:39], v[116:119], a[176:191]
    ds_read_b128 v[32:35], v146 offset:0
    ds_read_b128 v[36:39], v146 offset:4096
    ds_read_b64_tr_b16 v[104:105], v4 offset:24576
    ds_read_b64_tr_b16 v[106:107], v4 offset:25600
    ds_read_b64_tr_b16 v[108:109], v5 offset:24576
    ds_read_b64_tr_b16 v[110:111], v5 offset:25600
    ds_read_b64_tr_b16 v[112:113], v4 offset:40960
    ds_read_b64_tr_b16 v[114:115], v4 offset:41984
    ds_read_b64_tr_b16 v[116:117], v5 offset:40960
    ds_read_b64_tr_b16 v[118:119], v5 offset:41984
    s_waitcnt lgkmcnt(10)
    v_mfma_f32_32x32x16_bf16 a[64:79], v[128:131], v[40:43], a[64:79]
    v_mfma_f32_32x32x16_bf16 a[96:111], v[128:131], v[44:47], a[96:111]
    v_mfma_f32_32x32x16_bf16 a[80:95], v[132:135], v[40:43], a[80:95]
    v_mfma_f32_32x32x16_bf16 a[112:127], v[132:135], v[44:47], a[112:127]
    v_mfma_f32_32x32x16_bf16 a[128:143], v[40:43], v[136:139], a[128:143]
    v_mfma_f32_32x32x16_bf16 a[160:175], v[44:47], v[136:139], a[160:175]
    v_mfma_f32_32x32x16_bf16 a[144:159], v[40:43], v[140:143], a[144:159]
    v_mfma_f32_32x32x16_bf16 a[176:191], v[44:47], v[140:143], a[176:191]
    ds_read_b128 v[40:43], v147 offset:0
    ds_read_b128 v[44:47], v147 offset:4096
    ds_read_b64_tr_b16 v[128:129], v4 offset:28672
    ds_read_b64_tr_b16 v[130:131], v4 offset:29696
    ds_read_b64_tr_b16 v[132:133], v5 offset:28672
    ds_read_b64_tr_b16 v[134:135], v5 offset:29696
    ds_read_b64_tr_b16 v[136:137], v4 offset:45056
    ds_read_b64_tr_b16 v[138:139], v4 offset:46080
    ds_read_b64_tr_b16 v[140:141], v5 offset:45056
    ds_read_b64_tr_b16 v[142:143], v5 offset:46080
    s_waitcnt lgkmcnt(10)
    v_mfma_f32_32x32x16_bf16 a[64:79], v[104:107], v[32:35], a[64:79]
    v_mfma_f32_32x32x16_bf16 a[96:111], v[104:107], v[36:39], a[96:111]
    v_mfma_f32_32x32x16_bf16 a[80:95], v[108:111], v[32:35], a[80:95]
    v_mfma_f32_32x32x16_bf16 a[112:127], v[108:111], v[36:39], a[112:127]
    v_mfma_f32_32x32x16_bf16 a[128:143], v[32:35], v[112:115], a[128:143]
    v_mfma_f32_32x32x16_bf16 a[160:175], v[36:39], v[112:115], a[160:175]
    v_mfma_f32_32x32x16_bf16 a[144:159], v[32:35], v[116:119], a[144:159]
    v_mfma_f32_32x32x16_bf16 a[176:191], v[36:39], v[116:119], a[176:191]
    s_waitcnt lgkmcnt(0)
    v_mfma_f32_32x32x16_bf16 a[64:79], v[128:131], v[40:43], a[64:79]
    v_mfma_f32_32x32x16_bf16 a[96:111], v[128:131], v[44:47], a[96:111]
    v_mfma_f32_32x32x16_bf16 a[80:95], v[132:135], v[40:43], a[80:95]
    v_mfma_f32_32x32x16_bf16 a[112:127], v[132:135], v[44:47], a[112:127]
    v_mfma_f32_32x32x16_bf16 a[128:143], v[40:43], v[136:139], a[128:143]
    v_mfma_f32_32x32x16_bf16 a[160:175], v[44:47], v[136:139], a[160:175]
    v_mfma_f32_32x32x16_bf16 a[144:159], v[40:43], v[140:143], a[144:159]
    v_mfma_f32_32x32x16_bf16 a[176:191], v[44:47], v[140:143], a[176:191]
    s_nop 15
    s_barrier
    v_accvgpr_read_b32 v32, a64
    v_accvgpr_read_b32 v33, a65
    v_accvgpr_read_b32 v34, a66
    v_accvgpr_read_b32 v35, a67
    v_accvgpr_read_b32 v36, a68
    v_accvgpr_read_b32 v37, a69
    v_accvgpr_read_b32 v38, a70
    v_accvgpr_read_b32 v39, a71
    v_accvgpr_read_b32 v40, a72
    v_accvgpr_read_b32 v41, a73
    v_accvgpr_read_b32 v42, a74
    v_accvgpr_read_b32 v43, a75
    v_accvgpr_read_b32 v44, a76
    v_accvgpr_read_b32 v45, a77
    v_accvgpr_read_b32 v46, a78
    v_accvgpr_read_b32 v47, a79
    v_cvt_pk_bf16_f32 v48, v32, v33
    v_cvt_pk_bf16_f32 v49, v34, v35
    v_cvt_pk_bf16_f32 v50, v36, v37
    v_cvt_pk_bf16_f32 v51, v38, v39
    v_cvt_pk_bf16_f32 v52, v40, v41
    v_cvt_pk_bf16_f32 v53, v42, v43
    v_cvt_pk_bf16_f32 v54, v44, v45
    v_cvt_pk_bf16_f32 v55, v46, v47
    ds_write_b64 v10, v[48:49] offset:8192
    ds_write_b64 v11, v[50:51] offset:8192
    ds_write_b64 v12, v[52:53] offset:8192
    ds_write_b64 v13, v[54:55] offset:8192
    v_accvgpr_read_b32 v64, a80
    v_accvgpr_read_b32 v65, a81
    v_accvgpr_read_b32 v66, a82
    v_accvgpr_read_b32 v67, a83
    v_accvgpr_read_b32 v68, a84
    v_accvgpr_read_b32 v69, a85
    v_accvgpr_read_b32 v70, a86
    v_accvgpr_read_b32 v71, a87
    v_accvgpr_read_b32 v72, a88
    v_accvgpr_read_b32 v73, a89
    v_accvgpr_read_b32 v74, a90
    v_accvgpr_read_b32 v75, a91
    v_accvgpr_read_b32 v76, a92
    v_accvgpr_read_b32 v77, a93
    v_accvgpr_read_b32 v78, a94
    v_accvgpr_read_b32 v79, a95
    v_cvt_pk_bf16_f32 v80, v64, v65
    v_cvt_pk_bf16_f32 v81, v66, v67
    v_cvt_pk_bf16_f32 v82, v68, v69
    v_cvt_pk_bf16_f32 v83, v70, v71
    v_cvt_pk_bf16_f32 v84, v72, v73
    v_cvt_pk_bf16_f32 v85, v74, v75
    v_cvt_pk_bf16_f32 v86, v76, v77
    v_cvt_pk_bf16_f32 v87, v78, v79
    ds_write_b64 v14, v[80:81] offset:8192
    ds_write_b64 v15, v[82:83] offset:8192
    ds_write_b64 v16, v[84:85] offset:8192
    ds_write_b64 v17, v[86:87] offset:8192
    v_accvgpr_read_b32 v32, a96
    v_accvgpr_read_b32 v33, a97
    v_accvgpr_read_b32 v34, a98
    v_accvgpr_read_b32 v35, a99
    v_accvgpr_read_b32 v36, a100
    v_accvgpr_read_b32 v37, a101
    v_accvgpr_read_b32 v38, a102
    v_accvgpr_read_b32 v39, a103
    v_accvgpr_read_b32 v40, a104
    v_accvgpr_read_b32 v41, a105
    v_accvgpr_read_b32 v42, a106
    v_accvgpr_read_b32 v43, a107
    v_accvgpr_read_b32 v44, a108
    v_accvgpr_read_b32 v45, a109
    v_accvgpr_read_b32 v46, a110
    v_accvgpr_read_b32 v47, a111
    v_cvt_pk_bf16_f32 v48, v32, v33
    v_cvt_pk_bf16_f32 v49, v34, v35
    v_cvt_pk_bf16_f32 v50, v36, v37
    v_cvt_pk_bf16_f32 v51, v38, v39
    v_cvt_pk_bf16_f32 v52, v40, v41
    v_cvt_pk_bf16_f32 v53, v42, v43
    v_cvt_pk_bf16_f32 v54, v44, v45
    v_cvt_pk_bf16_f32 v55, v46, v47
    ds_write_b64 v10, v[48:49] offset:32768
    ds_write_b64 v11, v[50:51] offset:32768
    ds_write_b64 v12, v[52:53] offset:32768
    ds_write_b64 v13, v[54:55] offset:32768
    v_accvgpr_read_b32 v64, a112
    v_accvgpr_read_b32 v65, a113
    v_accvgpr_read_b32 v66, a114
    v_accvgpr_read_b32 v67, a115
    v_accvgpr_read_b32 v68, a116
    v_accvgpr_read_b32 v69, a117
    v_accvgpr_read_b32 v70, a118
    v_accvgpr_read_b32 v71, a119
    v_accvgpr_read_b32 v72, a120
    v_accvgpr_read_b32 v73, a121
    v_accvgpr_read_b32 v74, a122
    v_accvgpr_read_b32 v75, a123
    v_accvgpr_read_b32 v76, a124
    v_accvgpr_read_b32 v77, a125
    v_accvgpr_read_b32 v78, a126
    v_accvgpr_read_b32 v79, a127
    v_cvt_pk_bf16_f32 v80, v64, v65
    v_cvt_pk_bf16_f32 v81, v66, v67
    v_cvt_pk_bf16_f32 v82, v68, v69
    v_cvt_pk_bf16_f32 v83, v70, v71
    v_cvt_pk_bf16_f32 v84, v72, v73
    v_cvt_pk_bf16_f32 v85, v74, v75
    v_cvt_pk_bf16_f32 v86, v76, v77
    v_cvt_pk_bf16_f32 v87, v78, v79
    ds_write_b64 v14, v[80:81] offset:32768
    ds_write_b64 v15, v[82:83] offset:32768
    ds_write_b64 v16, v[84:85] offset:32768
    ds_write_b64 v17, v[86:87] offset:32768
    v_accvgpr_read_b32 v32, a128
    v_accvgpr_read_b32 v33, a129
    v_accvgpr_read_b32 v34, a130
    v_accvgpr_read_b32 v35, a131
    v_accvgpr_read_b32 v36, a132
    v_accvgpr_read_b32 v37, a133
    v_accvgpr_read_b32 v38, a134
    v_accvgpr_read_b32 v39, a135
    v_accvgpr_read_b32 v40, a136
    v_accvgpr_read_b32 v41, a137
    v_accvgpr_read_b32 v42, a138
    v_accvgpr_read_b32 v43, a139
    v_accvgpr_read_b32 v44, a140
    v_accvgpr_read_b32 v45, a141
    v_accvgpr_read_b32 v46, a142
    v_accvgpr_read_b32 v47, a143
    v_cvt_pk_bf16_f32 v48, v32, v33
    v_cvt_pk_bf16_f32 v49, v34, v35
    v_cvt_pk_bf16_f32 v50, v40, v41
    v_cvt_pk_bf16_f32 v51, v42, v43
    v_cvt_pk_bf16_f32 v52, v36, v37
    v_cvt_pk_bf16_f32 v53, v38, v39
    v_cvt_pk_bf16_f32 v54, v44, v45
    v_cvt_pk_bf16_f32 v55, v46, v47
    ds_write_b128 v18, v[48:51] offset:0
    ds_write_b128 v18, v[52:55] offset:32
    v_accvgpr_read_b32 v64, a144
    v_accvgpr_read_b32 v65, a145
    v_accvgpr_read_b32 v66, a146
    v_accvgpr_read_b32 v67, a147
    v_accvgpr_read_b32 v68, a148
    v_accvgpr_read_b32 v69, a149
    v_accvgpr_read_b32 v70, a150
    v_accvgpr_read_b32 v71, a151
    v_accvgpr_read_b32 v72, a152
    v_accvgpr_read_b32 v73, a153
    v_accvgpr_read_b32 v74, a154
    v_accvgpr_read_b32 v75, a155
    v_accvgpr_read_b32 v76, a156
    v_accvgpr_read_b32 v77, a157
    v_accvgpr_read_b32 v78, a158
    v_accvgpr_read_b32 v79, a159
    v_cvt_pk_bf16_f32 v80, v64, v65
    v_cvt_pk_bf16_f32 v81, v66, v67
    v_cvt_pk_bf16_f32 v82, v72, v73
    v_cvt_pk_bf16_f32 v83, v74, v75
    v_cvt_pk_bf16_f32 v84, v68, v69
    v_cvt_pk_bf16_f32 v85, v70, v71
    v_cvt_pk_bf16_f32 v86, v76, v77
    v_cvt_pk_bf16_f32 v87, v78, v79
    ds_write_b128 v18, v[80:83] offset:2048
    ds_write_b128 v18, v[84:87] offset:2080
    v_accvgpr_read_b32 v32, a160
    v_accvgpr_read_b32 v33, a161
    v_accvgpr_read_b32 v34, a162
    v_accvgpr_read_b32 v35, a163
    v_accvgpr_read_b32 v36, a164
    v_accvgpr_read_b32 v37, a165
    v_accvgpr_read_b32 v38, a166
    v_accvgpr_read_b32 v39, a167
    v_accvgpr_read_b32 v40, a168
    v_accvgpr_read_b32 v41, a169
    v_accvgpr_read_b32 v42, a170
    v_accvgpr_read_b32 v43, a171
    v_accvgpr_read_b32 v44, a172
    v_accvgpr_read_b32 v45, a173
    v_accvgpr_read_b32 v46, a174
    v_accvgpr_read_b32 v47, a175
    v_cvt_pk_bf16_f32 v48, v32, v33
    v_cvt_pk_bf16_f32 v49, v34, v35
    v_cvt_pk_bf16_f32 v50, v40, v41
    v_cvt_pk_bf16_f32 v51, v42, v43
    v_cvt_pk_bf16_f32 v52, v36, v37
    v_cvt_pk_bf16_f32 v53, v38, v39
    v_cvt_pk_bf16_f32 v54, v44, v45
    v_cvt_pk_bf16_f32 v55, v46, v47
    ds_write_b128 v18, v[48:51] offset:24576
    ds_write_b128 v18, v[52:55] offset:24608
    v_accvgpr_read_b32 v64, a176
    v_accvgpr_read_b32 v65, a177
    v_accvgpr_read_b32 v66, a178
    v_accvgpr_read_b32 v67, a179
    v_accvgpr_read_b32 v68, a180
    v_accvgpr_read_b32 v69, a181
    v_accvgpr_read_b32 v70, a182
    v_accvgpr_read_b32 v71, a183
    v_accvgpr_read_b32 v72, a184
    v_accvgpr_read_b32 v73, a185
    v_accvgpr_read_b32 v74, a186
    v_accvgpr_read_b32 v75, a187
    v_accvgpr_read_b32 v76, a188
    v_accvgpr_read_b32 v77, a189
    v_accvgpr_read_b32 v78, a190
    v_accvgpr_read_b32 v79, a191
    v_cvt_pk_bf16_f32 v80, v64, v65
    v_cvt_pk_bf16_f32 v81, v66, v67
    v_cvt_pk_bf16_f32 v82, v72, v73
    v_cvt_pk_bf16_f32 v83, v74, v75
    v_cvt_pk_bf16_f32 v84, v68, v69
    v_cvt_pk_bf16_f32 v85, v70, v71
    v_cvt_pk_bf16_f32 v86, v76, v77
    v_cvt_pk_bf16_f32 v87, v78, v79
    ds_write_b128 v18, v[80:83] offset:26624
    ds_write_b128 v18, v[84:87] offset:26656
    s_waitcnt lgkmcnt(0)
    s_barrier
    s_lshl_b32 s35, s41, 2
    s_lshl_b32 s36, s42, 6
    s_add_u32 s35, s35, s36
    s_lshl_b32 s35, s35, 13
    v_add_u32 v24, 65536, v19
    ds_read_b128 v[32:35], v19 offset:8192
    ds_read_b128 v[36:39], v19 offset:12288
    ds_read_b128 v[40:43], v19 offset:32768
    ds_read_b128 v[44:47], v19 offset:36864
    ds_read_b128 v[48:51], v19 offset:57344
    ds_read_b128 v[52:55], v19 offset:61440
    ds_read_b128 v[56:59], v24 offset:16384
    ds_read_b128 v[60:63], v24 offset:20480
    ds_read_b128 v[64:67], v19 offset:16384
    ds_read_b128 v[68:71], v19 offset:20480
    ds_read_b128 v[72:75], v19 offset:40960
    ds_read_b128 v[76:79], v19 offset:45056
    ds_read_b128 v[80:83], v24 offset:0
    ds_read_b128 v[84:87], v24 offset:4096
    ds_read_b128 v[88:91], v24 offset:24576
    ds_read_b128 v[92:95], v24 offset:28672
    s_waitcnt lgkmcnt(12)
    s_add_u32 s36, s35, 33554432
    buffer_store_dwordx4 v[32:35], v20, s[4:7], s36 offen sc1
    s_add_u32 s36, s35, 33558528
    buffer_store_dwordx4 v[36:39], v20, s[4:7], s36 offen sc1
    s_add_u32 s36, s35, 33562624
    buffer_store_dwordx4 v[40:43], v20, s[4:7], s36 offen sc1
    s_add_u32 s36, s35, 33566720
    buffer_store_dwordx4 v[44:47], v20, s[4:7], s36 offen sc1
    s_waitcnt lgkmcnt(8)
    s_add_u32 s36, s35, 33570816
    buffer_store_dwordx4 v[48:51], v20, s[4:7], s36 offen sc1
    s_add_u32 s36, s35, 33574912
    buffer_store_dwordx4 v[52:55], v20, s[4:7], s36 offen sc1
    s_add_u32 s36, s35, 33579008
    buffer_store_dwordx4 v[56:59], v20, s[4:7], s36 offen sc1
    s_add_u32 s36, s35, 33583104
    buffer_store_dwordx4 v[60:63], v20, s[4:7], s36 offen sc1
    s_waitcnt lgkmcnt(4)
    s_add_u32 s36, s35, 50331648
    buffer_store_dwordx4 v[64:67], v19, s[4:7], s36 offen sc1
    s_add_u32 s36, s35, 50335744
    buffer_store_dwordx4 v[68:71], v19, s[4:7], s36 offen sc1
    s_add_u32 s36, s35, 50339840
    buffer_store_dwordx4 v[72:75], v19, s[4:7], s36 offen sc1
    s_add_u32 s36, s35, 50343936
    buffer_store_dwordx4 v[76:79], v19, s[4:7], s36 offen sc1
    s_waitcnt lgkmcnt(0)
    s_add_u32 s36, s35, 50348032
    buffer_store_dwordx4 v[80:83], v19, s[4:7], s36 offen sc1
    s_add_u32 s36, s35, 50352128
    buffer_store_dwordx4 v[84:87], v19, s[4:7], s36 offen sc1
    s_add_u32 s36, s35, 50356224
    buffer_store_dwordx4 v[88:91], v19, s[4:7], s36 offen sc1
    s_add_u32 s36, s35, 50360320
    buffer_store_dwordx4 v[92:95], v19, s[4:7], s36 offen sc1
    s_waitcnt vmcnt(0)
    s_barrier
    s_cmp_lg_u32 s32, 0
    s_cbranch_scc1 QKV_NEXT
    s_lshl_b32 s35, 1, s42
    s_lshl_b32 s36, s41, 6
    s_add_u32 s36, s36, 1024
    v_mov_b32 v24, s35
    v_mov_b32 v25, s36
    s_mov_b64 exec, 1
    buffer_atomic_or v24, v25, s[4:7], 0 offen
    s_mov_b64 exec, -1
    s_branch QKV_NEXT
QKV_BODY_Q:
    s_lshl_b32 s43, s52, 7
    s_add_u32 s43, s43, s46
    s_lshl_b32 s44, s52, 19
    s_add_u32 s44, s44, s47
    s_add_u32 s52, s52, 1
    s_cmp_eq_u32 s52, 9
    s_cselect_b32 s52, 0, s52
    s_add_u32 m0, s53, 49152
    s_add_u32 s36, s43, 0
    buffer_load_dwordx4 v2, s[48:51], s36 offen lds
    s_add_u32 m0, s53, 53248
    s_add_u32 s36, s43, 36864
    buffer_load_dwordx4 v2, s[48:51], s36 offen lds
    s_add_u32 m0, s53, 57344
    s_add_u32 s36, s43, 73728
    buffer_load_dwordx4 v2, s[48:51], s36 offen lds
    s_add_u32 m0, s53, 61440
    s_add_u32 s36, s43, 110592
    buffer_load_dwordx4 v2, s[48:51], s36 offen lds
    s_add_u32 m0, s53, 0
    s_add_u32 s36, s44, 0
    buffer_load_dwordx4 v3, s[12:15], s36 offen lds
    s_add_u32 m0, s53, 4096
    s_add_u32 s36, s44, 131072
    buffer_load_dwordx4 v3, s[12:15], s36 offen lds
    s_add_u32 m0, s53, 8192
    s_add_u32 s36, s44, 262144
    buffer_load_dwordx4 v3, s[12:15], s36 offen lds
    s_add_u32 m0, s53, 12288
    s_add_u32 s36, s44, 393216
    buffer_load_dwordx4 v3, s[12:15], s36 offen lds
    s_waitcnt vmcnt(0)
    s_barrier
    ds_read_b128 v[32:35], v144 offset:0
    ds_read_b128 v[36:39], v144 offset:4096
    ds_read_b64_tr_b16 v[96:97], v4 offset:0
    ds_read_b64_tr_b16 v[98:99], v4 offset:1024
    ds_read_b64_tr_b16 v[100:101], v5 offset:0
    ds_read_b64_tr_b16 v[102:103], v5 offset:1024
    s_lshl_b32 s43, s52, 7
    s_add_u32 s43, s43, s46
    s_lshl_b32 s44, s52, 19
    s_add_u32 s44, s44, s47
    s_add_u32 s52, s52, 1
    s_cmp_eq_u32 s52, 9
    s_cselect_b32 s52, 0, s52
    ds_read_b128 v[40:43], v145 offset:0
    ds_read_b128 v[44:47], v145 offset:4096
    ds_read_b64_tr_b16 v[120:121], v4 offset:4096
    ds_read_b64_tr_b16 v[122:123], v4 offset:5120
    ds_read_b64_tr_b16 v[124:125], v5 offset:4096
    ds_read_b64_tr_b16 v[126:127], v5 offset:5120
    s_waitcnt lgkmcnt(6)
    v_mfma_f32_32x32x16_bf16 a[0:15], v[96:99], v[32:35], 0
    s_add_u32 m0, s53, 114688
    s_add_u32 s36, s43, 0
    buffer_load_dwordx4 v2, s[48:51], s36 offen lds
    v_mfma_f32_32x32x16_bf16 a[32:47], v[96:99], v[36:39], 0
    s_add_u32 m0, s53, 118784
    s_add_u32 s36, s43, 36864
    buffer_load_dwordx4 v2, s[48:51], s36 offen lds
    v_mfma_f32_32x32x16_bf16 a[16:31], v[100:103], v[32:35], 0
    s_add_u32 m0, s53, 122880
    s_add_u32 s36, s43, 73728
    buffer_load_dwordx4 v2, s[48:51], s36 offen lds
    v_mfma_f32_32x32x16_bf16 a[48:63], v[100:103], v[36:39], 0
    s_add_u32 m0, s53, 126976
    s_add_u32 s36, s43, 110592
    buffer_load_dwordx4 v2, s[48:51], s36 offen lds
    ds_read_b128 v[32:35], v146 offset:0
    ds_read_b128 v[36:39], v146 offset:4096
    ds_read_b64_tr_b16 v[96:97], v4 offset:8192
    ds_read_b64_tr_b16 v[98:99], v4 offset:9216
    ds_read_b64_tr_b16 v[100:101], v5 offset:8192
    ds_read_b64_tr_b16 v[102:103], v5 offset:9216
    s_waitcnt lgkmcnt(6)
    v_mfma_f32_32x32x16_bf16 a[0:15], v[120:123], v[40:43], a[0:15]
    s_add_u32 m0, s53, 65536
    s_add_u32 s36, s44, 0
    buffer_load_dwordx4 v3, s[12:15], s36 offen lds
    v_mfma_f32_32x32x16_bf16 a[32:47], v[120:123], v[44:47], a[32:47]
    s_add_u32 m0, s53, 69632
    s_add_u32 s36, s44, 131072
    buffer_load_dwordx4 v3, s[12:15], s36 offen lds
    v_mfma_f32_32x32x16_bf16 a[16:31], v[124:127], v[40:43], a[16:31]
    s_add_u32 m0, s53, 73728
    s_add_u32 s36, s44, 262144
    buffer_load_dwordx4 v3, s[12:15], s36 offen lds
    v_mfma_f32_32x32x16_bf16 a[48:63], v[124:127], v[44:47], a[48:63]
    s_add_u32 m0, s53, 77824
    s_add_u32 s36, s44, 393216
    buffer_load_dwordx4 v3, s[12:15], s36 offen lds
    ds_read_b128 v[40:43], v147 offset:0
    ds_read_b128 v[44:47], v147 offset:4096
    ds_read_b64_tr_b16 v[120:121], v4 offset:12288
    ds_read_b64_tr_b16 v[122:123], v4 offset:13312
    ds_read_b64_tr_b16 v[124:125], v5 offset:12288
    ds_read_b64_tr_b16 v[126:127], v5 offset:13312
    s_waitcnt lgkmcnt(6)
    v_mfma_f32_32x32x16_bf16 a[0:15], v[96:99], v[32:35], a[0:15]
    v_mfma_f32_32x32x16_bf16 a[32:47], v[96:99], v[36:39], a[32:47]
    v_mfma_f32_32x32x16_bf16 a[16:31], v[100:103], v[32:35], a[16:31]
    v_mfma_f32_32x32x16_bf16 a[48:63], v[100:103], v[36:39], a[48:63]
    s_waitcnt lgkmcnt(0)
    v_mfma_f32_32x32x16_bf16 a[0:15], v[120:123], v[40:43], a[0:15]
    v_mfma_f32_32x32x16_bf16 a[32:47], v[120:123], v[44:47], a[32:47]
    v_mfma_f32_32x32x16_bf16 a[16:31], v[124:127], v[40:43], a[16:31]
    v_mfma_f32_32x32x16_bf16 a[48:63], v[124:127], v[44:47], a[48:63]
    s_mov_b32 s45, 0
QKV_LOOP_Q:
    s_waitcnt vmcnt(0)
    s_barrier
    ds_read_b128 v[32:35], v148 offset:0
    ds_read_b128 v[36:39], v148 offset:4096
    ds_read_b64_tr_b16 v[96:97], v6 offset:0
    ds_read_b64_tr_b16 v[98:99], v6 offset:1024
    ds_read_b64_tr_b16 v[100:101], v7 offset:0
    ds_read_b64_tr_b16 v[102:103], v7 offset:1024
    s_lshl_b32 s43, s52, 7
    s_add_u32 s43, s43, s46
    s_lshl_b32 s44, s52, 19
    s_add_u32 s44, s44, s47
    s_add_u32 s52, s52, 1
    s_cmp_eq_u32 s52, 9
    s_cselect_b32 s52, 0, s52
    ds_read_b128 v[40:43], v149 offset:0
    ds_read_b128 v[44:47], v149 offset:4096
    ds_read_b64_tr_b16 v[120:121], v6 offset:4096
    ds_read_b64_tr_b16 v[122:123], v6 offset:5120
    ds_read_b64_tr_b16 v[124:125], v7 offset:4096
    ds_read_b64_tr_b16 v[126:127], v7 offset:5120
    s_waitcnt lgkmcnt(6)
    v_mfma_f32_32x32x16_bf16 a[0:15], v[96:99], v[32:35], a[0:15]
    s_add_u32 m0, s53, 49152
    s_add_u32 s36, s43, 0
    buffer_load_dwordx4 v2, s[48:51], s36 offen lds
    v_mfma_f32_32x32x16_bf16 a[32:47], v[96:99], v[36:39], a[32:47]
    s_add_u32 m0, s53, 53248
    s_add_u32 s36, s43, 36864
    buffer_load_dwordx4 v2, s[48:51], s36 offen lds
    v_mfma_f32_32x32x16_bf16 a[16:31], v[100:103], v[32:35], a[16:31]
    s_add_u32 m0, s53, 57344
    s_add_u32 s36, s43, 73728
    buffer_load_dwordx4 v2, s[48:51], s36 offen lds
    v_mfma_f32_32x32x16_bf16 a[48:63], v[100:103], v[36:39], a[48:63]
    s_add_u32 m0, s53, 61440
    s_add_u32 s36, s43, 110592
    buffer_load_dwordx4 v2, s[48:51], s36 offen lds
    ds_read_b128 v[32:35], v150 offset:0
    ds_read_b128 v[36:39], v150 offset:4096
    ds_read_b64_tr_b16 v[96:97], v6 offset:8192
    ds_read_b64_tr_b16 v[98:99], v6 offset:9216
    ds_read_b64_tr_b16 v[100:101], v7 offset:8192
    ds_read_b64_tr_b16 v[102:103], v7 offset:9216
    s_waitcnt lgkmcnt(6)
    v_mfma_f32_32x32x16_bf16 a[0:15], v[120:123], v[40:43], a[0:15]
    s_add_u32 m0, s53, 0
    s_add_u32 s36, s44, 0
    buffer_load_dwordx4 v3, s[12:15], s36 offen lds
    v_mfma_f32_32x32x16_bf16 a[32:47], v[120:123], v[44:47], a[32:47]
    s_add_u32 m0, s53, 4096
    s_add_u32 s36, s44, 131072
    buffer_load_dwordx4 v3, s[12:15], s36 offen lds
    v_mfma_f32_32x32x16_bf16 a[16:31], v[124:127], v[40:43], a[16:31]
    s_add_u32 m0, s53, 8192
    s_add_u32 s36, s44, 262144
    buffer_load_dwordx4 v3, s[12:15], s36 offen lds
    v_mfma_f32_32x32x16_bf16 a[48:63], v[124:127], v[44:47], a[48:63]
    s_add_u32 m0, s53, 12288
    s_add_u32 s36, s44, 393216
    buffer_load_dwordx4 v3, s[12:15], s36 offen lds
    ds_read_b128 v[40:43], v151 offset:0
    ds_read_b128 v[44:47], v151 offset:4096
    ds_read_b64_tr_b16 v[120:121], v6 offset:12288
    ds_read_b64_tr_b16 v[122:123], v6 offset:13312
    ds_read_b64_tr_b16 v[124:125], v7 offset:12288
    ds_read_b64_tr_b16 v[126:127], v7 offset:13312
    s_waitcnt lgkmcnt(6)
    v_mfma_f32_32x32x16_bf16 a[0:15], v[96:99], v[32:35], a[0:15]
    v_mfma_f32_32x32x16_bf16 a[32:47], v[96:99], v[36:39], a[32:47]
    v_mfma_f32_32x32x16_bf16 a[16:31], v[100:103], v[32:35], a[16:31]
    v_mfma_f32_32x32x16_bf16 a[48:63], v[100:103], v[36:39], a[48:63]
    s_waitcnt lgkmcnt(0)
    v_mfma_f32_32x32x16_bf16 a[0:15], v[120:123], v[40:43], a[0:15]
    v_mfma_f32_32x32x16_bf16 a[32:47], v[120:123], v[44:47], a[32:47]
    v_mfma_f32_32x32x16_bf16 a[16:31], v[124:127], v[40:43], a[16:31]
    v_mfma_f32_32x32x16_bf16 a[48:63], v[124:127], v[44:47], a[48:63]
    s_waitcnt vmcnt(0)
    s_barrier
    s_cmp_eq_u32 s45, 3
    s_cbranch_scc1 QKV_LASTC_Q
    ds_read_b128 v[32:35], v144 offset:0
    ds_read_b128 v[36:39], v144 offset:4096
    ds_read_b64_tr_b16 v[96:97], v4 offset:0
    ds_read_b64_tr_b16 v[98:99], v4 offset:1024
    ds_read_b64_tr_b16 v[100:101], v5 offset:0
    ds_read_b64_tr_b16 v[102:103], v5 offset:1024
    s_lshl_b32 s43, s52, 7
    s_add_u32 s43, s43, s46
    s_lshl_b32 s44, s52, 19
    s_add_u32 s44, s44, s47
    s_add_u32 s52, s52, 1
    s_cmp_eq_u32 s52, 9
    s_cselect_b32 s52, 0, s52
    ds_read_b128 v[40:43], v145 offset:0
    ds_read_b128 v[44:47], v145 offset:4096
    ds_read_b64_tr_b16 v[120:121], v4 offset:4096
    ds_read_b64_tr_b16 v[122:123], v4 offset:5120
    ds_read_b64_tr_b16 v[124:125], v5 offset:4096
    ds_read_b64_tr_b16 v[126:127], v5 offset:5120
    s_waitcnt lgkmcnt(6)
    v_mfma_f32_32x32x16_bf16 a[0:15], v[96:99], v[32:35], a[0:15]
    s_add_u32 m0, s53, 114688
    s_add_u32 s36, s43, 0
    buffer_load_dwordx4 v2, s[48:51], s36 offen lds
    v_mfma_f32_32x32x16_bf16 a[32:47], v[96:99], v[36:39], a[32:47]
    s_add_u32 m0, s53, 118784
    s_add_u32 s36, s43, 36864
    buffer_load_dwordx4 v2, s[48:51], s36 offen lds
    v_mfma_f32_32x32x16_bf16 a[16:31], v[100:103], v[32:35], a[16:31]
    s_add_u32 m0, s53, 122880
    s_add_u32 s36, s43, 73728
    buffer_load_dwordx4 v2, s[48:51], s36 offen lds
    v_mfma_f32_32x32x16_bf16 a[48:63], v[100:103], v[36:39], a[48:63]
    s_add_u32 m0, s53, 126976
    s_add_u32 s36, s43, 110592
    buffer_load_dwordx4 v2, s[48:51], s36 offen lds
    ds_read_b128 v[32:35], v146 offset:0
    ds_read_b128 v[36:39], v146 offset:4096
    ds_read_b64_tr_b16 v[96:97], v4 offset:8192
    ds_read_b64_tr_b16 v[98:99], v4 offset:9216
    ds_read_b64_tr_b16 v[100:101], v5 offset:8192
    ds_read_b64_tr_b16 v[102:103], v5 offset:9216
    s_waitcnt lgkmcnt(6)
    v_mfma_f32_32x32x16_bf16 a[0:15], v[120:123], v[40:43], a[0:15]
    s_add_u32 m0, s53, 65536
    s_add_u32 s36, s44, 0
    buffer_load_dwordx4 v3, s[12:15], s36 offen lds
    v_mfma_f32_32x32x16_bf16 a[32:47], v[120:123], v[44:47], a[32:47]
    s_add_u32 m0, s53, 69632
    s_add_u32 s36, s44, 131072
    buffer_load_dwordx4 v3, s[12:15], s36 offen lds
    v_mfma_f32_32x32x16_bf16 a[16:31], v[124:127], v[40:43], a[16:31]
    s_add_u32 m0, s53, 73728
    s_add_u32 s36, s44, 262144
    buffer_load_dwordx4 v3, s[12:15], s36 offen lds
    v_mfma_f32_32x32x16_bf16 a[48:63], v[124:127], v[44:47], a[48:63]
    s_add_u32 m0, s53, 77824
    s_add_u32 s36, s44, 393216
    buffer_load_dwordx4 v3, s[12:15], s36 offen lds
    ds_read_b128 v[40:43], v147 offset:0
    ds_read_b128 v[44:47], v147 offset:4096
    ds_read_b64_tr_b16 v[120:121], v4 offset:12288
    ds_read_b64_tr_b16 v[122:123], v4 offset:13312
    ds_read_b64_tr_b16 v[124:125], v5 offset:12288
    ds_read_b64_tr_b16 v[126:127], v5 offset:13312
    s_waitcnt lgkmcnt(6)
    v_mfma_f32_32x32x16_bf16 a[0:15], v[96:99], v[32:35], a[0:15]
    v_mfma_f32_32x32x16_bf16 a[32:47], v[96:99], v[36:39], a[32:47]
    v_mfma_f32_32x32x16_bf16 a[16:31], v[100:103], v[32:35], a[16:31]
    v_mfma_f32_32x32x16_bf16 a[48:63], v[100:103], v[36:39], a[48:63]
    s_waitcnt lgkmcnt(0)
    v_mfma_f32_32x32x16_bf16 a[0:15], v[120:123], v[40:43], a[0:15]
    v_mfma_f32_32x32x16_bf16 a[32:47], v[120:123], v[44:47], a[32:47]
    v_mfma_f32_32x32x16_bf16 a[16:31], v[124:127], v[40:43], a[16:31]
    v_mfma_f32_32x32x16_bf16 a[48:63], v[124:127], v[44:47], a[48:63]
    s_add_u32 s45, s45, 1
    s_branch QKV_LOOP_Q
QKV_LASTC_Q:
    ds_read_b128 v[32:35], v144 offset:0
    ds_read_b128 v[36:39], v144 offset:4096
    ds_read_b64_tr_b16 v[96:97], v4 offset:0
    ds_read_b64_tr_b16 v[98:99], v4 offset:1024
    ds_read_b64_tr_b16 v[100:101], v5 offset:0
    ds_read_b64_tr_b16 v[102:103], v5 offset:1024
    ds_read_b128 v[40:43], v145 offset:0
    ds_read_b128 v[44:47], v145 offset:4096
    ds_read_b64_tr_b16 v[120:121], v4 offset:4096
    ds_read_b64_tr_b16 v[122:123], v4 offset:5120
    ds_read_b64_tr_b16 v[124:125], v5 offset:4096
    ds_read_b64_tr_b16 v[126:127], v5 offset:5120
    s_waitcnt lgkmcnt(6)
    v_mfma_f32_32x32x16_bf16 a[0:15], v[96:99], v[32:35], a[0:15]
    v_mfma_f32_32x32x16_bf16 a[32:47], v[96:99], v[36:39], a[32:47]
    v_mfma_f32_32x32x16_bf16 a[16:31], v[100:103], v[32:35], a[16:31]
    v_mfma_f32_32x32x16_bf16 a[48:63], v[100:103], v[36:39], a[48:63]
    ds_read_b128 v[32:35], v146 offset:0
    ds_read_b128 v[36:39], v146 offset:4096
    ds_read_b64_tr_b16 v[96:97], v4 offset:8192
    ds_read_b64_tr_b16 v[98:99], v4 offset:9216
    ds_read_b64_tr_b16 v[100:101], v5 offset:8192
    ds_read_b64_tr_b16 v[102:103], v5 offset:9216
    s_waitcnt lgkmcnt(6)
    v_mfma_f32_32x32x16_bf16 a[0:15], v[120:123], v[40:43], a[0:15]
    v_mfma_f32_32x32x16_bf16 a[32:47], v[120:123], v[44:47], a[32:47]
    v_mfma_f32_32x32x16_bf16 a[16:31], v[124:127], v[40:43], a[16:31]
    v_mfma_f32_32x32x16_bf16 a[48:63], v[124:127], v[44:47], a[48:63]
    ds_read_b128 v[40:43], v147 offset:0
    ds_read_b128 v[44:47], v147 offset:4096
    ds_read_b64_tr_b16 v[120:121], v4 offset:12288
    ds_read_b64_tr_b16 v[122:123], v4 offset:13312
    ds_read_b64_tr_b16 v[124:125], v5 offset:12288
    ds_read_b64_tr_b16 v[126:127], v5 offset:13312
    s_waitcnt lgkmcnt(6)
    v_mfma_f32_32x32x16_bf16 a[0:15], v[96:99], v[32:35], a[0:15]
    v_mfma_f32_32x32x16_bf16 a[32:47], v[96:99], v[36:39], a[32:47]
    v_mfma_f32_32x32x16_bf16 a[16:31], v[100:103], v[32:35], a[16:31]
    v_mfma_f32_32x32x16_bf16 a[48:63], v[100:103], v[36:39], a[48:63]
    s_waitcnt lgkmcnt(0)
    v_mfma_f32_32x32x16_bf16 a[0:15], v[120:123], v[40:43], a[0:15]
    v_mfma_f32_32x32x16_bf16 a[32:47], v[120:123], v[44:47], a[32:47]
    v_mfma_f32_32x32x16_bf16 a[16:31], v[124:127], v[40:43], a[16:31]
    v_mfma_f32_32x32x16_bf16 a[48:63], v[124:127], v[44:47], a[48:63]
    s_nop 15
    s_barrier
    v_accvgpr_read_b32 v32, a0
    v_accvgpr_read_b32 v33, a1
    v_accvgpr_read_b32 v34, a2
    v_accvgpr_read_b32 v35, a3
    v_accvgpr_read_b32 v36, a4
    v_accvgpr_read_b32 v37, a5
    v_accvgpr_read_b32 v38, a6
    v_accvgpr_read_b32 v39, a7
    v_accvgpr_read_b32 v40, a8
    v_accvgpr_read_b32 v41, a9
    v_accvgpr_read_b32 v42, a10
    v_accvgpr_read_b32 v43, a11
    v_accvgpr_read_b32 v44, a12
    v_accvgpr_read_b32 v45, a13
    v_accvgpr_read_b32 v46, a14
    v_accvgpr_read_b32 v47, a15
    v_cvt_pk_bf16_f32 v48, v32, v33
    v_cvt_pk_bf16_f32 v49, v34, v35
    v_cvt_pk_bf16_f32 v50, v36, v37
    v_cvt_pk_bf16_f32 v51, v38, v39
    v_cvt_pk_bf16_f32 v52, v40, v41
    v_cvt_pk_bf16_f32 v53, v42, v43
    v_cvt_pk_bf16_f32 v54, v44, v45
    v_cvt_pk_bf16_f32 v55, v46, v47
    ds_write_b64 v10, v[48:49] offset:0
    ds_write_b64 v11, v[50:51] offset:0
    ds_write_b64 v12, v[52:53] offset:0
    ds_write_b64 v13, v[54:55] offset:0
    v_accvgpr_read_b32 v64, a16
    v_accvgpr_read_b32 v65, a17
    v_accvgpr_read_b32 v66, a18
    v_accvgpr_read_b32 v67, a19
    v_accvgpr_read_b32 v68, a20
    v_accvgpr_read_b32 v69, a21
    v_accvgpr_read_b32 v70, a22
    v_accvgpr_read_b32 v71, a23
    v_accvgpr_read_b32 v72, a24
    v_accvgpr_read_b32 v73, a25
    v_accvgpr_read_b32 v74, a26
    v_accvgpr_read_b32 v75, a27
    v_accvgpr_read_b32 v76, a28
    v_accvgpr_read_b32 v77, a29
    v_accvgpr_read_b32 v78, a30
    v_accvgpr_read_b32 v79, a31
    v_cvt_pk_bf16_f32 v80, v64, v65
    v_cvt_pk_bf16_f32 v81, v66, v67
    v_cvt_pk_bf16_f32 v82, v68, v69
    v_cvt_pk_bf16_f32 v83, v70, v71
    v_cvt_pk_bf16_f32 v84, v72, v73
    v_cvt_pk_bf16_f32 v85, v74, v75
    v_cvt_pk_bf16_f32 v86, v76, v77
    v_cvt_pk_bf16_f32 v87, v78, v79
    ds_write_b64 v14, v[80:81] offset:0
    ds_write_b64 v15, v[82:83] offset:0
    ds_write_b64 v16, v[84:85] offset:0
    ds_write_b64 v17, v[86:87] offset:0
    v_accvgpr_read_b32 v32, a32
    v_accvgpr_read_b32 v33, a33
    v_accvgpr_read_b32 v34, a34
    v_accvgpr_read_b32 v35, a35
    v_accvgpr_read_b32 v36, a36
    v_accvgpr_read_b32 v37, a37
    v_accvgpr_read_b32 v38, a38
    v_accvgpr_read_b32 v39, a39
    v_accvgpr_read_b32 v40, a40
    v_accvgpr_read_b32 v41, a41
    v_accvgpr_read_b32 v42, a42
    v_accvgpr_read_b32 v43, a43
    v_accvgpr_read_b32 v44, a44
    v_accvgpr_read_b32 v45, a45
    v_accvgpr_read_b32 v46, a46
    v_accvgpr_read_b32 v47, a47
    v_cvt_pk_bf16_f32 v48, v32, v33
    v_cvt_pk_bf16_f32 v49, v34, v35
    v_cvt_pk_bf16_f32 v50, v36, v37
    v_cvt_pk_bf16_f32 v51, v38, v39
    v_cvt_pk_bf16_f32 v52, v40, v41
    v_cvt_pk_bf16_f32 v53, v42, v43
    v_cvt_pk_bf16_f32 v54, v44, v45
    v_cvt_pk_bf16_f32 v55, v46, v47
    ds_write_b64 v10, v[48:49] offset:24576
    ds_write_b64 v11, v[50:51] offset:24576
    ds_write_b64 v12, v[52:53] offset:24576
    ds_write_b64 v13, v[54:55] offset:24576
    v_accvgpr_read_b32 v64, a48
    v_accvgpr_read_b32 v65, a49
    v_accvgpr_read_b32 v66, a50
    v_accvgpr_read_b32 v67, a51
    v_accvgpr_read_b32 v68, a52
    v_accvgpr_read_b32 v69, a53
    v_accvgpr_read_b32 v70, a54
    v_accvgpr_read_b32 v71, a55
    v_accvgpr_read_b32 v72, a56
    v_accvgpr_read_b32 v73, a57
    v_accvgpr_read_b32 v74, a58
    v_accvgpr_read_b32 v75, a59
    v_accvgpr_read_b32 v76, a60
    v_accvgpr_read_b32 v77, a61
    v_accvgpr_read_b32 v78, a62
    v_accvgpr_read_b32 v79, a63
    v_cvt_pk_bf16_f32 v80, v64, v65
    v_cvt_pk_bf16_f32 v81, v66, v67
    v_cvt_pk_bf16_f32 v82, v68, v69
    v_cvt_pk_bf16_f32 v83, v70, v71
    v_cvt_pk_bf16_f32 v84, v72, v73
    v_cvt_pk_bf16_f32 v85, v74, v75
    v_cvt_pk_bf16_f32 v86, v76, v77
    v_cvt_pk_bf16_f32 v87, v78, v79
    ds_write_b64 v14, v[80:81] offset:24576
    ds_write_b64 v15, v[82:83] offset:24576
    ds_write_b64 v16, v[84:85] offset:24576
    ds_write_b64 v17, v[86:87] offset:24576
    s_waitcnt lgkmcnt(0)
    s_barrier
    s_lshl_b32 s35, s41, 2
    s_lshl_b32 s36, s42, 6
    s_add_u32 s35, s35, s36
    s_lshl_b32 s35, s35, 13
    v_add_u32 v24, 65536, v19
    ds_read_b128 v[32:35], v19 offset:0
    ds_read_b128 v[36:39], v19 offset:4096
    ds_read_b128 v[40:43], v19 offset:24576
    ds_read_b128 v[44:47], v19 offset:28672
    ds_read_b128 v[48:51], v19 offset:49152
    ds_read_b128 v[52:55], v19 offset:53248
    ds_read_b128 v[56:59], v24 offset:8192
    ds_read_b128 v[60:63], v24 offset:12288
    s_waitcnt lgkmcnt(4)
    s_add_u32 s36, s35, 16777216
    buffer_store_dwordx4 v[32:35], v20, s[4:7], s36 offen sc1
    s_add_u32 s36, s35, 16781312
    buffer_store_dwordx4 v[36:39], v20, s[4:7], s36 offen sc1
    s_add_u32 s36, s35, 16785408
    buffer_store_dwordx4 v[40:43], v20, s[4:7], s36 offen sc1
    s_add_u32 s36, s35, 16789504
    buffer_store_dwordx4 v[44:47], v20, s[4:7], s36 offen sc1
    s_waitcnt lgkmcnt(0)
    s_add_u32 s36, s35, 16793600
    buffer_store_dwordx4 v[48:51], v20, s[4:7], s36 offen sc1
    s_add_u32 s36, s35, 16797696
    buffer_store_dwordx4 v[52:55], v20, s[4:7], s36 offen sc1
    s_add_u32 s36, s35, 16801792
    buffer_store_dwordx4 v[56:59], v20, s[4:7], s36 offen sc1
    s_add_u32 s36, s35, 16805888
    buffer_store_dwordx4 v[60:63], v20, s[4:7], s36 offen sc1
    s_waitcnt vmcnt(0)
    s_barrier
    s_cmp_lg_u32 s32, 0
    s_cbranch_scc1 QKV_NEXT
    s_lshl_b32 s35, 1, s42
    s_lshl_b32 s36, s41, 6
    s_add_u32 s36, s36, 1024
    v_mov_b32 v24, s35
    v_mov_b32 v25, s36
    s_mov_b64 exec, 1
    buffer_atomic_or v24, v25, s[4:7], 0 offen offset:4
    s_mov_b64 exec, -1
    s_branch QKV_NEXT
QKV_NEXT:
    s_add_u32 s40, s40, 1
    s_branch QKV_TILE
QKV_DONE:
GATE:
    s_cmp_lt_u32 s33, 64
    s_cbranch_scc1 GATE_DONE
    s_cmp_ge_u32 s33, 80
    s_cbranch_scc1 GATE_DONE
    s_load_dwordx2 s[52:53], s[0:1], 128
    v_and_b32 v1, 63, v0
    v_and_b32 v2, 7, v1
    v_lshlrev_b32 v2, 4, v2
    v_lshrrev_b32 v3, 3, v1
    v_mul_u32_u24 v4, 1152, v3
    v_add_u32 v4, v4, v2
    v_lshlrev_b32 v5, 2, v3
    v_and_b32 v6, 7, v1
    v_lshl_add_u32 v5, v6, 28, v5
    s_sub_u32 s35, s33, 64
    s_lshl_b32 s35, s35, 2
    s_add_u32 s35, s35, s32
    s_lshl_b32 s35, s35, 5
    s_mul_i32 s36, s35, 1152
    s_lshl_b32 s37, s35, 2
    s_add_u32 s37, s37, 88080384
    s_mov_b32 s59, 0xffff0000
    s_mov_b32 s58, 0xbfb8aa3b
    s_waitcnt lgkmcnt(0)
    s_and_b32 s53, s53, 0xffff
    s_mov_b32 s54, 1152
    s_mov_b32 s55, 0x00020000
    buffer_load_dwordx4 v[16:19], v2, s[52:55], 0 offen offset:0
    buffer_load_dwordx4 v[20:23], v2, s[52:55], 0 offen offset:128
    buffer_load_dwordx4 v[24:27], v2, s[52:55], 0 offen offset:256
    buffer_load_dwordx4 v[28:31], v2, s[52:55], 0 offen offset:384
    buffer_load_dwordx4 v[32:35], v2, s[52:55], 0 offen offset:512
    buffer_load_dwordx4 v[36:39], v2, s[52:55], 0 offen offset:640
    buffer_load_dwordx4 v[40:43], v2, s[52:55], 0 offen offset:768
    buffer_load_dwordx4 v[44:47], v2, s[52:55], 0 offen offset:896
    buffer_load_dwordx4 v[48:51], v2, s[52:55], 0 offen offset:1024
    s_waitcnt vmcnt(0)
    v_lshlrev_b32 v64, 16, v16
    v_and_b32 v65, s59, v16
    v_lshlrev_b32 v66, 16, v17
    v_and_b32 v67, s59, v17
    v_lshlrev_b32 v68, 16, v18
    v_and_b32 v69, s59, v18
    v_lshlrev_b32 v70, 16, v19
    v_and_b32 v71, s59, v19
    v_lshlrev_b32 v72, 16, v20
    v_and_b32 v73, s59, v20
    v_lshlrev_b32 v74, 16, v21
    v_and_b32 v75, s59, v21
    v_lshlrev_b32 v76, 16, v22
    v_and_b32 v77, s59, v22
    v_lshlrev_b32 v78, 16, v23
    v_and_b32 v79, s59, v23
    v_lshlrev_b32 v80, 16, v24
    v_and_b32 v81, s59, v24
    v_lshlrev_b32 v82, 16, v25
    v_and_b32 v83, s59, v25
    v_lshlrev_b32 v84, 16, v26
    v_and_b32 v85, s59, v26
    v_lshlrev_b32 v86, 16, v27
    v_and_b32 v87, s59, v27
    v_lshlrev_b32 v88, 16, v28
    v_and_b32 v89, s59, v28
    v_lshlrev_b32 v90, 16, v29
    v_and_b32 v91, s59, v29
    v_lshlrev_b32 v92, 16, v30
    v_and_b32 v93, s59, v30
    v_lshlrev_b32 v94, 16, v31
    v_and_b32 v95, s59, v31
    v_lshlrev_b32 v96, 16, v32
    v_and_b32 v97, s59, v32
    v_lshlrev_b32 v98, 16, v33
    v_and_b32 v99, s59, v33
    v_lshlrev_b32 v100, 16, v34
    v_and_b32 v101, s59, v34
    v_lshlrev_b32 v102, 16, v35
    v_and_b32 v103, s59, v35
    v_lshlrev_b32 v104, 16, v36
    v_and_b32 v105, s59, v36
    v_lshlrev_b32 v106, 16, v37
    v_and_b32 v107, s59, v37
    v_lshlrev_b32 v108, 16, v38
    v_and_b32 v109, s59, v38
    v_lshlrev_b32 v110, 16, v39
    v_and_b32 v111, s59, v39
    v_lshlrev_b32 v112, 16, v40
    v_and_b32 v113, s59, v40
    v_lshlrev_b32 v114, 16, v41
    v_and_b32 v115, s59, v41
    v_lshlrev_b32 v116, 16, v42
    v_and_b32 v117, s59, v42
    v_lshlrev_b32 v118, 16, v43
    v_and_b32 v119, s59, v43
    v_lshlrev_b32 v120, 16, v44
    v_and_b32 v121, s59, v44
    v_lshlrev_b32 v122, 16, v45
    v_and_b32 v123, s59, v45
    v_lshlrev_b32 v124, 16, v46
    v_and_b32 v125, s59, v46
    v_lshlrev_b32 v126, 16, v47
    v_and_b32 v127, s59, v47
    v_lshlrev_b32 v128, 16, v48
    v_and_b32 v129, s59, v48
    v_lshlrev_b32 v130, 16, v49
    v_and_b32 v131, s59, v49
    v_lshlrev_b32 v132, 16, v50
    v_and_b32 v133, s59, v50
    v_lshlrev_b32 v134, 16, v51
    v_and_b32 v135, s59, v51
    s_mov_b32 s38, 0
GATE_LOOP:
    buffer_load_dwordx4 v[16:19], v4, s[48:51], s36 offen offset:0
    buffer_load_dwordx4 v[20:23], v4, s[48:51], s36 offen offset:128
    buffer_load_dwordx4 v[24:27], v4, s[48:51], s36 offen offset:256
    buffer_load_dwordx4 v[28:31], v4, s[48:51], s36 offen offset:384
    buffer_load_dwordx4 v[32:35], v4, s[48:51], s36 offen offset:512
    buffer_load_dwordx4 v[36:39], v4, s[48:51], s36 offen offset:640
    buffer_load_dwordx4 v[40:43], v4, s[48:51], s36 offen offset:768
    buffer_load_dwordx4 v[44:47], v4, s[48:51], s36 offen offset:896
    buffer_load_dwordx4 v[48:51], v4, s[48:51], s36 offen offset:1024
    v_mov_b32 v8, 0
    v_mov_b32 v9, 0
    s_waitcnt vmcnt(0)
    v_lshlrev_b32 v10, 16, v16
    v_and_b32 v11, s59, v16
    v_mul_f32 v10, v10, v64
    v_mul_f32 v11, v11, v65
    v_cvt_pk_bf16_f32 v12, v10, v11
    v_lshlrev_b32 v10, 16, v12
    v_and_b32 v11, s59, v12
    v_add_f32 v8, v8, v10
    v_add_f32 v9, v9, v11
    v_lshlrev_b32 v10, 16, v17
    v_and_b32 v11, s59, v17
    v_mul_f32 v10, v10, v66
    v_mul_f32 v11, v11, v67
    v_cvt_pk_bf16_f32 v12, v10, v11
    v_lshlrev_b32 v10, 16, v12
    v_and_b32 v11, s59, v12
    v_add_f32 v8, v8, v10
    v_add_f32 v9, v9, v11
    v_lshlrev_b32 v10, 16, v18
    v_and_b32 v11, s59, v18
    v_mul_f32 v10, v10, v68
    v_mul_f32 v11, v11, v69
    v_cvt_pk_bf16_f32 v12, v10, v11
    v_lshlrev_b32 v10, 16, v12
    v_and_b32 v11, s59, v12
    v_add_f32 v8, v8, v10
    v_add_f32 v9, v9, v11
    v_lshlrev_b32 v10, 16, v19
    v_and_b32 v11, s59, v19
    v_mul_f32 v10, v10, v70
    v_mul_f32 v11, v11, v71
    v_cvt_pk_bf16_f32 v12, v10, v11
    v_lshlrev_b32 v10, 16, v12
    v_and_b32 v11, s59, v12
    v_add_f32 v8, v8, v10
    v_add_f32 v9, v9, v11
    v_lshlrev_b32 v10, 16, v20
    v_and_b32 v11, s59, v20
    v_mul_f32 v10, v10, v72
    v_mul_f32 v11, v11, v73
    v_cvt_pk_bf16_f32 v12, v10, v11
    v_lshlrev_b32 v10, 16, v12
    v_and_b32 v11, s59, v12
    v_add_f32 v8, v8, v10
    v_add_f32 v9, v9, v11
    v_lshlrev_b32 v10, 16, v21
    v_and_b32 v11, s59, v21
    v_mul_f32 v10, v10, v74
    v_mul_f32 v11, v11, v75
    v_cvt_pk_bf16_f32 v12, v10, v11
    v_lshlrev_b32 v10, 16, v12
    v_and_b32 v11, s59, v12
    v_add_f32 v8, v8, v10
    v_add_f32 v9, v9, v11
    v_lshlrev_b32 v10, 16, v22
    v_and_b32 v11, s59, v22
    v_mul_f32 v10, v10, v76
    v_mul_f32 v11, v11, v77
    v_cvt_pk_bf16_f32 v12, v10, v11
    v_lshlrev_b32 v10, 16, v12
    v_and_b32 v11, s59, v12
    v_add_f32 v8, v8, v10
    v_add_f32 v9, v9, v11
    v_lshlrev_b32 v10, 16, v23
    v_and_b32 v11, s59, v23
    v_mul_f32 v10, v10, v78
    v_mul_f32 v11, v11, v79
    v_cvt_pk_bf16_f32 v12, v10, v11
    v_lshlrev_b32 v10, 16, v12
    v_and_b32 v11, s59, v12
    v_add_f32 v8, v8, v10
    v_add_f32 v9, v9, v11
    v_lshlrev_b32 v10, 16, v24
    v_and_b32 v11, s59, v24
    v_mul_f32 v10, v10, v80
    v_mul_f32 v11, v11, v81
    v_cvt_pk_bf16_f32 v12, v10, v11
    v_lshlrev_b32 v10, 16, v12
    v_and_b32 v11, s59, v12
    v_add_f32 v8, v8, v10
    v_add_f32 v9, v9, v11
    v_lshlrev_b32 v10, 16, v25
    v_and_b32 v11, s59, v25
    v_mul_f32 v10, v10, v82
    v_mul_f32 v11, v11, v83
    v_cvt_pk_bf16_f32 v12, v10, v11
    v_lshlrev_b32 v10, 16, v12
    v_and_b32 v11, s59, v12
    v_add_f32 v8, v8, v10
    v_add_f32 v9, v9, v11
    v_lshlrev_b32 v10, 16, v26
    v_and_b32 v11, s59, v26
    v_mul_f32 v10, v10, v84
    v_mul_f32 v11, v11, v85
    v_cvt_pk_bf16_f32 v12, v10, v11
    v_lshlrev_b32 v10, 16, v12
    v_and_b32 v11, s59, v12
    v_add_f32 v8, v8, v10
    v_add_f32 v9, v9, v11
    v_lshlrev_b32 v10, 16, v27
    v_and_b32 v11, s59, v27
    v_mul_f32 v10, v10, v86
    v_mul_f32 v11, v11, v87
    v_cvt_pk_bf16_f32 v12, v10, v11
    v_lshlrev_b32 v10, 16, v12
    v_and_b32 v11, s59, v12
    v_add_f32 v8, v8, v10
    v_add_f32 v9, v9, v11
    v_lshlrev_b32 v10, 16, v28
    v_and_b32 v11, s59, v28
    v_mul_f32 v10, v10, v88
    v_mul_f32 v11, v11, v89
    v_cvt_pk_bf16_f32 v12, v10, v11
    v_lshlrev_b32 v10, 16, v12
    v_and_b32 v11, s59, v12
    v_add_f32 v8, v8, v10
    v_add_f32 v9, v9, v11
    v_lshlrev_b32 v10, 16, v29
    v_and_b32 v11, s59, v29
    v_mul_f32 v10, v10, v90
    v_mul_f32 v11, v11, v91
    v_cvt_pk_bf16_f32 v12, v10, v11
    v_lshlrev_b32 v10, 16, v12
    v_and_b32 v11, s59, v12
    v_add_f32 v8, v8, v10
    v_add_f32 v9, v9, v11
    v_lshlrev_b32 v10, 16, v30
    v_and_b32 v11, s59, v30
    v_mul_f32 v10, v10, v92
    v_mul_f32 v11, v11, v93
    v_cvt_pk_bf16_f32 v12, v10, v11
    v_lshlrev_b32 v10, 16, v12
    v_and_b32 v11, s59, v12
    v_add_f32 v8, v8, v10
    v_add_f32 v9, v9, v11
    v_lshlrev_b32 v10, 16, v31
    v_and_b32 v11, s59, v31
    v_mul_f32 v10, v10, v94
    v_mul_f32 v11, v11, v95
    v_cvt_pk_bf16_f32 v12, v10, v11
    v_lshlrev_b32 v10, 16, v12
    v_and_b32 v11, s59, v12
    v_add_f32 v8, v8, v10
    v_add_f32 v9, v9, v11
    v_lshlrev_b32 v10, 16, v32
    v_and_b32 v11, s59, v32
    v_mul_f32 v10, v10, v96
    v_mul_f32 v11, v11, v97
    v_cvt_pk_bf16_f32 v12, v10, v11
    v_lshlrev_b32 v10, 16, v12
    v_and_b32 v11, s59, v12
    v_add_f32 v8, v8, v10
    v_add_f32 v9, v9, v11
    v_lshlrev_b32 v10, 16, v33
    v_and_b32 v11, s59, v33
    v_mul_f32 v10, v10, v98
    v_mul_f32 v11, v11, v99
    v_cvt_pk_bf16_f32 v12, v10, v11
    v_lshlrev_b32 v10, 16, v12
    v_and_b32 v11, s59, v12
    v_add_f32 v8, v8, v10
    v_add_f32 v9, v9, v11
    v_lshlrev_b32 v10, 16, v34
    v_and_b32 v11, s59, v34
    v_mul_f32 v10, v10, v100
    v_mul_f32 v11, v11, v101
    v_cvt_pk_bf16_f32 v12, v10, v11
    v_lshlrev_b32 v10, 16, v12
    v_and_b32 v11, s59, v12
    v_add_f32 v8, v8, v10
    v_add_f32 v9, v9, v11
    v_lshlrev_b32 v10, 16, v35
    v_and_b32 v11, s59, v35
    v_mul_f32 v10, v10, v102
    v_mul_f32 v11, v11, v103
    v_cvt_pk_bf16_f32 v12, v10, v11
    v_lshlrev_b32 v10, 16, v12
    v_and_b32 v11, s59, v12
    v_add_f32 v8, v8, v10
    v_add_f32 v9, v9, v11
    v_lshlrev_b32 v10, 16, v36
    v_and_b32 v11, s59, v36
    v_mul_f32 v10, v10, v104
    v_mul_f32 v11, v11, v105
    v_cvt_pk_bf16_f32 v12, v10, v11
    v_lshlrev_b32 v10, 16, v12
    v_and_b32 v11, s59, v12
    v_add_f32 v8, v8, v10
    v_add_f32 v9, v9, v11
    v_lshlrev_b32 v10, 16, v37
    v_and_b32 v11, s59, v37
    v_mul_f32 v10, v10, v106
    v_mul_f32 v11, v11, v107
    v_cvt_pk_bf16_f32 v12, v10, v11
    v_lshlrev_b32 v10, 16, v12
    v_and_b32 v11, s59, v12
    v_add_f32 v8, v8, v10
    v_add_f32 v9, v9, v11
    v_lshlrev_b32 v10, 16, v38
    v_and_b32 v11, s59, v38
    v_mul_f32 v10, v10, v108
    v_mul_f32 v11, v11, v109
    v_cvt_pk_bf16_f32 v12, v10, v11
    v_lshlrev_b32 v10, 16, v12
    v_and_b32 v11, s59, v12
    v_add_f32 v8, v8, v10
    v_add_f32 v9, v9, v11
    v_lshlrev_b32 v10, 16, v39
    v_and_b32 v11, s59, v39
    v_mul_f32 v10, v10, v110
    v_mul_f32 v11, v11, v111
    v_cvt_pk_bf16_f32 v12, v10, v11
    v_lshlrev_b32 v10, 16, v12
    v_and_b32 v11, s59, v12
    v_add_f32 v8, v8, v10
    v_add_f32 v9, v9, v11
    v_lshlrev_b32 v10, 16, v40
    v_and_b32 v11, s59, v40
    v_mul_f32 v10, v10, v112
    v_mul_f32 v11, v11, v113
    v_cvt_pk_bf16_f32 v12, v10, v11
    v_lshlrev_b32 v10, 16, v12
    v_and_b32 v11, s59, v12
    v_add_f32 v8, v8, v10
    v_add_f32 v9, v9, v11
    v_lshlrev_b32 v10, 16, v41
    v_and_b32 v11, s59, v41
    v_mul_f32 v10, v10, v114
    v_mul_f32 v11, v11, v115
    v_cvt_pk_bf16_f32 v12, v10, v11
    v_lshlrev_b32 v10, 16, v12
    v_and_b32 v11, s59, v12
    v_add_f32 v8, v8, v10
    v_add_f32 v9, v9, v11
    v_lshlrev_b32 v10, 16, v42
    v_and_b32 v11, s59, v42
    v_mul_f32 v10, v10, v116
    v_mul_f32 v11, v11, v117
    v_cvt_pk_bf16_f32 v12, v10, v11
    v_lshlrev_b32 v10, 16, v12
    v_and_b32 v11, s59, v12
    v_add_f32 v8, v8, v10
    v_add_f32 v9, v9, v11
    v_lshlrev_b32 v10, 16, v43
    v_and_b32 v11, s59, v43
    v_mul_f32 v10, v10, v118
    v_mul_f32 v11, v11, v119
    v_cvt_pk_bf16_f32 v12, v10, v11
    v_lshlrev_b32 v10, 16, v12
    v_and_b32 v11, s59, v12
    v_add_f32 v8, v8, v10
    v_add_f32 v9, v9, v11
    v_lshlrev_b32 v10, 16, v44
    v_and_b32 v11, s59, v44
    v_mul_f32 v10, v10, v120
    v_mul_f32 v11, v11, v121
    v_cvt_pk_bf16_f32 v12, v10, v11
    v_lshlrev_b32 v10, 16, v12
    v_and_b32 v11, s59, v12
    v_add_f32 v8, v8, v10
    v_add_f32 v9, v9, v11
    v_lshlrev_b32 v10, 16, v45
    v_and_b32 v11, s59, v45
    v_mul_f32 v10, v10, v122
    v_mul_f32 v11, v11, v123
    v_cvt_pk_bf16_f32 v12, v10, v11
    v_lshlrev_b32 v10, 16, v12
    v_and_b32 v11, s59, v12
    v_add_f32 v8, v8, v10
    v_add_f32 v9, v9, v11
    v_lshlrev_b32 v10, 16, v46
    v_and_b32 v11, s59, v46
    v_mul_f32 v10, v10, v124
    v_mul_f32 v11, v11, v125
    v_cvt_pk_bf16_f32 v12, v10, v11
    v_lshlrev_b32 v10, 16, v12
    v_and_b32 v11, s59, v12
    v_add_f32 v8, v8, v10
    v_add_f32 v9, v9, v11
    v_lshlrev_b32 v10, 16, v47
    v_and_b32 v11, s59, v47
    v_mul_f32 v10, v10, v126
    v_mul_f32 v11, v11, v127
    v_cvt_pk_bf16_f32 v12, v10, v11
    v_lshlrev_b32 v10, 16, v12
    v_and_b32 v11, s59, v12
    v_add_f32 v8, v8, v10
    v_add_f32 v9, v9, v11
    v_lshlrev_b32 v10, 16, v48
    v_and_b32 v11, s59, v48
    v_mul_f32 v10, v10, v128
    v_mul_f32 v11, v11, v129
    v_cvt_pk_bf16_f32 v12, v10, v11
    v_lshlrev_b32 v10, 16, v12
    v_and_b32 v11, s59, v12
    v_add_f32 v8, v8, v10
    v_add_f32 v9, v9, v11
    v_lshlrev_b32 v10, 16, v49
    v_and_b32 v11, s59, v49
    v_mul_f32 v10, v10, v130
    v_mul_f32 v11, v11, v131
    v_cvt_pk_bf16_f32 v12, v10, v11
    v_lshlrev_b32 v10, 16, v12
    v_and_b32 v11, s59, v12
    v_add_f32 v8, v8, v10
    v_add_f32 v9, v9, v11
    v_lshlrev_b32 v10, 16, v50
    v_and_b32 v11, s59, v50
    v_mul_f32 v10, v10, v132
    v_mul_f32 v11, v11, v133
    v_cvt_pk_bf16_f32 v12, v10, v11
    v_lshlrev_b32 v10, 16, v12
    v_and_b32 v11, s59, v12
    v_add_f32 v8, v8, v10
    v_add_f32 v9, v9, v11
    v_lshlrev_b32 v10, 16, v51
    v_and_b32 v11, s59, v51
    v_mul_f32 v10, v10, v134
    v_mul_f32 v11, v11, v135
    v_cvt_pk_bf16_f32 v12, v10, v11
    v_lshlrev_b32 v10, 16, v12
    v_and_b32 v11, s59, v12
    v_add_f32 v8, v8, v10
    v_add_f32 v9, v9, v11
    v_add_f32 v8, v8, v9
    s_nop 1
    v_add_f32_dpp v8, v8, v8 quad_perm:[1,0,3,2] row_mask:0xf bank_mask:0xf
    s_nop 1
    v_add_f32_dpp v8, v8, v8 quad_perm:[2,3,0,1] row_mask:0xf bank_mask:0xf
    s_nop 1
    v_add_f32_dpp v8, v8, v8 row_half_mirror row_mask:0xf bank_mask:0xf
    v_cvt_pk_bf16_f32 v8, v8, v8
    v_lshlrev_b32 v8, 16, v8
    v_mul_f32 v8, s58, v8
    v_exp_f32 v8, v8
    s_nop 0
    v_add_f32 v8, 1.0, v8
    v_rcp_f32 v8, v8
    s_nop 0
    v_cvt_pk_bf16_f32 v8, v8, v8
    v_lshlrev_b32 v8, 16, v8
    buffer_store_dword v8, v5, s[4:7], s37 offen sc1
    s_add_u32 s36, s36, 9216
    s_add_u32 s37, s37, 32
    s_add_u32 s38, s38, 1
    s_cmp_lt_u32 s38, 4
    s_cbranch_scc1 GATE_LOOP
    s_waitcnt vmcnt(0)
    v_mov_b32 v8, 1
    v_mov_b32 v9, 8256
    s_mov_b64 exec, 1
    buffer_atomic_add v8, v9, s[4:7], 0 offen
    s_mov_b64 exec, -1
GATE_DONE:
S4:
    s_cmp_lt_u32 s33, 80
    s_cbranch_scc1 S4_DONE
    s_sub_u32 s40, s33, 80
    s_lshl_b32 s40, s40, 2
    s_add_u32 s42, s40, s32
    s_mul_i32 s41, s32, 40960
    v_and_b32 v1, 63, v0
    v_lshlrev_b32 v2, 4, v1
    v_add_u32 v2, s41, v2
    v_mov_b32 v4, 0
    v_mov_b32 v5, 0
    v_mov_b32 v6, 0
    v_mov_b32 v7, 0
    s_barrier
    ds_write_b128 v2, v[4:7] offset:0
    ds_write_b128 v2, v[4:7] offset:1024
    ds_write_b128 v2, v[4:7] offset:2048
    ds_write_b128 v2, v[4:7] offset:3072
    ds_write_b128 v2, v[4:7] offset:4096
    ds_write_b128 v2, v[4:7] offset:5120
    ds_write_b128 v2, v[4:7] offset:6144
    ds_write_b128 v2, v[4:7] offset:7168
    ds_write_b128 v2, v[4:7] offset:8192
    ds_write_b128 v2, v[4:7] offset:9216
    ds_write_b128 v2, v[4:7] offset:10240
    ds_write_b128 v2, v[4:7] offset:11264
    ds_write_b128 v2, v[4:7] offset:12288
    ds_write_b128 v2, v[4:7] offset:13312
    ds_write_b128 v2, v[4:7] offset:14336
    ds_write_b128 v2, v[4:7] offset:15360
    ds_write_b128 v2, v[4:7] offset:16384
    ds_write_b128 v2, v[4:7] offset:17408
    ds_write_b128 v2, v[4:7] offset:18432
    ds_write_b128 v2, v[4:7] offset:19456
    ds_write_b128 v2, v[4:7] offset:20480
    ds_write_b128 v2, v[4:7] offset:21504
    ds_write_b128 v2, v[4:7] offset:22528
    ds_write_b128 v2, v[4:7] offset:23552
    ds_write_b128 v2, v[4:7] offset:24576
    ds_write_b128 v2, v[4:7] offset:25600
    ds_write_b128 v2, v[4:7] offset:26624
    ds_write_b128 v2, v[4:7] offset:27648
    ds_write_b128 v2, v[4:7] offset:28672
    ds_write_b128 v2, v[4:7] offset:29696
    ds_write_b128 v2, v[4:7] offset:30720
    ds_write_b128 v2, v[4:7] offset:31744
    v_mul_u32_u24 v3, 1152, v0
    s_lshl_b32 s35, s40, 1
    buffer_load_dwordx2 v[16:17], v3, s[48:51], s35 offen
    s_add_u32 s35, s35, 294912
    buffer_load_dwordx2 v[18:19], v3, s[48:51], s35 offen
    s_add_u32 s35, s35, 294912
    buffer_load_dwordx2 v[20:21], v3, s[48:51], s35 offen
    s_add_u32 s35, s35, 294912
    buffer_load_dwordx2 v[22:23], v3, s[48:51], s35 offen
    s_add_u32 s35, s35, 294912
    buffer_load_dwordx2 v[24:25], v3, s[48:51], s35 offen
    s_add_u32 s35, s35, 294912
    buffer_load_dwordx2 v[26:27], v3, s[48:51], s35 offen
    s_add_u32 s35, s35, 294912
    buffer_load_dwordx2 v[28:29], v3, s[48:51], s35 offen
    s_add_u32 s35, s35, 294912
    buffer_load_dwordx2 v[30:31], v3, s[48:51], s35 offen
    v_lshlrev_b32 v3, 1, v1
    s_lshl_b32 s35, s42, 8
    s_mov_b32 s54, 147456
    s_mov_b32 s55, 0x00020000
    s_load_dwordx2 s[52:53], s[0:1], 8
    s_waitcnt lgkmcnt(0)
    s_and_b32 s53, s53, 0xffff
    buffer_load_ushort v32, v3, s[52:55], s35 offen
    buffer_load_ushort v33, v3, s[52:55], s35 offen offset:128
    s_nop 0
    s_load_dwordx2 s[52:53], s[0:1], 16
    s_waitcnt lgkmcnt(0)
    s_and_b32 s53, s53, 0xffff
    buffer_load_ushort v34, v3, s[52:55], s35 offen
    buffer_load_ushort v35, v3, s[52:55], s35 offen offset:128
    s_nop 0
    s_load_dwordx2 s[52:53], s[0:1], 24
    s_waitcnt lgkmcnt(0)
    s_and_b32 s53, s53, 0xffff
    buffer_load_ushort v36, v3, s[52:55], s35 offen
    buffer_load_ushort v37, v3, s[52:55], s35 offen offset:128
    s_nop 0
    s_load_dwordx2 s[52:53], s[0:1], 32
    s_waitcnt lgkmcnt(0)
    s_and_b32 s53, s53, 0xffff
    buffer_load_ushort v38, v3, s[52:55], s35 offen
    buffer_load_ushort v39, v3, s[52:55], s35 offen offset:128
    s_nop 0
    s_load_dwordx2 s[52:53], s[0:1], 40
    s_waitcnt lgkmcnt(0)
    s_and_b32 s53, s53, 0xffff
    buffer_load_ushort v40, v3, s[52:55], s35 offen
    buffer_load_ushort v41, v3, s[52:55], s35 offen offset:128
    s_nop 0
    s_load_dwordx2 s[52:53], s[0:1], 48
    s_waitcnt lgkmcnt(0)
    s_and_b32 s53, s53, 0xffff
    buffer_load_ushort v42, v3, s[52:55], s35 offen
    buffer_load_ushort v43, v3, s[52:55], s35 offen offset:128
    s_nop 0
    s_load_dwordx2 s[52:53], s[0:1], 56
    s_waitcnt lgkmcnt(0)
    s_and_b32 s53, s53, 0xffff
    s_mov_b32 s54, 1152
    s_lshl_b32 s35, s42, 1
    v_mov_b32 v3, 0
    buffer_load_ushort v44, v3, s[52:55], s35 offen
    s_barrier
    v_sub_u32 v8, 255, v0
    v_lshlrev_b32 v8, 1, v8
    v_add_u32 v9, 81920, v8
    s_waitcnt vmcnt(13)
    ds_write_b16 v8, v16 offset:3584
    ds_write_b16 v8, v16 offset:7762
    ds_write_b16 v8, v16 offset:11940
    ds_write_b16 v8, v16 offset:16118
    ds_write_b16_d16_hi v8, v16 offset:44544
    ds_write_b16_d16_hi v8, v16 offset:48722
    ds_write_b16_d16_hi v8, v16 offset:52900
    ds_write_b16_d16_hi v8, v16 offset:57078
    ds_write_b16 v9, v17 offset:3584
    ds_write_b16 v9, v17 offset:7762
    ds_write_b16 v9, v17 offset:11940
    ds_write_b16 v9, v17 offset:16118
    ds_write_b16_d16_hi v9, v17 offset:44544
    ds_write_b16_d16_hi v9, v17 offset:48722
    ds_write_b16_d16_hi v9, v17 offset:52900
    ds_write_b16_d16_hi v9, v17 offset:57078
    ds_write_b16 v8, v18 offset:3072
    ds_write_b16 v8, v18 offset:7250
    ds_write_b16 v8, v18 offset:11428
    ds_write_b16 v8, v18 offset:15606
    ds_write_b16_d16_hi v8, v18 offset:44032
    ds_write_b16_d16_hi v8, v18 offset:48210
    ds_write_b16_d16_hi v8, v18 offset:52388
    ds_write_b16_d16_hi v8, v18 offset:56566
    ds_write_b16 v9, v19 offset:3072
    ds_write_b16 v9, v19 offset:7250
    ds_write_b16 v9, v19 offset:11428
    ds_write_b16 v9, v19 offset:15606
    ds_write_b16_d16_hi v9, v19 offset:44032
    ds_write_b16_d16_hi v9, v19 offset:48210
    ds_write_b16_d16_hi v9, v19 offset:52388
    ds_write_b16_d16_hi v9, v19 offset:56566
    ds_write_b16 v8, v20 offset:2560
    ds_write_b16 v8, v20 offset:6738
    ds_write_b16 v8, v20 offset:10916
    ds_write_b16 v8, v20 offset:15094
    ds_write_b16_d16_hi v8, v20 offset:43520
    ds_write_b16_d16_hi v8, v20 offset:47698
    ds_write_b16_d16_hi v8, v20 offset:51876
    ds_write_b16_d16_hi v8, v20 offset:56054
    ds_write_b16 v9, v21 offset:2560
    ds_write_b16 v9, v21 offset:6738
    ds_write_b16 v9, v21 offset:10916
    ds_write_b16 v9, v21 offset:15094
    ds_write_b16_d16_hi v9, v21 offset:43520
    ds_write_b16_d16_hi v9, v21 offset:47698
    ds_write_b16_d16_hi v9, v21 offset:51876
    ds_write_b16_d16_hi v9, v21 offset:56054
    ds_write_b16 v8, v22 offset:2048
    ds_write_b16 v8, v22 offset:6226
    ds_write_b16 v8, v22 offset:10404
    ds_write_b16 v8, v22 offset:14582
    ds_write_b16_d16_hi v8, v22 offset:43008
    ds_write_b16_d16_hi v8, v22 offset:47186
    ds_write_b16_d16_hi v8, v22 offset:51364
    ds_write_b16_d16_hi v8, v22 offset:55542
    ds_write_b16 v9, v23 offset:2048
    ds_write_b16 v9, v23 offset:6226
    ds_write_b16 v9, v23 offset:10404
    ds_write_b16 v9, v23 offset:14582
    ds_write_b16_d16_hi v9, v23 offset:43008
    ds_write_b16_d16_hi v9, v23 offset:47186
    ds_write_b16_d16_hi v9, v23 offset:51364
    ds_write_b16_d16_hi v9, v23 offset:55542
    ds_write_b16 v8, v24 offset:1536
    ds_write_b16 v8, v24 offset:5714
    ds_write_b16 v8, v24 offset:9892
    ds_write_b16 v8, v24 offset:14070
    ds_write_b16_d16_hi v8, v24 offset:42496
    ds_write_b16_d16_hi v8, v24 offset:46674
    ds_write_b16_d16_hi v8, v24 offset:50852
    ds_write_b16_d16_hi v8, v24 offset:55030
    ds_write_b16 v9, v25 offset:1536
    ds_write_b16 v9, v25 offset:5714
    ds_write_b16 v9, v25 offset:9892
    ds_write_b16 v9, v25 offset:14070
    ds_write_b16_d16_hi v9, v25 offset:42496
    ds_write_b16_d16_hi v9, v25 offset:46674
    ds_write_b16_d16_hi v9, v25 offset:50852
    ds_write_b16_d16_hi v9, v25 offset:55030
    ds_write_b16 v8, v26 offset:1024
    ds_write_b16 v8, v26 offset:5202
    ds_write_b16 v8, v26 offset:9380
    ds_write_b16 v8, v26 offset:13558
    ds_write_b16_d16_hi v8, v26 offset:41984
    ds_write_b16_d16_hi v8, v26 offset:46162
    ds_write_b16_d16_hi v8, v26 offset:50340
    ds_write_b16_d16_hi v8, v26 offset:54518
    ds_write_b16 v9, v27 offset:1024
    ds_write_b16 v9, v27 offset:5202
    ds_write_b16 v9, v27 offset:9380
    ds_write_b16 v9, v27 offset:13558
    ds_write_b16_d16_hi v9, v27 offset:41984
    ds_write_b16_d16_hi v9, v27 offset:46162
    ds_write_b16_d16_hi v9, v27 offset:50340
    ds_write_b16_d16_hi v9, v27 offset:54518
    ds_write_b16 v8, v28 offset:512
    ds_write_b16 v8, v28 offset:4690
    ds_write_b16 v8, v28 offset:8868
    ds_write_b16 v8, v28 offset:13046
    ds_write_b16_d16_hi v8, v28 offset:41472
    ds_write_b16_d16_hi v8, v28 offset:45650
    ds_write_b16_d16_hi v8, v28 offset:49828
    ds_write_b16_d16_hi v8, v28 offset:54006
    ds_write_b16 v9, v29 offset:512
    ds_write_b16 v9, v29 offset:4690
    ds_write_b16 v9, v29 offset:8868
    ds_write_b16 v9, v29 offset:13046
    ds_write_b16_d16_hi v9, v29 offset:41472
    ds_write_b16_d16_hi v9, v29 offset:45650
    ds_write_b16_d16_hi v9, v29 offset:49828
    ds_write_b16_d16_hi v9, v29 offset:54006
    ds_write_b16 v8, v30 offset:0
    ds_write_b16 v8, v30 offset:4178
    ds_write_b16 v8, v30 offset:8356
    ds_write_b16 v8, v30 offset:12534
    ds_write_b16_d16_hi v8, v30 offset:40960
    ds_write_b16_d16_hi v8, v30 offset:45138
    ds_write_b16_d16_hi v8, v30 offset:49316
    ds_write_b16_d16_hi v8, v30 offset:53494
    ds_write_b16 v9, v31 offset:0
    ds_write_b16 v9, v31 offset:4178
    ds_write_b16 v9, v31 offset:8356
    ds_write_b16 v9, v31 offset:12534
    ds_write_b16_d16_hi v9, v31 offset:40960
    ds_write_b16_d16_hi v9, v31 offset:45138
    ds_write_b16_d16_hi v9, v31 offset:49316
    ds_write_b16_d16_hi v9, v31 offset:53494
    s_waitcnt vmcnt(0)
    s_mov_b32 s35, 0x3fb8aa3b
    s_mov_b32 s36, 0x3e22f983
    v_lshlrev_b32 v44, 16, v44
    v_mul_f32 v44, s35, v44
    v_exp_f32 v44, v44
    s_nop 0
    v_cvt_pk_bf16_f32 v44, v44, v44
    v_lshlrev_b32 v44, 16, v44
    v_add_u32 v2, 34480, v2
    v_lshlrev_b32 v32, 16, v32
    v_lshlrev_b32 v34, 16, v34
    v_lshlrev_b32 v36, 16, v36
    v_lshlrev_b32 v38, 16, v38
    v_lshlrev_b32 v40, 16, v40
    v_lshlrev_b32 v42, 16, v42
    v_mul_f32 v32, v44, v32
    v_mul_f32 v34, v44, v34
    v_mul_f32 v36, v44, v36
    v_mul_f32 v38, v44, v38
    v_mul_f32 v48, s35, v32
    v_mul_f32 v49, s36, v34
    v_mul_f32 v50, v40, v36
    v_fma_f32 v50, -v42, v38, v50
    v_mul_f32 v51, v40, v38
    v_fma_f32 v51, v42, v36, v51
    ds_write_b128 v2, v[48:51] offset:0
    v_lshlrev_b32 v33, 16, v33
    v_lshlrev_b32 v35, 16, v35
    v_lshlrev_b32 v37, 16, v37
    v_lshlrev_b32 v39, 16, v39
    v_lshlrev_b32 v41, 16, v41
    v_lshlrev_b32 v43, 16, v43
    v_mul_f32 v33, v44, v33
    v_mul_f32 v35, v44, v35
    v_mul_f32 v37, v44, v37
    v_mul_f32 v39, v44, v39
    v_mul_f32 v48, s35, v33
    v_mul_f32 v49, s36, v35
    v_mul_f32 v50, v41, v37
    v_fma_f32 v50, -v43, v39, v50
    v_mul_f32 v51, v41, v39
    v_fma_f32 v51, v43, v37, v51
    ds_write_b128 v2, v[48:51] offset:1024
    v_and_b32 v10, 15, v1
    v_lshrrev_b32 v11, 4, v1
    v_cvt_f32_u32 v12, v10
    v_cmp_eq_u32 s[60:61], 0, v10
    v_mov_b32 v13, 16
    s_nop 0
    v_cndmask_b32 v13, v10, v13, s[60:61]
    v_lshlrev_b32 v13, 4, v13
    v_cvt_f32_u32 v13, v13
    v_lshlrev_b32 v14, 4, v11
    v_add_u32 v14, s41, v14
    v_add_u32 v14, 34480, v14
    s_mov_b32 s43, 0
    s_waitcnt lgkmcnt(0)
    v_mov_b32 v64, 0
    v_mov_b32 v65, 0
    v_mov_b32 v66, 0
    v_mov_b32 v67, 0
    v_mov_b32 v68, 0
    v_mov_b32 v69, 0
    v_mov_b32 v70, 0
    v_mov_b32 v71, 0
    v_mov_b32 v72, 0
    v_mov_b32 v73, 0
    v_mov_b32 v74, 0
    v_mov_b32 v75, 0
    v_mov_b32 v76, 0
    v_mov_b32 v77, 0
    v_mov_b32 v78, 0
    v_mov_b32 v79, 0
    ds_read_b128 v[48:51], v14
S4_KG:
    s_waitcnt lgkmcnt(0)
    v_mul_f32 v26, v48, v13
    v_mul_f32 v27, v49, v13
    v_mul_f32 v28, v48, v12
    v_mul_f32 v29, v49, v12
    v_mov_b32 v52, v50
    v_mov_b32 v53, v51
    v_add_u32 v14, 64, v14
    ds_read_b128 v[48:51], v14
    v_exp_f32 v26, v26
    v_fract_f32 v27, v27
    v_exp_f32 v28, v28
    v_fract_f32 v29, v29
    v_cos_f32 v20, v27
    v_sin_f32 v21, v27
    v_cos_f32 v22, v29
    v_sin_f32 v23, v29
    v_mul_f32 v20, v20, v26
    v_mul_f32 v21, v21, v26
    v_mul_f32 v22, v22, v28
    v_mul_f32 v23, v23, v28
    v_cndmask_b32 v30, v20, 1.0, s[60:61]
    v_cndmask_b32 v31, v21, 0, s[60:61]
    v_mul_f32 v54, v52, v30
    v_fma_f32 v54, -v53, v31, v54
    v_mul_f32 v55, v52, v31
    v_fma_f32 v55, v53, v30, v55
    v_mov_b32 v34, v22
    v_sub_f32 v35, 0, v23
    v_mul_f32 v26, v21, v21
    v_mul_f32 v27, v20, v21
    v_fma_f32 v20, v20, v20, -v26
    v_add_f32 v21, v27, v27
    v_mul_f32 v26, v23, v23
    v_mul_f32 v27, v22, v23
    v_fma_f32 v22, v22, v22, -v26
    v_add_f32 v23, v27, v27
    v_mfma_f32_16x16x4_f32 v[64:67], v54, v34, v[64:67]
    v_mfma_f32_16x16x4_f32 v[64:67], v55, v35, v[64:67]
    v_mul_f32 v56, v52, v20
    v_fma_f32 v56, -v53, v21, v56
    v_mul_f32 v57, v52, v21
    v_fma_f32 v57, v53, v20, v57
    v_mov_b32 v36, v22
    v_sub_f32 v37, 0, v23
    v_mul_f32 v26, v21, v21
    v_mul_f32 v27, v20, v21
    v_fma_f32 v20, v20, v20, -v26
    v_add_f32 v21, v27, v27
    v_mul_f32 v26, v23, v23
    v_mul_f32 v27, v22, v23
    v_fma_f32 v22, v22, v22, -v26
    v_add_f32 v23, v27, v27
    v_mfma_f32_16x16x4_f32 v[68:71], v56, v36, v[68:71]
    v_mfma_f32_16x16x4_f32 v[68:71], v57, v37, v[68:71]
    v_mul_f32 v58, v52, v20
    v_fma_f32 v58, -v53, v21, v58
    v_mul_f32 v59, v52, v21
    v_fma_f32 v59, v53, v20, v59
    v_mov_b32 v38, v22
    v_sub_f32 v39, 0, v23
    v_mul_f32 v26, v21, v21
    v_mul_f32 v27, v20, v21
    v_fma_f32 v20, v20, v20, -v26
    v_add_f32 v21, v27, v27
    v_mul_f32 v26, v23, v23
    v_mul_f32 v27, v22, v23
    v_fma_f32 v22, v22, v22, -v26
    v_add_f32 v23, v27, v27
    v_mfma_f32_16x16x4_f32 v[72:75], v58, v38, v[72:75]
    v_mfma_f32_16x16x4_f32 v[72:75], v59, v39, v[72:75]
    v_mul_f32 v60, v52, v20
    v_fma_f32 v60, -v53, v21, v60
    v_mul_f32 v61, v52, v21
    v_fma_f32 v61, v53, v20, v61
    v_mov_b32 v40, v22
    v_sub_f32 v41, 0, v23
    s_nop 0
    v_mfma_f32_16x16x4_f32 v[76:79], v60, v40, v[76:79]
    v_mfma_f32_16x16x4_f32 v[76:79], v61, v41, v[76:79]
    s_add_u32 s43, s43, 1
    s_cmp_lt_u32 s43, 32
    s_cbranch_scc1 S4_KG
    s_waitcnt lgkmcnt(0)
    s_nop 15
    v_lshl_add_u32 v14, v11, 6, v10
    v_lshlrev_b32 v14, 2, v14
    v_add_u32 v14, s41, v14
    v_add_u32 v14, 31904, v14
    v_cmp_gt_u32 vcc, 2, v11
    v_mov_b32 v15, 0x100000
    s_nop 0
    v_cndmask_b32 v15, v14, v15, vcc
    ds_write_b32 v14, v64 offset:0
    ds_write_b32 v14, v65 offset:64
    ds_write_b32 v14, v66 offset:128
    ds_write_b32 v14, v67 offset:192
    ds_write_b32 v15, v68 offset:512
    ds_write_b32 v15, v69 offset:576
    ds_write_b32 v15, v70 offset:640
    ds_write_b32 v15, v71 offset:704
    ds_write_b32 v15, v72 offset:1024
    ds_write_b32 v15, v73 offset:1088
    ds_write_b32 v15, v74 offset:1152
    ds_write_b32 v15, v75 offset:1216
    ds_write_b32 v15, v76 offset:1536
    ds_write_b32 v15, v77 offset:1600
    ds_write_b32 v15, v78 offset:1664
    ds_write_b32 v15, v79 offset:1728
    s_mov_b64 exec, 1
    ds_write_b32 v14, v76 offset:2560
    s_mov_b64 exec, -1
    v_lshlrev_b32 v16, 1, v1
    v_lshrrev_b32 v17, 4, v1
    v_mul_u32_u24 v17, 80, v17
    v_lshl_add_u32 v17, v10, 2, v17
    v_add_u32 v17, s41, v17
    s_add_u32 s35, s41, -36192
    s_add_u32 s36, s41, 31904
    s_mov_b32 s37, 0xffff0000
    s_waitcnt lgkmcnt(0)
    v_lshl_add_u32 v18, v16, 2, s36
    ds_read_b64 v[32:33], v18 offset:0
    v_lshl_add_u32 v18, v16, 2, s36
    ds_read_b64 v[34:35], v18 offset:512
    v_add_u32 v18, 256, v16
    v_add_u32 v19, 257, v16
    v_cvt_f32_u32 v18, v18
    v_cvt_f32_u32 v19, v19
    v_cvt_pk_bf16_f32 v18, v18, v19
    v_lshrrev_b32 v19, 16, v18
    v_and_b32 v18, 0xffff, v18
    v_lshl_add_u32 v18, v18, 2, s35
    v_lshl_add_u32 v19, v19, 2, s35
    ds_read_b32 v36, v18
    ds_read_b32 v37, v19
    v_add_u32 v18, 384, v16
    v_add_u32 v19, 385, v16
    v_cvt_f32_u32 v18, v18
    v_cvt_f32_u32 v19, v19
    v_cvt_pk_bf16_f32 v18, v18, v19
    v_lshrrev_b32 v19, 16, v18
    v_and_b32 v18, 0xffff, v18
    v_lshl_add_u32 v18, v18, 2, s35
    v_lshl_add_u32 v19, v19, 2, s35
    ds_read_b32 v38, v18
    ds_read_b32 v39, v19
    s_waitcnt lgkmcnt(0)
    v_add_u32 v18, 512, v16
    v_add_u32 v19, 513, v16
    v_cvt_f32_u32 v18, v18
    v_cvt_f32_u32 v19, v19
    v_cvt_pk_bf16_f32 v18, v18, v19
    v_lshrrev_b32 v19, 16, v18
    v_and_b32 v18, 0xffff, v18
    v_lshl_add_u32 v18, v18, 2, s35
    v_lshl_add_u32 v19, v19, 2, s35
    ds_read_b32 v40, v18
    ds_read_b32 v41, v19
    v_add_u32 v18, 640, v16
    v_add_u32 v19, 641, v16
    v_cvt_f32_u32 v18, v18
    v_cvt_f32_u32 v19, v19
    v_cvt_pk_bf16_f32 v18, v18, v19
    v_lshrrev_b32 v19, 16, v18
    v_and_b32 v18, 0xffff, v18
    v_lshl_add_u32 v18, v18, 2, s35
    v_lshl_add_u32 v19, v19, 2, s35
    ds_read_b32 v42, v18
    ds_read_b32 v43, v19
    v_add_u32 v18, 768, v16
    v_add_u32 v19, 769, v16
    v_cvt_f32_u32 v18, v18
    v_cvt_f32_u32 v19, v19
    v_cvt_pk_bf16_f32 v18, v18, v19
    v_lshrrev_b32 v19, 16, v18
    v_and_b32 v18, 0xffff, v18
    v_lshl_add_u32 v18, v18, 2, s35
    v_lshl_add_u32 v19, v19, 2, s35
    ds_read_b32 v44, v18
    ds_read_b32 v45, v19
    v_add_u32 v18, 896, v16
    v_add_u32 v19, 897, v16
    v_cvt_f32_u32 v18, v18
    v_cvt_f32_u32 v19, v19
    v_cvt_pk_bf16_f32 v18, v18, v19
    v_lshrrev_b32 v19, 16, v18
    v_and_b32 v18, 0xffff, v18
    v_lshl_add_u32 v18, v18, 2, s35
    v_lshl_add_u32 v19, v19, 2, s35
    ds_read_b32 v46, v18
    ds_read_b32 v47, v19
    s_waitcnt lgkmcnt(0)
    v_add_u32 v18, 1024, v16
    v_add_u32 v19, 1025, v16
    v_cvt_f32_u32 v18, v18
    v_cvt_f32_u32 v19, v19
    v_cvt_pk_bf16_f32 v18, v18, v19
    v_lshrrev_b32 v19, 16, v18
    v_and_b32 v18, 0xffff, v18
    v_lshl_add_u32 v18, v18, 2, s35
    v_lshl_add_u32 v19, v19, 2, s35
    ds_read_b32 v48, v18
    ds_read_b32 v49, v19
    v_add_u32 v18, 1152, v16
    v_add_u32 v19, 1153, v16
    v_cvt_f32_u32 v18, v18
    v_cvt_f32_u32 v19, v19
    v_cvt_pk_bf16_f32 v18, v18, v19
    v_lshrrev_b32 v19, 16, v18
    v_and_b32 v18, 0xffff, v18
    v_lshl_add_u32 v18, v18, 2, s35
    v_lshl_add_u32 v19, v19, 2, s35
    ds_read_b32 v50, v18
    ds_read_b32 v51, v19
    v_add_u32 v18, 1280, v16
    v_add_u32 v19, 1281, v16
    v_cvt_f32_u32 v18, v18
    v_cvt_f32_u32 v19, v19
    v_cvt_pk_bf16_f32 v18, v18, v19
    v_lshrrev_b32 v19, 16, v18
    v_and_b32 v18, 0xffff, v18
    v_lshl_add_u32 v18, v18, 2, s35
    v_lshl_add_u32 v19, v19, 2, s35
    ds_read_b32 v52, v18
    ds_read_b32 v53, v19
    v_add_u32 v18, 1408, v16
    v_add_u32 v19, 1409, v16
    v_cvt_f32_u32 v18, v18
    v_cvt_f32_u32 v19, v19
    v_cvt_pk_bf16_f32 v18, v18, v19
    v_lshrrev_b32 v19, 16, v18
    v_and_b32 v18, 0xffff, v18
    v_lshl_add_u32 v18, v18, 2, s35
    v_lshl_add_u32 v19, v19, 2, s35
    ds_read_b32 v54, v18
    ds_read_b32 v55, v19
    s_waitcnt lgkmcnt(0)
    v_add_u32 v18, 1536, v16
    v_add_u32 v19, 1537, v16
    v_cvt_f32_u32 v18, v18
    v_cvt_f32_u32 v19, v19
    v_cvt_pk_bf16_f32 v18, v18, v19
    v_lshrrev_b32 v19, 16, v18
    v_and_b32 v18, 0xffff, v18
    v_lshl_add_u32 v18, v18, 2, s35
    v_lshl_add_u32 v19, v19, 2, s35
    ds_read_b32 v56, v18
    ds_read_b32 v57, v19
    v_add_u32 v18, 1664, v16
    v_add_u32 v19, 1665, v16
    v_cvt_f32_u32 v18, v18
    v_cvt_f32_u32 v19, v19
    v_cvt_pk_bf16_f32 v18, v18, v19
    v_lshrrev_b32 v19, 16, v18
    v_and_b32 v18, 0xffff, v18
    v_lshl_add_u32 v18, v18, 2, s35
    v_lshl_add_u32 v19, v19, 2, s35
    ds_read_b32 v58, v18
    ds_read_b32 v59, v19
    v_add_u32 v18, 1792, v16
    v_add_u32 v19, 1793, v16
    v_cvt_f32_u32 v18, v18
    v_cvt_f32_u32 v19, v19
    v_cvt_pk_bf16_f32 v18, v18, v19
    v_lshrrev_b32 v19, 16, v18
    v_and_b32 v18, 0xffff, v18
    v_lshl_add_u32 v18, v18, 2, s35
    v_lshl_add_u32 v19, v19, 2, s35
    ds_read_b32 v60, v18
    ds_read_b32 v61, v19
    v_add_u32 v18, 1920, v16
    v_add_u32 v19, 1921, v16
    v_cvt_f32_u32 v18, v18
    v_cvt_f32_u32 v19, v19
    v_cvt_pk_bf16_f32 v18, v18, v19
    v_lshrrev_b32 v19, 16, v18
    v_and_b32 v18, 0xffff, v18
    v_lshl_add_u32 v18, v18, 2, s35
    v_lshl_add_u32 v19, v19, 2, s35
    ds_read_b32 v62, v18
    ds_read_b32 v63, v19
    s_waitcnt lgkmcnt(0)
    v_cvt_pk_bf16_f32 v18, v32, v33
    v_lshlrev_b32 v19, 16, v18
    v_and_b32 v20, s37, v18
    v_sub_f32 v19, v32, v19
    v_sub_f32 v20, v33, v20
    v_cvt_pk_bf16_f32 v19, v19, v20
    ds_write_b32 v17, v18 offset:19184
    ds_write_b32 v17, v19 offset:26784
    v_cvt_pk_bf16_f32 v18, v34, v35
    v_lshlrev_b32 v19, 16, v18
    v_and_b32 v20, s37, v18
    v_sub_f32 v19, v34, v19
    v_sub_f32 v20, v35, v20
    v_cvt_pk_bf16_f32 v19, v19, v20
    ds_write_b32 v17, v18 offset:19504
    ds_write_b32 v17, v19 offset:27104
    v_cvt_pk_bf16_f32 v18, v36, v37
    v_lshlrev_b32 v19, 16, v18
    v_and_b32 v20, s37, v18
    v_sub_f32 v19, v36, v19
    v_sub_f32 v20, v37, v20
    v_cvt_pk_bf16_f32 v19, v19, v20
    ds_write_b32 v17, v18 offset:19824
    ds_write_b32 v17, v19 offset:27424
    v_cvt_pk_bf16_f32 v18, v38, v39
    v_lshlrev_b32 v19, 16, v18
    v_and_b32 v20, s37, v18
    v_sub_f32 v19, v38, v19
    v_sub_f32 v20, v39, v20
    v_cvt_pk_bf16_f32 v19, v19, v20
    ds_write_b32 v17, v18 offset:20144
    ds_write_b32 v17, v19 offset:27744
    v_cvt_pk_bf16_f32 v18, v40, v41
    v_lshlrev_b32 v19, 16, v18
    v_and_b32 v20, s37, v18
    v_sub_f32 v19, v40, v19
    v_sub_f32 v20, v41, v20
    v_cvt_pk_bf16_f32 v19, v19, v20
    ds_write_b32 v17, v18 offset:20464
    ds_write_b32 v17, v19 offset:28064
    v_cvt_pk_bf16_f32 v18, v42, v43
    v_lshlrev_b32 v19, 16, v18
    v_and_b32 v20, s37, v18
    v_sub_f32 v19, v42, v19
    v_sub_f32 v20, v43, v20
    v_cvt_pk_bf16_f32 v19, v19, v20
    ds_write_b32 v17, v18 offset:20784
    ds_write_b32 v17, v19 offset:28384
    v_cvt_pk_bf16_f32 v18, v44, v45
    v_lshlrev_b32 v19, 16, v18
    v_and_b32 v20, s37, v18
    v_sub_f32 v19, v44, v19
    v_sub_f32 v20, v45, v20
    v_cvt_pk_bf16_f32 v19, v19, v20
    ds_write_b32 v17, v18 offset:21104
    ds_write_b32 v17, v19 offset:28704
    v_cvt_pk_bf16_f32 v18, v46, v47
    v_lshlrev_b32 v19, 16, v18
    v_and_b32 v20, s37, v18
    v_sub_f32 v19, v46, v19
    v_sub_f32 v20, v47, v20
    v_cvt_pk_bf16_f32 v19, v19, v20
    ds_write_b32 v17, v18 offset:21424
    ds_write_b32 v17, v19 offset:29024
    v_cvt_pk_bf16_f32 v18, v48, v49
    v_lshlrev_b32 v19, 16, v18
    v_and_b32 v20, s37, v18
    v_sub_f32 v19, v48, v19
    v_sub_f32 v20, v49, v20
    v_cvt_pk_bf16_f32 v19, v19, v20
    ds_write_b32 v17, v18 offset:21744
    ds_write_b32 v17, v19 offset:29344
    v_cvt_pk_bf16_f32 v18, v50, v51
    v_lshlrev_b32 v19, 16, v18
    v_and_b32 v20, s37, v18
    v_sub_f32 v19, v50, v19
    v_sub_f32 v20, v51, v20
    v_cvt_pk_bf16_f32 v19, v19, v20
    ds_write_b32 v17, v18 offset:22064
    ds_write_b32 v17, v19 offset:29664
    v_cvt_pk_bf16_f32 v18, v52, v53
    v_lshlrev_b32 v19, 16, v18
    v_and_b32 v20, s37, v18
    v_sub_f32 v19, v52, v19
    v_sub_f32 v20, v53, v20
    v_cvt_pk_bf16_f32 v19, v19, v20
    ds_write_b32 v17, v18 offset:22384
    ds_write_b32 v17, v19 offset:29984
    v_cvt_pk_bf16_f32 v18, v54, v55
    v_lshlrev_b32 v19, 16, v18
    v_and_b32 v20, s37, v18
    v_sub_f32 v19, v54, v19
    v_sub_f32 v20, v55, v20
    v_cvt_pk_bf16_f32 v19, v19, v20
    ds_write_b32 v17, v18 offset:22704
    ds_write_b32 v17, v19 offset:30304
    v_cvt_pk_bf16_f32 v18, v56, v57
    v_lshlrev_b32 v19, 16, v18
    v_and_b32 v20, s37, v18
    v_sub_f32 v19, v56, v19
    v_sub_f32 v20, v57, v20
    v_cvt_pk_bf16_f32 v19, v19, v20
    ds_write_b32 v17, v18 offset:23024
    ds_write_b32 v17, v19 offset:30624
    v_cvt_pk_bf16_f32 v18, v58, v59
    v_lshlrev_b32 v19, 16, v18
    v_and_b32 v20, s37, v18
    v_sub_f32 v19, v58, v19
    v_sub_f32 v20, v59, v20
    v_cvt_pk_bf16_f32 v19, v19, v20
    ds_write_b32 v17, v18 offset:23344
    ds_write_b32 v17, v19 offset:30944
    v_cvt_pk_bf16_f32 v18, v60, v61
    v_lshlrev_b32 v19, 16, v18
    v_and_b32 v20, s37, v18
    v_sub_f32 v19, v60, v19
    v_sub_f32 v20, v61, v20
    v_cvt_pk_bf16_f32 v19, v19, v20
    ds_write_b32 v17, v18 offset:23664
    ds_write_b32 v17, v19 offset:31264
    v_cvt_pk_bf16_f32 v18, v62, v63
    v_lshlrev_b32 v19, 16, v18
    v_and_b32 v20, s37, v18
    v_sub_f32 v19, v62, v19
    v_sub_f32 v20, v63, v20
    v_cvt_pk_bf16_f32 v19, v19, v20
    ds_write_b32 v17, v18 offset:23984
    ds_write_b32 v17, v19 offset:31584
    v_and_b32 v10, 31, v1
    v_lshrrev_b32 v11, 5, v1
    v_add_u32 v12, 1, v10
    v_and_b32 v12, 3, v12
    v_mul_u32_u24 v13, 4178, v12
    v_lshlrev_b32 v14, 3, v11
    v_sub_u32 v14, v14, v10
    v_add_u32 v14, 31, v14
    v_lshl_add_u32 v13, v14, 1, v13
    v_add_u32 v13, s41, v13
    v_mul_u32_u24 v14, 80, v10
    v_lshl_add_u32 v14, v11, 4, v14
    v_add_u32 v14, s41, v14
    s_waitcnt lgkmcnt(0)
    s_barrier
    ds_read_b128 v[32:35], v13 offset:4032
    ds_read_b128 v[36:39], v14 offset:19184
    ds_read_b128 v[40:43], v14 offset:26784
    ds_read_b128 v[44:47], v14 offset:21744
    ds_read_b128 v[48:51], v14 offset:29344
    ds_read_b128 v[52:55], v13 offset:4064
    ds_read_b128 v[56:59], v14 offset:19216
    ds_read_b128 v[60:63], v14 offset:26816
    ds_read_b128 v[64:67], v14 offset:21776
    ds_read_b128 v[68:71], v14 offset:29376
    ds_read_b128 v[72:75], v13 offset:3968
    ds_read_b128 v[76:79], v14 offset:19104
    ds_read_b128 v[80:83], v14 offset:26704
    ds_read_b128 v[84:87], v14 offset:21664
    ds_read_b128 v[88:91], v14 offset:29264
    s_waitcnt lgkmcnt(10)
    v_mfma_f32_32x32x16_bf16 a[0:15], v[32:35], v[36:39], 0
    v_mfma_f32_32x32x16_bf16 a[0:15], v[32:35], v[40:43], a[0:15]
    v_mfma_f32_32x32x16_bf16 a[16:31], v[32:35], v[44:47], 0
    v_mfma_f32_32x32x16_bf16 a[16:31], v[32:35], v[48:51], a[16:31]
    ds_read_b128 v[32:35], v13 offset:4000
    ds_read_b128 v[36:39], v14 offset:19136
    ds_read_b128 v[40:43], v14 offset:26736
    ds_read_b128 v[44:47], v14 offset:21696
    ds_read_b128 v[48:51], v14 offset:29296
    s_waitcnt lgkmcnt(10)
    v_mfma_f32_32x32x16_bf16 a[0:15], v[52:55], v[56:59], a[0:15]
    v_mfma_f32_32x32x16_bf16 a[0:15], v[52:55], v[60:63], a[0:15]
    v_mfma_f32_32x32x16_bf16 a[16:31], v[52:55], v[64:67], a[16:31]
    v_mfma_f32_32x32x16_bf16 a[16:31], v[52:55], v[68:71], a[16:31]
    ds_read_b128 v[52:55], v13 offset:3904
    ds_read_b128 v[56:59], v14 offset:19024
    ds_read_b128 v[60:63], v14 offset:26624
    ds_read_b128 v[64:67], v14 offset:21584
    ds_read_b128 v[68:71], v14 offset:29184
    s_waitcnt lgkmcnt(10)
    v_mfma_f32_32x32x16_bf16 a[0:15], v[72:75], v[76:79], a[0:15]
    v_mfma_f32_32x32x16_bf16 a[0:15], v[72:75], v[80:83], a[0:15]
    v_mfma_f32_32x32x16_bf16 a[16:31], v[72:75], v[84:87], a[16:31]
    v_mfma_f32_32x32x16_bf16 a[16:31], v[72:75], v[88:91], a[16:31]
    ds_read_b128 v[72:75], v13 offset:3936
    ds_read_b128 v[76:79], v14 offset:19056
    ds_read_b128 v[80:83], v14 offset:26656
    ds_read_b128 v[84:87], v14 offset:21616
    ds_read_b128 v[88:91], v14 offset:29216
    s_waitcnt lgkmcnt(10)
    v_mfma_f32_32x32x16_bf16 a[0:15], v[32:35], v[36:39], a[0:15]
    v_mfma_f32_32x32x16_bf16 a[0:15], v[32:35], v[40:43], a[0:15]
    v_mfma_f32_32x32x16_bf16 a[16:31], v[32:35], v[44:47], a[16:31]
    v_mfma_f32_32x32x16_bf16 a[16:31], v[32:35], v[48:51], a[16:31]
    ds_read_b128 v[32:35], v13 offset:3840
    ds_read_b128 v[36:39], v14 offset:18944
    ds_read_b128 v[40:43], v14 offset:26544
    ds_read_b128 v[44:47], v14 offset:21504
    ds_read_b128 v[48:51], v14 offset:29104
    s_waitcnt lgkmcnt(10)
    v_mfma_f32_32x32x16_bf16 a[0:15], v[52:55], v[56:59], a[0:15]
    v_mfma_f32_32x32x16_bf16 a[0:15], v[52:55], v[60:63], a[0:15]
    v_mfma_f32_32x32x16_bf16 a[16:31], v[52:55], v[64:67], a[16:31]
    v_mfma_f32_32x32x16_bf16 a[16:31], v[52:55], v[68:71], a[16:31]
    ds_read_b128 v[52:55], v13 offset:3872
    ds_read_b128 v[56:59], v14 offset:18976
    ds_read_b128 v[60:63], v14 offset:26576
    ds_read_b128 v[64:67], v14 offset:21536
    ds_read_b128 v[68:71], v14 offset:29136
    s_waitcnt lgkmcnt(10)
    v_mfma_f32_32x32x16_bf16 a[0:15], v[72:75], v[76:79], a[0:15]
    v_mfma_f32_32x32x16_bf16 a[0:15], v[72:75], v[80:83], a[0:15]
    v_mfma_f32_32x32x16_bf16 a[16:31], v[72:75], v[84:87], a[16:31]
    v_mfma_f32_32x32x16_bf16 a[16:31], v[72:75], v[88:91], a[16:31]
    ds_read_b128 v[72:75], v13 offset:3776
    ds_read_b128 v[76:79], v14 offset:18864
    ds_read_b128 v[80:83], v14 offset:26464
    ds_read_b128 v[84:87], v14 offset:21424
    ds_read_b128 v[88:91], v14 offset:29024
    s_waitcnt lgkmcnt(10)
    v_mfma_f32_32x32x16_bf16 a[0:15], v[32:35], v[36:39], a[0:15]
    v_mfma_f32_32x32x16_bf16 a[0:15], v[32:35], v[40:43], a[0:15]
    v_mfma_f32_32x32x16_bf16 a[16:31], v[32:35], v[44:47], a[16:31]
    v_mfma_f32_32x32x16_bf16 a[16:31], v[32:35], v[48:51], a[16:31]
    ds_read_b128 v[32:35], v13 offset:3808
    ds_read_b128 v[36:39], v14 offset:18896
    ds_read_b128 v[40:43], v14 offset:26496
    ds_read_b128 v[44:47], v14 offset:21456
    ds_read_b128 v[48:51], v14 offset:29056
    s_waitcnt lgkmcnt(10)
    v_mfma_f32_32x32x16_bf16 a[0:15], v[52:55], v[56:59], a[0:15]
    v_mfma_f32_32x32x16_bf16 a[0:15], v[52:55], v[60:63], a[0:15]
    v_mfma_f32_32x32x16_bf16 a[16:31], v[52:55], v[64:67], a[16:31]
    v_mfma_f32_32x32x16_bf16 a[16:31], v[52:55], v[68:71], a[16:31]
    ds_read_b128 v[52:55], v13 offset:3712
    ds_read_b128 v[56:59], v14 offset:18784
    ds_read_b128 v[60:63], v14 offset:26384
    ds_read_b128 v[64:67], v14 offset:21344
    ds_read_b128 v[68:71], v14 offset:28944
    s_waitcnt lgkmcnt(10)
    v_mfma_f32_32x32x16_bf16 a[0:15], v[72:75], v[76:79], a[0:15]
    v_mfma_f32_32x32x16_bf16 a[0:15], v[72:75], v[80:83], a[0:15]
    v_mfma_f32_32x32x16_bf16 a[16:31], v[72:75], v[84:87], a[16:31]
    v_mfma_f32_32x32x16_bf16 a[16:31], v[72:75], v[88:91], a[16:31]
    ds_read_b128 v[72:75], v13 offset:3744
    ds_read_b128 v[76:79], v14 offset:18816
    ds_read_b128 v[80:83], v14 offset:26416
    ds_read_b128 v[84:87], v14 offset:21376
    ds_read_b128 v[88:91], v14 offset:28976
    s_waitcnt lgkmcnt(10)
    v_mfma_f32_32x32x16_bf16 a[0:15], v[32:35], v[36:39], a[0:15]
    v_mfma_f32_32x32x16_bf16 a[0:15], v[32:35], v[40:43], a[0:15]
    v_mfma_f32_32x32x16_bf16 a[16:31], v[32:35], v[44:47], a[16:31]
    v_mfma_f32_32x32x16_bf16 a[16:31], v[32:35], v[48:51], a[16:31]
    ds_read_b128 v[32:35], v13 offset:3648
    ds_read_b128 v[36:39], v14 offset:18704
    ds_read_b128 v[40:43], v14 offset:26304
    ds_read_b128 v[44:47], v14 offset:21264
    ds_read_b128 v[48:51], v14 offset:28864
    s_waitcnt lgkmcnt(10)
    v_mfma_f32_32x32x16_bf16 a[0:15], v[52:55], v[56:59], a[0:15]
    v_mfma_f32_32x32x16_bf16 a[0:15], v[52:55], v[60:63], a[0:15]
    v_mfma_f32_32x32x16_bf16 a[16:31], v[52:55], v[64:67], a[16:31]
    v_mfma_f32_32x32x16_bf16 a[16:31], v[52:55], v[68:71], a[16:31]
    ds_read_b128 v[52:55], v13 offset:3680
    ds_read_b128 v[56:59], v14 offset:18736
    ds_read_b128 v[60:63], v14 offset:26336
    ds_read_b128 v[64:67], v14 offset:21296
    ds_read_b128 v[68:71], v14 offset:28896
    s_waitcnt lgkmcnt(10)
    v_mfma_f32_32x32x16_bf16 a[0:15], v[72:75], v[76:79], a[0:15]
    v_mfma_f32_32x32x16_bf16 a[0:15], v[72:75], v[80:83], a[0:15]
    v_mfma_f32_32x32x16_bf16 a[16:31], v[72:75], v[84:87], a[16:31]
    v_mfma_f32_32x32x16_bf16 a[16:31], v[72:75], v[88:91], a[16:31]
    ds_read_b128 v[72:75], v13 offset:3584
    ds_read_b128 v[76:79], v14 offset:18624
    ds_read_b128 v[80:83], v14 offset:26224
    ds_read_b128 v[84:87], v14 offset:21184
    ds_read_b128 v[88:91], v14 offset:28784
    s_waitcnt lgkmcnt(10)
    v_mfma_f32_32x32x16_bf16 a[0:15], v[32:35], v[36:39], a[0:15]
    v_mfma_f32_32x32x16_bf16 a[0:15], v[32:35], v[40:43], a[0:15]
    v_mfma_f32_32x32x16_bf16 a[16:31], v[32:35], v[44:47], a[16:31]
    v_mfma_f32_32x32x16_bf16 a[16:31], v[32:35], v[48:51], a[16:31]
    ds_read_b128 v[32:35], v13 offset:3616
    ds_read_b128 v[36:39], v14 offset:18656
    ds_read_b128 v[40:43], v14 offset:26256
    ds_read_b128 v[44:47], v14 offset:21216
    ds_read_b128 v[48:51], v14 offset:28816
    s_waitcnt lgkmcnt(10)
    v_mfma_f32_32x32x16_bf16 a[0:15], v[52:55], v[56:59], a[0:15]
    v_mfma_f32_32x32x16_bf16 a[0:15], v[52:55], v[60:63], a[0:15]
    v_mfma_f32_32x32x16_bf16 a[16:31], v[52:55], v[64:67], a[16:31]
    v_mfma_f32_32x32x16_bf16 a[16:31], v[52:55], v[68:71], a[16:31]
    ds_read_b128 v[52:55], v13 offset:3520
    ds_read_b128 v[56:59], v14 offset:18544
    ds_read_b128 v[60:63], v14 offset:26144
    ds_read_b128 v[64:67], v14 offset:21104
    ds_read_b128 v[68:71], v14 offset:28704
    s_waitcnt lgkmcnt(10)
    v_mfma_f32_32x32x16_bf16 a[0:15], v[72:75], v[76:79], a[0:15]
    v_mfma_f32_32x32x16_bf16 a[0:15], v[72:75], v[80:83], a[0:15]
    v_mfma_f32_32x32x16_bf16 a[16:31], v[72:75], v[84:87], a[16:31]
    v_mfma_f32_32x32x16_bf16 a[16:31], v[72:75], v[88:91], a[16:31]
    ds_read_b128 v[72:75], v13 offset:3552
    ds_read_b128 v[76:79], v14 offset:18576
    ds_read_b128 v[80:83], v14 offset:26176
    ds_read_b128 v[84:87], v14 offset:21136
    ds_read_b128 v[88:91], v14 offset:28736
    s_waitcnt lgkmcnt(10)
    v_mfma_f32_32x32x16_bf16 a[0:15], v[32:35], v[36:39], a[0:15]
    v_mfma_f32_32x32x16_bf16 a[0:15], v[32:35], v[40:43], a[0:15]
    v_mfma_f32_32x32x16_bf16 a[16:31], v[32:35], v[44:47], a[16:31]
    v_mfma_f32_32x32x16_bf16 a[16:31], v[32:35], v[48:51], a[16:31]
    ds_read_b128 v[32:35], v13 offset:3456
    ds_read_b128 v[36:39], v14 offset:18464
    ds_read_b128 v[40:43], v14 offset:26064
    ds_read_b128 v[44:47], v14 offset:21024
    ds_read_b128 v[48:51], v14 offset:28624
    s_waitcnt lgkmcnt(10)
    v_mfma_f32_32x32x16_bf16 a[0:15], v[52:55], v[56:59], a[0:15]
    v_mfma_f32_32x32x16_bf16 a[0:15], v[52:55], v[60:63], a[0:15]
    v_mfma_f32_32x32x16_bf16 a[16:31], v[52:55], v[64:67], a[16:31]
    v_mfma_f32_32x32x16_bf16 a[16:31], v[52:55], v[68:71], a[16:31]
    ds_read_b128 v[52:55], v13 offset:3488
    ds_read_b128 v[56:59], v14 offset:18496
    ds_read_b128 v[60:63], v14 offset:26096
    ds_read_b128 v[64:67], v14 offset:21056
    ds_read_b128 v[68:71], v14 offset:28656
    s_waitcnt lgkmcnt(10)
    v_mfma_f32_32x32x16_bf16 a[0:15], v[72:75], v[76:79], a[0:15]
    v_mfma_f32_32x32x16_bf16 a[0:15], v[72:75], v[80:83], a[0:15]
    v_mfma_f32_32x32x16_bf16 a[16:31], v[72:75], v[84:87], a[16:31]
    v_mfma_f32_32x32x16_bf16 a[16:31], v[72:75], v[88:91], a[16:31]
    ds_read_b128 v[72:75], v13 offset:3392
    ds_read_b128 v[76:79], v14 offset:18384
    ds_read_b128 v[80:83], v14 offset:25984
    ds_read_b128 v[84:87], v14 offset:20944
    ds_read_b128 v[88:91], v14 offset:28544
    s_waitcnt lgkmcnt(10)
    v_mfma_f32_32x32x16_bf16 a[0:15], v[32:35], v[36:39], a[0:15]
    v_mfma_f32_32x32x16_bf16 a[0:15], v[32:35], v[40:43], a[0:15]
    v_mfma_f32_32x32x16_bf16 a[16:31], v[32:35], v[44:47], a[16:31]
    v_mfma_f32_32x32x16_bf16 a[16:31], v[32:35], v[48:51], a[16:31]
    ds_read_b128 v[32:35], v13 offset:3424
    ds_read_b128 v[36:39], v14 offset:18416
    ds_read_b128 v[40:43], v14 offset:26016
    ds_read_b128 v[44:47], v14 offset:20976
    ds_read_b128 v[48:51], v14 offset:28576
    s_waitcnt lgkmcnt(10)
    v_mfma_f32_32x32x16_bf16 a[0:15], v[52:55], v[56:59], a[0:15]
    v_mfma_f32_32x32x16_bf16 a[0:15], v[52:55], v[60:63], a[0:15]
    v_mfma_f32_32x32x16_bf16 a[16:31], v[52:55], v[64:67], a[16:31]
    v_mfma_f32_32x32x16_bf16 a[16:31], v[52:55], v[68:71], a[16:31]
    ds_read_b128 v[52:55], v13 offset:3328
    ds_read_b128 v[56:59], v14 offset:18304
    ds_read_b128 v[60:63], v14 offset:25904
    ds_read_b128 v[64:67], v14 offset:20864
    ds_read_b128 v[68:71], v14 offset:28464
    s_waitcnt lgkmcnt(10)
    v_mfma_f32_32x32x16_bf16 a[0:15], v[72:75], v[76:79], a[0:15]
    v_mfma_f32_32x32x16_bf16 a[0:15], v[72:75], v[80:83], a[0:15]
    v_mfma_f32_32x32x16_bf16 a[16:31], v[72:75], v[84:87], a[16:31]
    v_mfma_f32_32x32x16_bf16 a[16:31], v[72:75], v[88:91], a[16:31]
    ds_read_b128 v[72:75], v13 offset:3360
    ds_read_b128 v[76:79], v14 offset:18336
    ds_read_b128 v[80:83], v14 offset:25936
    ds_read_b128 v[84:87], v14 offset:20896
    ds_read_b128 v[88:91], v14 offset:28496
    s_waitcnt lgkmcnt(10)
    v_mfma_f32_32x32x16_bf16 a[0:15], v[32:35], v[36:39], a[0:15]
    v_mfma_f32_32x32x16_bf16 a[0:15], v[32:35], v[40:43], a[0:15]
    v_mfma_f32_32x32x16_bf16 a[16:31], v[32:35], v[44:47], a[16:31]
    v_mfma_f32_32x32x16_bf16 a[16:31], v[32:35], v[48:51], a[16:31]
    ds_read_b128 v[32:35], v13 offset:3264
    ds_read_b128 v[36:39], v14 offset:18224
    ds_read_b128 v[40:43], v14 offset:25824
    ds_read_b128 v[44:47], v14 offset:20784
    ds_read_b128 v[48:51], v14 offset:28384
    s_waitcnt lgkmcnt(10)
    v_mfma_f32_32x32x16_bf16 a[0:15], v[52:55], v[56:59], a[0:15]
    v_mfma_f32_32x32x16_bf16 a[0:15], v[52:55], v[60:63], a[0:15]
    v_mfma_f32_32x32x16_bf16 a[16:31], v[52:55], v[64:67], a[16:31]
    v_mfma_f32_32x32x16_bf16 a[16:31], v[52:55], v[68:71], a[16:31]
    ds_read_b128 v[52:55], v13 offset:3296
    ds_read_b128 v[56:59], v14 offset:18256
    ds_read_b128 v[60:63], v14 offset:25856
    ds_read_b128 v[64:67], v14 offset:20816
    ds_read_b128 v[68:71], v14 offset:28416
    s_waitcnt lgkmcnt(10)
    v_mfma_f32_32x32x16_bf16 a[0:15], v[72:75], v[76:79], a[0:15]
    v_mfma_f32_32x32x16_bf16 a[0:15], v[72:75], v[80:83], a[0:15]
    v_mfma_f32_32x32x16_bf16 a[16:31], v[72:75], v[84:87], a[16:31]
    v_mfma_f32_32x32x16_bf16 a[16:31], v[72:75], v[88:91], a[16:31]
    ds_read_b128 v[72:75], v13 offset:3200
    ds_read_b128 v[76:79], v14 offset:18144
    ds_read_b128 v[80:83], v14 offset:25744
    ds_read_b128 v[84:87], v14 offset:20704
    ds_read_b128 v[88:91], v14 offset:28304
    s_waitcnt lgkmcnt(10)
    v_mfma_f32_32x32x16_bf16 a[0:15], v[32:35], v[36:39], a[0:15]
    v_mfma_f32_32x32x16_bf16 a[0:15], v[32:35], v[40:43], a[0:15]
    v_mfma_f32_32x32x16_bf16 a[16:31], v[32:35], v[44:47], a[16:31]
    v_mfma_f32_32x32x16_bf16 a[16:31], v[32:35], v[48:51], a[16:31]
    ds_read_b128 v[32:35], v13 offset:3232
    ds_read_b128 v[36:39], v14 offset:18176
    ds_read_b128 v[40:43], v14 offset:25776
    ds_read_b128 v[44:47], v14 offset:20736
    ds_read_b128 v[48:51], v14 offset:28336
    s_waitcnt lgkmcnt(10)
    v_mfma_f32_32x32x16_bf16 a[0:15], v[52:55], v[56:59], a[0:15]
    v_mfma_f32_32x32x16_bf16 a[0:15], v[52:55], v[60:63], a[0:15]
    v_mfma_f32_32x32x16_bf16 a[16:31], v[52:55], v[64:67], a[16:31]
    v_mfma_f32_32x32x16_bf16 a[16:31], v[52:55], v[68:71], a[16:31]
    ds_read_b128 v[52:55], v13 offset:3136
    ds_read_b128 v[56:59], v14 offset:18064
    ds_read_b128 v[60:63], v14 offset:25664
    ds_read_b128 v[64:67], v14 offset:20624
    ds_read_b128 v[68:71], v14 offset:28224
    s_waitcnt lgkmcnt(10)
    v_mfma_f32_32x32x16_bf16 a[0:15], v[72:75], v[76:79], a[0:15]
    v_mfma_f32_32x32x16_bf16 a[0:15], v[72:75], v[80:83], a[0:15]
    v_mfma_f32_32x32x16_bf16 a[16:31], v[72:75], v[84:87], a[16:31]
    v_mfma_f32_32x32x16_bf16 a[16:31], v[72:75], v[88:91], a[16:31]
    ds_read_b128 v[72:75], v13 offset:3168
    ds_read_b128 v[76:79], v14 offset:18096
    ds_read_b128 v[80:83], v14 offset:25696
    ds_read_b128 v[84:87], v14 offset:20656
    ds_read_b128 v[88:91], v14 offset:28256
    s_waitcnt lgkmcnt(10)
    v_mfma_f32_32x32x16_bf16 a[0:15], v[32:35], v[36:39], a[0:15]
    v_mfma_f32_32x32x16_bf16 a[0:15], v[32:35], v[40:43], a[0:15]
    v_mfma_f32_32x32x16_bf16 a[16:31], v[32:35], v[44:47], a[16:31]
    v_mfma_f32_32x32x16_bf16 a[16:31], v[32:35], v[48:51], a[16:31]
    ds_read_b128 v[32:35], v13 offset:3072
    ds_read_b128 v[36:39], v14 offset:17984
    ds_read_b128 v[40:43], v14 offset:25584
    ds_read_b128 v[44:47], v14 offset:20544
    ds_read_b128 v[48:51], v14 offset:28144
    s_waitcnt lgkmcnt(10)
    v_mfma_f32_32x32x16_bf16 a[0:15], v[52:55], v[56:59], a[0:15]
    v_mfma_f32_32x32x16_bf16 a[0:15], v[52:55], v[60:63], a[0:15]
    v_mfma_f32_32x32x16_bf16 a[16:31], v[52:55], v[64:67], a[16:31]
    v_mfma_f32_32x32x16_bf16 a[16:31], v[52:55], v[68:71], a[16:31]
    ds_read_b128 v[52:55], v13 offset:3104
    ds_read_b128 v[56:59], v14 offset:18016
    ds_read_b128 v[60:63], v14 offset:25616
    ds_read_b128 v[64:67], v14 offset:20576
    ds_read_b128 v[68:71], v14 offset:28176
    s_waitcnt lgkmcnt(10)
    v_mfma_f32_32x32x16_bf16 a[0:15], v[72:75], v[76:79], a[0:15]
    v_mfma_f32_32x32x16_bf16 a[0:15], v[72:75], v[80:83], a[0:15]
    v_mfma_f32_32x32x16_bf16 a[16:31], v[72:75], v[84:87], a[16:31]
    v_mfma_f32_32x32x16_bf16 a[16:31], v[72:75], v[88:91], a[16:31]
    ds_read_b128 v[72:75], v13 offset:3008
    ds_read_b128 v[76:79], v14 offset:17904
    ds_read_b128 v[80:83], v14 offset:25504
    ds_read_b128 v[84:87], v14 offset:20464
    ds_read_b128 v[88:91], v14 offset:28064
    s_waitcnt lgkmcnt(10)
    v_mfma_f32_32x32x16_bf16 a[0:15], v[32:35], v[36:39], a[0:15]
    v_mfma_f32_32x32x16_bf16 a[0:15], v[32:35], v[40:43], a[0:15]
    v_mfma_f32_32x32x16_bf16 a[16:31], v[32:35], v[44:47], a[16:31]
    v_mfma_f32_32x32x16_bf16 a[16:31], v[32:35], v[48:51], a[16:31]
    ds_read_b128 v[32:35], v13 offset:3040
    ds_read_b128 v[36:39], v14 offset:17936
    ds_read_b128 v[40:43], v14 offset:25536
    ds_read_b128 v[44:47], v14 offset:20496
    ds_read_b128 v[48:51], v14 offset:28096
    s_waitcnt lgkmcnt(10)
    v_mfma_f32_32x32x16_bf16 a[0:15], v[52:55], v[56:59], a[0:15]
    v_mfma_f32_32x32x16_bf16 a[0:15], v[52:55], v[60:63], a[0:15]
    v_mfma_f32_32x32x16_bf16 a[16:31], v[52:55], v[64:67], a[16:31]
    v_mfma_f32_32x32x16_bf16 a[16:31], v[52:55], v[68:71], a[16:31]
    ds_read_b128 v[52:55], v13 offset:2944
    ds_read_b128 v[56:59], v14 offset:17824
    ds_read_b128 v[60:63], v14 offset:25424
    ds_read_b128 v[64:67], v14 offset:20384
    ds_read_b128 v[68:71], v14 offset:27984
    s_waitcnt lgkmcnt(10)
    v_mfma_f32_32x32x16_bf16 a[0:15], v[72:75], v[76:79], a[0:15]
    v_mfma_f32_32x32x16_bf16 a[0:15], v[72:75], v[80:83], a[0:15]
    v_mfma_f32_32x32x16_bf16 a[16:31], v[72:75], v[84:87], a[16:31]
    v_mfma_f32_32x32x16_bf16 a[16:31], v[72:75], v[88:91], a[16:31]
    ds_read_b128 v[72:75], v13 offset:2976
    ds_read_b128 v[76:79], v14 offset:17856
    ds_read_b128 v[80:83], v14 offset:25456
    ds_read_b128 v[84:87], v14 offset:20416
    ds_read_b128 v[88:91], v14 offset:28016
    s_waitcnt lgkmcnt(10)
    v_mfma_f32_32x32x16_bf16 a[0:15], v[32:35], v[36:39], a[0:15]
    v_mfma_f32_32x32x16_bf16 a[0:15], v[32:35], v[40:43], a[0:15]
    v_mfma_f32_32x32x16_bf16 a[16:31], v[32:35], v[44:47], a[16:31]
    v_mfma_f32_32x32x16_bf16 a[16:31], v[32:35], v[48:51], a[16:31]
    ds_read_b128 v[32:35], v13 offset:2880
    ds_read_b128 v[36:39], v14 offset:17744
    ds_read_b128 v[40:43], v14 offset:25344
    ds_read_b128 v[44:47], v14 offset:20304
    ds_read_b128 v[48:51], v14 offset:27904
    s_waitcnt lgkmcnt(10)
    v_mfma_f32_32x32x16_bf16 a[0:15], v[52:55], v[56:59], a[0:15]
    v_mfma_f32_32x32x16_bf16 a[0:15], v[52:55], v[60:63], a[0:15]
    v_mfma_f32_32x32x16_bf16 a[16:31], v[52:55], v[64:67], a[16:31]
    v_mfma_f32_32x32x16_bf16 a[16:31], v[52:55], v[68:71], a[16:31]
    ds_read_b128 v[52:55], v13 offset:2912
    ds_read_b128 v[56:59], v14 offset:17776
    ds_read_b128 v[60:63], v14 offset:25376
    ds_read_b128 v[64:67], v14 offset:20336
    ds_read_b128 v[68:71], v14 offset:27936
    s_waitcnt lgkmcnt(10)
    v_mfma_f32_32x32x16_bf16 a[0:15], v[72:75], v[76:79], a[0:15]
    v_mfma_f32_32x32x16_bf16 a[0:15], v[72:75], v[80:83], a[0:15]
    v_mfma_f32_32x32x16_bf16 a[16:31], v[72:75], v[84:87], a[16:31]
    v_mfma_f32_32x32x16_bf16 a[16:31], v[72:75], v[88:91], a[16:31]
    ds_read_b128 v[72:75], v13 offset:2816
    ds_read_b128 v[76:79], v14 offset:17664
    ds_read_b128 v[80:83], v14 offset:25264
    ds_read_b128 v[84:87], v14 offset:20224
    ds_read_b128 v[88:91], v14 offset:27824
    s_waitcnt lgkmcnt(10)
    v_mfma_f32_32x32x16_bf16 a[0:15], v[32:35], v[36:39], a[0:15]
    v_mfma_f32_32x32x16_bf16 a[0:15], v[32:35], v[40:43], a[0:15]
    v_mfma_f32_32x32x16_bf16 a[16:31], v[32:35], v[44:47], a[16:31]
    v_mfma_f32_32x32x16_bf16 a[16:31], v[32:35], v[48:51], a[16:31]
    ds_read_b128 v[32:35], v13 offset:2848
    ds_read_b128 v[36:39], v14 offset:17696
    ds_read_b128 v[40:43], v14 offset:25296
    ds_read_b128 v[44:47], v14 offset:20256
    ds_read_b128 v[48:51], v14 offset:27856
    s_waitcnt lgkmcnt(10)
    v_mfma_f32_32x32x16_bf16 a[0:15], v[52:55], v[56:59], a[0:15]
    v_mfma_f32_32x32x16_bf16 a[0:15], v[52:55], v[60:63], a[0:15]
    v_mfma_f32_32x32x16_bf16 a[16:31], v[52:55], v[64:67], a[16:31]
    v_mfma_f32_32x32x16_bf16 a[16:31], v[52:55], v[68:71], a[16:31]
    ds_read_b128 v[52:55], v13 offset:2752
    ds_read_b128 v[56:59], v14 offset:17584
    ds_read_b128 v[60:63], v14 offset:25184
    ds_read_b128 v[64:67], v14 offset:20144
    ds_read_b128 v[68:71], v14 offset:27744
    s_waitcnt lgkmcnt(10)
    v_mfma_f32_32x32x16_bf16 a[0:15], v[72:75], v[76:79], a[0:15]
    v_mfma_f32_32x32x16_bf16 a[0:15], v[72:75], v[80:83], a[0:15]
    v_mfma_f32_32x32x16_bf16 a[16:31], v[72:75], v[84:87], a[16:31]
    v_mfma_f32_32x32x16_bf16 a[16:31], v[72:75], v[88:91], a[16:31]
    ds_read_b128 v[72:75], v13 offset:2784
    ds_read_b128 v[76:79], v14 offset:17616
    ds_read_b128 v[80:83], v14 offset:25216
    ds_read_b128 v[84:87], v14 offset:20176
    ds_read_b128 v[88:91], v14 offset:27776
    s_waitcnt lgkmcnt(10)
    v_mfma_f32_32x32x16_bf16 a[0:15], v[32:35], v[36:39], a[0:15]
    v_mfma_f32_32x32x16_bf16 a[0:15], v[32:35], v[40:43], a[0:15]
    v_mfma_f32_32x32x16_bf16 a[16:31], v[32:35], v[44:47], a[16:31]
    v_mfma_f32_32x32x16_bf16 a[16:31], v[32:35], v[48:51], a[16:31]
    ds_read_b128 v[32:35], v13 offset:2688
    ds_read_b128 v[36:39], v14 offset:17504
    ds_read_b128 v[40:43], v14 offset:25104
    ds_read_b128 v[44:47], v14 offset:20064
    ds_read_b128 v[48:51], v14 offset:27664
    s_waitcnt lgkmcnt(10)
    v_mfma_f32_32x32x16_bf16 a[0:15], v[52:55], v[56:59], a[0:15]
    v_mfma_f32_32x32x16_bf16 a[0:15], v[52:55], v[60:63], a[0:15]
    v_mfma_f32_32x32x16_bf16 a[16:31], v[52:55], v[64:67], a[16:31]
    v_mfma_f32_32x32x16_bf16 a[16:31], v[52:55], v[68:71], a[16:31]
    ds_read_b128 v[52:55], v13 offset:2720
    ds_read_b128 v[56:59], v14 offset:17536
    ds_read_b128 v[60:63], v14 offset:25136
    ds_read_b128 v[64:67], v14 offset:20096
    ds_read_b128 v[68:71], v14 offset:27696
    s_waitcnt lgkmcnt(10)
    v_mfma_f32_32x32x16_bf16 a[0:15], v[72:75], v[76:79], a[0:15]
    v_mfma_f32_32x32x16_bf16 a[0:15], v[72:75], v[80:83], a[0:15]
    v_mfma_f32_32x32x16_bf16 a[16:31], v[72:75], v[84:87], a[16:31]
    v_mfma_f32_32x32x16_bf16 a[16:31], v[72:75], v[88:91], a[16:31]
    ds_read_b128 v[72:75], v13 offset:2624
    ds_read_b128 v[76:79], v14 offset:17424
    ds_read_b128 v[80:83], v14 offset:25024
    ds_read_b128 v[84:87], v14 offset:19984
    ds_read_b128 v[88:91], v14 offset:27584
    s_waitcnt lgkmcnt(10)
    v_mfma_f32_32x32x16_bf16 a[0:15], v[32:35], v[36:39], a[0:15]
    v_mfma_f32_32x32x16_bf16 a[0:15], v[32:35], v[40:43], a[0:15]
    v_mfma_f32_32x32x16_bf16 a[16:31], v[32:35], v[44:47], a[16:31]
    v_mfma_f32_32x32x16_bf16 a[16:31], v[32:35], v[48:51], a[16:31]
    ds_read_b128 v[32:35], v13 offset:2656
    ds_read_b128 v[36:39], v14 offset:17456
    ds_read_b128 v[40:43], v14 offset:25056
    ds_read_b128 v[44:47], v14 offset:20016
    ds_read_b128 v[48:51], v14 offset:27616
    s_waitcnt lgkmcnt(10)
    v_mfma_f32_32x32x16_bf16 a[0:15], v[52:55], v[56:59], a[0:15]
    v_mfma_f32_32x32x16_bf16 a[0:15], v[52:55], v[60:63], a[0:15]
    v_mfma_f32_32x32x16_bf16 a[16:31], v[52:55], v[64:67], a[16:31]
    v_mfma_f32_32x32x16_bf16 a[16:31], v[52:55], v[68:71], a[16:31]
    ds_read_b128 v[52:55], v13 offset:2560
    ds_read_b128 v[56:59], v14 offset:17344
    ds_read_b128 v[60:63], v14 offset:24944
    ds_read_b128 v[64:67], v14 offset:19904
    ds_read_b128 v[68:71], v14 offset:27504
    s_waitcnt lgkmcnt(10)
    v_mfma_f32_32x32x16_bf16 a[0:15], v[72:75], v[76:79], a[0:15]
    v_mfma_f32_32x32x16_bf16 a[0:15], v[72:75], v[80:83], a[0:15]
    v_mfma_f32_32x32x16_bf16 a[16:31], v[72:75], v[84:87], a[16:31]
    v_mfma_f32_32x32x16_bf16 a[16:31], v[72:75], v[88:91], a[16:31]
    ds_read_b128 v[72:75], v13 offset:2592
    ds_read_b128 v[76:79], v14 offset:17376
    ds_read_b128 v[80:83], v14 offset:24976
    ds_read_b128 v[84:87], v14 offset:19936
    ds_read_b128 v[88:91], v14 offset:27536
    s_waitcnt lgkmcnt(10)
    v_mfma_f32_32x32x16_bf16 a[0:15], v[32:35], v[36:39], a[0:15]
    v_mfma_f32_32x32x16_bf16 a[0:15], v[32:35], v[40:43], a[0:15]
    v_mfma_f32_32x32x16_bf16 a[16:31], v[32:35], v[44:47], a[16:31]
    v_mfma_f32_32x32x16_bf16 a[16:31], v[32:35], v[48:51], a[16:31]
    ds_read_b128 v[32:35], v13 offset:2496
    ds_read_b128 v[36:39], v14 offset:17264
    ds_read_b128 v[40:43], v14 offset:24864
    ds_read_b128 v[44:47], v14 offset:19824
    ds_read_b128 v[48:51], v14 offset:27424
    s_waitcnt lgkmcnt(10)
    v_mfma_f32_32x32x16_bf16 a[0:15], v[52:55], v[56:59], a[0:15]
    v_mfma_f32_32x32x16_bf16 a[0:15], v[52:55], v[60:63], a[0:15]
    v_mfma_f32_32x32x16_bf16 a[16:31], v[52:55], v[64:67], a[16:31]
    v_mfma_f32_32x32x16_bf16 a[16:31], v[52:55], v[68:71], a[16:31]
    ds_read_b128 v[52:55], v13 offset:2528
    ds_read_b128 v[56:59], v14 offset:17296
    ds_read_b128 v[60:63], v14 offset:24896
    ds_read_b128 v[64:67], v14 offset:19856
    ds_read_b128 v[68:71], v14 offset:27456
    s_waitcnt lgkmcnt(10)
    v_mfma_f32_32x32x16_bf16 a[0:15], v[72:75], v[76:79], a[0:15]
    v_mfma_f32_32x32x16_bf16 a[0:15], v[72:75], v[80:83], a[0:15]
    v_mfma_f32_32x32x16_bf16 a[16:31], v[72:75], v[84:87], a[16:31]
    v_mfma_f32_32x32x16_bf16 a[16:31], v[72:75], v[88:91], a[16:31]
    ds_read_b128 v[72:75], v13 offset:2432
    ds_read_b128 v[76:79], v14 offset:17184
    ds_read_b128 v[80:83], v14 offset:24784
    ds_read_b128 v[84:87], v14 offset:19744
    ds_read_b128 v[88:91], v14 offset:27344
    s_waitcnt lgkmcnt(10)
    v_mfma_f32_32x32x16_bf16 a[0:15], v[32:35], v[36:39], a[0:15]
    v_mfma_f32_32x32x16_bf16 a[0:15], v[32:35], v[40:43], a[0:15]
    v_mfma_f32_32x32x16_bf16 a[16:31], v[32:35], v[44:47], a[16:31]
    v_mfma_f32_32x32x16_bf16 a[16:31], v[32:35], v[48:51], a[16:31]
    ds_read_b128 v[32:35], v13 offset:2464
    ds_read_b128 v[36:39], v14 offset:17216
    ds_read_b128 v[40:43], v14 offset:24816
    ds_read_b128 v[44:47], v14 offset:19776
    ds_read_b128 v[48:51], v14 offset:27376
    s_waitcnt lgkmcnt(10)
    v_mfma_f32_32x32x16_bf16 a[0:15], v[52:55], v[56:59], a[0:15]
    v_mfma_f32_32x32x16_bf16 a[0:15], v[52:55], v[60:63], a[0:15]
    v_mfma_f32_32x32x16_bf16 a[16:31], v[52:55], v[64:67], a[16:31]
    v_mfma_f32_32x32x16_bf16 a[16:31], v[52:55], v[68:71], a[16:31]
    ds_read_b128 v[52:55], v13 offset:2368
    ds_read_b128 v[56:59], v14 offset:17104
    ds_read_b128 v[60:63], v14 offset:24704
    ds_read_b128 v[64:67], v14 offset:19664
    ds_read_b128 v[68:71], v14 offset:27264
    s_waitcnt lgkmcnt(10)
    v_mfma_f32_32x32x16_bf16 a[0:15], v[72:75], v[76:79], a[0:15]
    v_mfma_f32_32x32x16_bf16 a[0:15], v[72:75], v[80:83], a[0:15]
    v_mfma_f32_32x32x16_bf16 a[16:31], v[72:75], v[84:87], a[16:31]
    v_mfma_f32_32x32x16_bf16 a[16:31], v[72:75], v[88:91], a[16:31]
    ds_read_b128 v[72:75], v13 offset:2400
    ds_read_b128 v[76:79], v14 offset:17136
    ds_read_b128 v[80:83], v14 offset:24736
    ds_read_b128 v[84:87], v14 offset:19696
    ds_read_b128 v[88:91], v14 offset:27296
    s_waitcnt lgkmcnt(10)
    v_mfma_f32_32x32x16_bf16 a[0:15], v[32:35], v[36:39], a[0:15]
    v_mfma_f32_32x32x16_bf16 a[0:15], v[32:35], v[40:43], a[0:15]
    v_mfma_f32_32x32x16_bf16 a[16:31], v[32:35], v[44:47], a[16:31]
    v_mfma_f32_32x32x16_bf16 a[16:31], v[32:35], v[48:51], a[16:31]
    ds_read_b128 v[32:35], v13 offset:2304
    ds_read_b128 v[36:39], v14 offset:17024
    ds_read_b128 v[40:43], v14 offset:24624
    ds_read_b128 v[44:47], v14 offset:19584
    ds_read_b128 v[48:51], v14 offset:27184
    s_waitcnt lgkmcnt(10)
    v_mfma_f32_32x32x16_bf16 a[0:15], v[52:55], v[56:59], a[0:15]
    v_mfma_f32_32x32x16_bf16 a[0:15], v[52:55], v[60:63], a[0:15]
    v_mfma_f32_32x32x16_bf16 a[16:31], v[52:55], v[64:67], a[16:31]
    v_mfma_f32_32x32x16_bf16 a[16:31], v[52:55], v[68:71], a[16:31]
    ds_read_b128 v[52:55], v13 offset:2336
    ds_read_b128 v[56:59], v14 offset:17056
    ds_read_b128 v[60:63], v14 offset:24656
    ds_read_b128 v[64:67], v14 offset:19616
    ds_read_b128 v[68:71], v14 offset:27216
    s_waitcnt lgkmcnt(10)
    v_mfma_f32_32x32x16_bf16 a[0:15], v[72:75], v[76:79], a[0:15]
    v_mfma_f32_32x32x16_bf16 a[0:15], v[72:75], v[80:83], a[0:15]
    v_mfma_f32_32x32x16_bf16 a[16:31], v[72:75], v[84:87], a[16:31]
    v_mfma_f32_32x32x16_bf16 a[16:31], v[72:75], v[88:91], a[16:31]
    ds_read_b128 v[72:75], v13 offset:2240
    ds_read_b128 v[76:79], v14 offset:16944
    ds_read_b128 v[80:83], v14 offset:24544
    ds_read_b128 v[84:87], v14 offset:19504
    ds_read_b128 v[88:91], v14 offset:27104
    s_waitcnt lgkmcnt(10)
    v_mfma_f32_32x32x16_bf16 a[0:15], v[32:35], v[36:39], a[0:15]
    v_mfma_f32_32x32x16_bf16 a[0:15], v[32:35], v[40:43], a[0:15]
    v_mfma_f32_32x32x16_bf16 a[16:31], v[32:35], v[44:47], a[16:31]
    v_mfma_f32_32x32x16_bf16 a[16:31], v[32:35], v[48:51], a[16:31]
    ds_read_b128 v[32:35], v13 offset:2272
    ds_read_b128 v[36:39], v14 offset:16976
    ds_read_b128 v[40:43], v14 offset:24576
    ds_read_b128 v[44:47], v14 offset:19536
    ds_read_b128 v[48:51], v14 offset:27136
    s_waitcnt lgkmcnt(10)
    v_mfma_f32_32x32x16_bf16 a[0:15], v[52:55], v[56:59], a[0:15]
    v_mfma_f32_32x32x16_bf16 a[0:15], v[52:55], v[60:63], a[0:15]
    v_mfma_f32_32x32x16_bf16 a[16:31], v[52:55], v[64:67], a[16:31]
    v_mfma_f32_32x32x16_bf16 a[16:31], v[52:55], v[68:71], a[16:31]
    ds_read_b128 v[52:55], v13 offset:2176
    ds_read_b128 v[56:59], v14 offset:16864
    ds_read_b128 v[60:63], v14 offset:24464
    ds_read_b128 v[64:67], v14 offset:19424
    ds_read_b128 v[68:71], v14 offset:27024
    s_waitcnt lgkmcnt(10)
    v_mfma_f32_32x32x16_bf16 a[0:15], v[72:75], v[76:79], a[0:15]
    v_mfma_f32_32x32x16_bf16 a[0:15], v[72:75], v[80:83], a[0:15]
    v_mfma_f32_32x32x16_bf16 a[16:31], v[72:75], v[84:87], a[16:31]
    v_mfma_f32_32x32x16_bf16 a[16:31], v[72:75], v[88:91], a[16:31]
    ds_read_b128 v[72:75], v13 offset:2208
    ds_read_b128 v[76:79], v14 offset:16896
    ds_read_b128 v[80:83], v14 offset:24496
    ds_read_b128 v[84:87], v14 offset:19456
    ds_read_b128 v[88:91], v14 offset:27056
    s_waitcnt lgkmcnt(10)
    v_mfma_f32_32x32x16_bf16 a[0:15], v[32:35], v[36:39], a[0:15]
    v_mfma_f32_32x32x16_bf16 a[0:15], v[32:35], v[40:43], a[0:15]
    v_mfma_f32_32x32x16_bf16 a[16:31], v[32:35], v[44:47], a[16:31]
    v_mfma_f32_32x32x16_bf16 a[16:31], v[32:35], v[48:51], a[16:31]
    ds_read_b128 v[32:35], v13 offset:2112
    ds_read_b128 v[36:39], v14 offset:16784
    ds_read_b128 v[40:43], v14 offset:24384
    ds_read_b128 v[44:47], v14 offset:19344
    ds_read_b128 v[48:51], v14 offset:26944
    s_waitcnt lgkmcnt(10)
    v_mfma_f32_32x32x16_bf16 a[0:15], v[52:55], v[56:59], a[0:15]
    v_mfma_f32_32x32x16_bf16 a[0:15], v[52:55], v[60:63], a[0:15]
    v_mfma_f32_32x32x16_bf16 a[16:31], v[52:55], v[64:67], a[16:31]
    v_mfma_f32_32x32x16_bf16 a[16:31], v[52:55], v[68:71], a[16:31]
    ds_read_b128 v[52:55], v13 offset:2144
    ds_read_b128 v[56:59], v14 offset:16816
    ds_read_b128 v[60:63], v14 offset:24416
    ds_read_b128 v[64:67], v14 offset:19376
    ds_read_b128 v[68:71], v14 offset:26976
    s_waitcnt lgkmcnt(10)
    v_mfma_f32_32x32x16_bf16 a[0:15], v[72:75], v[76:79], a[0:15]
    v_mfma_f32_32x32x16_bf16 a[0:15], v[72:75], v[80:83], a[0:15]
    v_mfma_f32_32x32x16_bf16 a[16:31], v[72:75], v[84:87], a[16:31]
    v_mfma_f32_32x32x16_bf16 a[16:31], v[72:75], v[88:91], a[16:31]
    ds_read_b128 v[72:75], v13 offset:2048
    ds_read_b128 v[76:79], v14 offset:16704
    ds_read_b128 v[80:83], v14 offset:24304
    ds_read_b128 v[84:87], v14 offset:19264
    ds_read_b128 v[88:91], v14 offset:26864
    s_waitcnt lgkmcnt(10)
    v_mfma_f32_32x32x16_bf16 a[0:15], v[32:35], v[36:39], a[0:15]
    v_mfma_f32_32x32x16_bf16 a[0:15], v[32:35], v[40:43], a[0:15]
    v_mfma_f32_32x32x16_bf16 a[16:31], v[32:35], v[44:47], a[16:31]
    v_mfma_f32_32x32x16_bf16 a[16:31], v[32:35], v[48:51], a[16:31]
    ds_read_b128 v[32:35], v13 offset:2080
    ds_read_b128 v[36:39], v14 offset:16736
    ds_read_b128 v[40:43], v14 offset:24336
    ds_read_b128 v[44:47], v14 offset:19296
    ds_read_b128 v[48:51], v14 offset:26896
    s_waitcnt lgkmcnt(10)
    v_mfma_f32_32x32x16_bf16 a[0:15], v[52:55], v[56:59], a[0:15]
    v_mfma_f32_32x32x16_bf16 a[0:15], v[52:55], v[60:63], a[0:15]
    v_mfma_f32_32x32x16_bf16 a[16:31], v[52:55], v[64:67], a[16:31]
    v_mfma_f32_32x32x16_bf16 a[16:31], v[52:55], v[68:71], a[16:31]
    ds_read_b128 v[52:55], v13 offset:1984
    ds_read_b128 v[64:67], v14 offset:19184
    ds_read_b128 v[68:71], v14 offset:26784
    s_waitcnt lgkmcnt(8)
    v_mfma_f32_32x32x16_bf16 a[0:15], v[72:75], v[76:79], a[0:15]
    v_mfma_f32_32x32x16_bf16 a[0:15], v[72:75], v[80:83], a[0:15]
    v_mfma_f32_32x32x16_bf16 a[16:31], v[72:75], v[84:87], a[16:31]
    v_mfma_f32_32x32x16_bf16 a[16:31], v[72:75], v[88:91], a[16:31]
    ds_read_b128 v[72:75], v13 offset:2016
    ds_read_b128 v[84:87], v14 offset:19216
    ds_read_b128 v[88:91], v14 offset:26816
    s_waitcnt lgkmcnt(6)
    v_mfma_f32_32x32x16_bf16 a[0:15], v[32:35], v[36:39], a[0:15]
    v_mfma_f32_32x32x16_bf16 a[0:15], v[32:35], v[40:43], a[0:15]
    v_mfma_f32_32x32x16_bf16 a[16:31], v[32:35], v[44:47], a[16:31]
    v_mfma_f32_32x32x16_bf16 a[16:31], v[32:35], v[48:51], a[16:31]
    ds_read_b128 v[32:35], v13 offset:1920
    ds_read_b128 v[44:47], v14 offset:19104
    ds_read_b128 v[48:51], v14 offset:26704
    s_waitcnt lgkmcnt(6)
    v_mfma_f32_32x32x16_bf16 a[16:31], v[52:55], v[64:67], a[16:31]
    v_mfma_f32_32x32x16_bf16 a[16:31], v[52:55], v[68:71], a[16:31]
    ds_read_b128 v[52:55], v13 offset:1952
    ds_read_b128 v[64:67], v14 offset:19136
    ds_read_b128 v[68:71], v14 offset:26736
    s_waitcnt lgkmcnt(6)
    v_mfma_f32_32x32x16_bf16 a[16:31], v[72:75], v[84:87], a[16:31]
    v_mfma_f32_32x32x16_bf16 a[16:31], v[72:75], v[88:91], a[16:31]
    ds_read_b128 v[72:75], v13 offset:1856
    ds_read_b128 v[84:87], v14 offset:19024
    ds_read_b128 v[88:91], v14 offset:26624
    s_waitcnt lgkmcnt(6)
    v_mfma_f32_32x32x16_bf16 a[16:31], v[32:35], v[44:47], a[16:31]
    v_mfma_f32_32x32x16_bf16 a[16:31], v[32:35], v[48:51], a[16:31]
    ds_read_b128 v[32:35], v13 offset:1888
    ds_read_b128 v[44:47], v14 offset:19056
    ds_read_b128 v[48:51], v14 offset:26656
    s_waitcnt lgkmcnt(6)
    v_mfma_f32_32x32x16_bf16 a[16:31], v[52:55], v[64:67], a[16:31]
    v_mfma_f32_32x32x16_bf16 a[16:31], v[52:55], v[68:71], a[16:31]
    ds_read_b128 v[52:55], v13 offset:1792
    ds_read_b128 v[64:67], v14 offset:18944
    ds_read_b128 v[68:71], v14 offset:26544
    s_waitcnt lgkmcnt(6)
    v_mfma_f32_32x32x16_bf16 a[16:31], v[72:75], v[84:87], a[16:31]
    v_mfma_f32_32x32x16_bf16 a[16:31], v[72:75], v[88:91], a[16:31]
    ds_read_b128 v[72:75], v13 offset:1824
    ds_read_b128 v[84:87], v14 offset:18976
    ds_read_b128 v[88:91], v14 offset:26576
    s_waitcnt lgkmcnt(6)
    v_mfma_f32_32x32x16_bf16 a[16:31], v[32:35], v[44:47], a[16:31]
    v_mfma_f32_32x32x16_bf16 a[16:31], v[32:35], v[48:51], a[16:31]
    ds_read_b128 v[32:35], v13 offset:1728
    ds_read_b128 v[44:47], v14 offset:18864
    ds_read_b128 v[48:51], v14 offset:26464
    s_waitcnt lgkmcnt(6)
    v_mfma_f32_32x32x16_bf16 a[16:31], v[52:55], v[64:67], a[16:31]
    v_mfma_f32_32x32x16_bf16 a[16:31], v[52:55], v[68:71], a[16:31]
    ds_read_b128 v[52:55], v13 offset:1760
    ds_read_b128 v[64:67], v14 offset:18896
    ds_read_b128 v[68:71], v14 offset:26496
    s_waitcnt lgkmcnt(6)
    v_mfma_f32_32x32x16_bf16 a[16:31], v[72:75], v[84:87], a[16:31]
    v_mfma_f32_32x32x16_bf16 a[16:31], v[72:75], v[88:91], a[16:31]
    ds_read_b128 v[72:75], v13 offset:1664
    ds_read_b128 v[84:87], v14 offset:18784
    ds_read_b128 v[88:91], v14 offset:26384
    s_waitcnt lgkmcnt(6)
    v_mfma_f32_32x32x16_bf16 a[16:31], v[32:35], v[44:47], a[16:31]
    v_mfma_f32_32x32x16_bf16 a[16:31], v[32:35], v[48:51], a[16:31]
    ds_read_b128 v[32:35], v13 offset:1696
    ds_read_b128 v[44:47], v14 offset:18816
    ds_read_b128 v[48:51], v14 offset:26416
    s_waitcnt lgkmcnt(6)
    v_mfma_f32_32x32x16_bf16 a[16:31], v[52:55], v[64:67], a[16:31]
    v_mfma_f32_32x32x16_bf16 a[16:31], v[52:55], v[68:71], a[16:31]
    ds_read_b128 v[52:55], v13 offset:1600
    ds_read_b128 v[64:67], v14 offset:18704
    ds_read_b128 v[68:71], v14 offset:26304
    s_waitcnt lgkmcnt(6)
    v_mfma_f32_32x32x16_bf16 a[16:31], v[72:75], v[84:87], a[16:31]
    v_mfma_f32_32x32x16_bf16 a[16:31], v[72:75], v[88:91], a[16:31]
    ds_read_b128 v[72:75], v13 offset:1632
    ds_read_b128 v[84:87], v14 offset:18736
    ds_read_b128 v[88:91], v14 offset:26336
    s_waitcnt lgkmcnt(6)
    v_mfma_f32_32x32x16_bf16 a[16:31], v[32:35], v[44:47], a[16:31]
    v_mfma_f32_32x32x16_bf16 a[16:31], v[32:35], v[48:51], a[16:31]
    ds_read_b128 v[32:35], v13 offset:1536
    ds_read_b128 v[44:47], v14 offset:18624
    ds_read_b128 v[48:51], v14 offset:26224
    s_waitcnt lgkmcnt(6)
    v_mfma_f32_32x32x16_bf16 a[16:31], v[52:55], v[64:67], a[16:31]
    v_mfma_f32_32x32x16_bf16 a[16:31], v[52:55], v[68:71], a[16:31]
    ds_read_b128 v[52:55], v13 offset:1568
    ds_read_b128 v[64:67], v14 offset:18656
    ds_read_b128 v[68:71], v14 offset:26256
    s_waitcnt lgkmcnt(6)
    v_mfma_f32_32x32x16_bf16 a[16:31], v[72:75], v[84:87], a[16:31]
    v_mfma_f32_32x32x16_bf16 a[16:31], v[72:75], v[88:91], a[16:31]
    ds_read_b128 v[72:75], v13 offset:1472
    ds_read_b128 v[84:87], v14 offset:18544
    ds_read_b128 v[88:91], v14 offset:26144
    s_waitcnt lgkmcnt(6)
    v_mfma_f32_32x32x16_bf16 a[16:31], v[32:35], v[44:47], a[16:31]
    v_mfma_f32_32x32x16_bf16 a[16:31], v[32:35], v[48:51], a[16:31]
    ds_read_b128 v[32:35], v13 offset:1504
    ds_read_b128 v[44:47], v14 offset:18576
    ds_read_b128 v[48:51], v14 offset:26176
    s_waitcnt lgkmcnt(6)
    v_mfma_f32_32x32x16_bf16 a[16:31], v[52:55], v[64:67], a[16:31]
    v_mfma_f32_32x32x16_bf16 a[16:31], v[52:55], v[68:71], a[16:31]
    ds_read_b128 v[52:55], v13 offset:1408
    ds_read_b128 v[64:67], v14 offset:18464
    ds_read_b128 v[68:71], v14 offset:26064
    s_waitcnt lgkmcnt(6)
    v_mfma_f32_32x32x16_bf16 a[16:31], v[72:75], v[84:87], a[16:31]
    v_mfma_f32_32x32x16_bf16 a[16:31], v[72:75], v[88:91], a[16:31]
    ds_read_b128 v[72:75], v13 offset:1440
    ds_read_b128 v[84:87], v14 offset:18496
    ds_read_b128 v[88:91], v14 offset:26096
    s_waitcnt lgkmcnt(6)
    v_mfma_f32_32x32x16_bf16 a[16:31], v[32:35], v[44:47], a[16:31]
    v_mfma_f32_32x32x16_bf16 a[16:31], v[32:35], v[48:51], a[16:31]
    ds_read_b128 v[32:35], v13 offset:1344
    ds_read_b128 v[44:47], v14 offset:18384
    ds_read_b128 v[48:51], v14 offset:25984
    s_waitcnt lgkmcnt(6)
    v_mfma_f32_32x32x16_bf16 a[16:31], v[52:55], v[64:67], a[16:31]
    v_mfma_f32_32x32x16_bf16 a[16:31], v[52:55], v[68:71], a[16:31]
    ds_read_b128 v[52:55], v13 offset:1376
    ds_read_b128 v[64:67], v14 offset:18416
    ds_read_b128 v[68:71], v14 offset:26016
    s_waitcnt lgkmcnt(6)
    v_mfma_f32_32x32x16_bf16 a[16:31], v[72:75], v[84:87], a[16:31]
    v_mfma_f32_32x32x16_bf16 a[16:31], v[72:75], v[88:91], a[16:31]
    ds_read_b128 v[72:75], v13 offset:1280
    ds_read_b128 v[84:87], v14 offset:18304
    ds_read_b128 v[88:91], v14 offset:25904
    s_waitcnt lgkmcnt(6)
    v_mfma_f32_32x32x16_bf16 a[16:31], v[32:35], v[44:47], a[16:31]
    v_mfma_f32_32x32x16_bf16 a[16:31], v[32:35], v[48:51], a[16:31]
    ds_read_b128 v[32:35], v13 offset:1312
    ds_read_b128 v[44:47], v14 offset:18336
    ds_read_b128 v[48:51], v14 offset:25936
    s_waitcnt lgkmcnt(6)
    v_mfma_f32_32x32x16_bf16 a[16:31], v[52:55], v[64:67], a[16:31]
    v_mfma_f32_32x32x16_bf16 a[16:31], v[52:55], v[68:71], a[16:31]
    ds_read_b128 v[52:55], v13 offset:1216
    ds_read_b128 v[64:67], v14 offset:18224
    ds_read_b128 v[68:71], v14 offset:25824
    s_waitcnt lgkmcnt(6)
    v_mfma_f32_32x32x16_bf16 a[16:31], v[72:75], v[84:87], a[16:31]
    v_mfma_f32_32x32x16_bf16 a[16:31], v[72:75], v[88:91], a[16:31]
    ds_read_b128 v[72:75], v13 offset:1248
    ds_read_b128 v[84:87], v14 offset:18256
    ds_read_b128 v[88:91], v14 offset:25856
    s_waitcnt lgkmcnt(6)
    v_mfma_f32_32x32x16_bf16 a[16:31], v[32:35], v[44:47], a[16:31]
    v_mfma_f32_32x32x16_bf16 a[16:31], v[32:35], v[48:51], a[16:31]
    ds_read_b128 v[32:35], v13 offset:1152
    ds_read_b128 v[44:47], v14 offset:18144
    ds_read_b128 v[48:51], v14 offset:25744
    s_waitcnt lgkmcnt(6)
    v_mfma_f32_32x32x16_bf16 a[16:31], v[52:55], v[64:67], a[16:31]
    v_mfma_f32_32x32x16_bf16 a[16:31], v[52:55], v[68:71], a[16:31]
    ds_read_b128 v[52:55], v13 offset:1184
    ds_read_b128 v[64:67], v14 offset:18176
    ds_read_b128 v[68:71], v14 offset:25776
    s_waitcnt lgkmcnt(6)
    v_mfma_f32_32x32x16_bf16 a[16:31], v[72:75], v[84:87], a[16:31]
    v_mfma_f32_32x32x16_bf16 a[16:31], v[72:75], v[88:91], a[16:31]
    ds_read_b128 v[72:75], v13 offset:1088
    ds_read_b128 v[84:87], v14 offset:18064
    ds_read_b128 v[88:91], v14 offset:25664
    s_waitcnt lgkmcnt(6)
    v_mfma_f32_32x32x16_bf16 a[16:31], v[32:35], v[44:47], a[16:31]
    v_mfma_f32_32x32x16_bf16 a[16:31], v[32:35], v[48:51], a[16:31]
    ds_read_b128 v[32:35], v13 offset:1120
    ds_read_b128 v[44:47], v14 offset:18096
    ds_read_b128 v[48:51], v14 offset:25696
    s_waitcnt lgkmcnt(6)
    v_mfma_f32_32x32x16_bf16 a[16:31], v[52:55], v[64:67], a[16:31]
    v_mfma_f32_32x32x16_bf16 a[16:31], v[52:55], v[68:71], a[16:31]
    ds_read_b128 v[52:55], v13 offset:1024
    ds_read_b128 v[64:67], v14 offset:17984
    ds_read_b128 v[68:71], v14 offset:25584
    s_waitcnt lgkmcnt(6)
    v_mfma_f32_32x32x16_bf16 a[16:31], v[72:75], v[84:87], a[16:31]
    v_mfma_f32_32x32x16_bf16 a[16:31], v[72:75], v[88:91], a[16:31]
    ds_read_b128 v[72:75], v13 offset:1056
    ds_read_b128 v[84:87], v14 offset:18016
    ds_read_b128 v[88:91], v14 offset:25616
    s_waitcnt lgkmcnt(6)
    v_mfma_f32_32x32x16_bf16 a[16:31], v[32:35], v[44:47], a[16:31]
    v_mfma_f32_32x32x16_bf16 a[16:31], v[32:35], v[48:51], a[16:31]
    ds_read_b128 v[32:35], v13 offset:960
    ds_read_b128 v[44:47], v14 offset:17904
    ds_read_b128 v[48:51], v14 offset:25504
    s_waitcnt lgkmcnt(6)
    v_mfma_f32_32x32x16_bf16 a[16:31], v[52:55], v[64:67], a[16:31]
    v_mfma_f32_32x32x16_bf16 a[16:31], v[52:55], v[68:71], a[16:31]
    ds_read_b128 v[52:55], v13 offset:992
    ds_read_b128 v[64:67], v14 offset:17936
    ds_read_b128 v[68:71], v14 offset:25536
    s_waitcnt lgkmcnt(6)
    v_mfma_f32_32x32x16_bf16 a[16:31], v[72:75], v[84:87], a[16:31]
    v_mfma_f32_32x32x16_bf16 a[16:31], v[72:75], v[88:91], a[16:31]
    ds_read_b128 v[72:75], v13 offset:896
    ds_read_b128 v[84:87], v14 offset:17824
    ds_read_b128 v[88:91], v14 offset:25424
    s_waitcnt lgkmcnt(6)
    v_mfma_f32_32x32x16_bf16 a[16:31], v[32:35], v[44:47], a[16:31]
    v_mfma_f32_32x32x16_bf16 a[16:31], v[32:35], v[48:51], a[16:31]
    ds_read_b128 v[32:35], v13 offset:928
    ds_read_b128 v[44:47], v14 offset:17856
    ds_read_b128 v[48:51], v14 offset:25456
    s_waitcnt lgkmcnt(6)
    v_mfma_f32_32x32x16_bf16 a[16:31], v[52:55], v[64:67], a[16:31]
    v_mfma_f32_32x32x16_bf16 a[16:31], v[52:55], v[68:71], a[16:31]
    ds_read_b128 v[52:55], v13 offset:832
    ds_read_b128 v[64:67], v14 offset:17744
    ds_read_b128 v[68:71], v14 offset:25344
    s_waitcnt lgkmcnt(6)
    v_mfma_f32_32x32x16_bf16 a[16:31], v[72:75], v[84:87], a[16:31]
    v_mfma_f32_32x32x16_bf16 a[16:31], v[72:75], v[88:91], a[16:31]
    ds_read_b128 v[72:75], v13 offset:864
    ds_read_b128 v[84:87], v14 offset:17776
    ds_read_b128 v[88:91], v14 offset:25376
    s_waitcnt lgkmcnt(6)
    v_mfma_f32_32x32x16_bf16 a[16:31], v[32:35], v[44:47], a[16:31]
    v_mfma_f32_32x32x16_bf16 a[16:31], v[32:35], v[48:51], a[16:31]
    ds_read_b128 v[32:35], v13 offset:768
    ds_read_b128 v[44:47], v14 offset:17664
    ds_read_b128 v[48:51], v14 offset:25264
    s_waitcnt lgkmcnt(6)
    v_mfma_f32_32x32x16_bf16 a[16:31], v[52:55], v[64:67], a[16:31]
    v_mfma_f32_32x32x16_bf16 a[16:31], v[52:55], v[68:71], a[16:31]
    ds_read_b128 v[52:55], v13 offset:800
    ds_read_b128 v[64:67], v14 offset:17696
    ds_read_b128 v[68:71], v14 offset:25296
    s_waitcnt lgkmcnt(6)
    v_mfma_f32_32x32x16_bf16 a[16:31], v[72:75], v[84:87], a[16:31]
    v_mfma_f32_32x32x16_bf16 a[16:31], v[72:75], v[88:91], a[16:31]
    ds_read_b128 v[72:75], v13 offset:704
    ds_read_b128 v[84:87], v14 offset:17584
    ds_read_b128 v[88:91], v14 offset:25184
    s_waitcnt lgkmcnt(6)
    v_mfma_f32_32x32x16_bf16 a[16:31], v[32:35], v[44:47], a[16:31]
    v_mfma_f32_32x32x16_bf16 a[16:31], v[32:35], v[48:51], a[16:31]
    ds_read_b128 v[32:35], v13 offset:736
    ds_read_b128 v[44:47], v14 offset:17616
    ds_read_b128 v[48:51], v14 offset:25216
    s_waitcnt lgkmcnt(6)
    v_mfma_f32_32x32x16_bf16 a[16:31], v[52:55], v[64:67], a[16:31]
    v_mfma_f32_32x32x16_bf16 a[16:31], v[52:55], v[68:71], a[16:31]
    ds_read_b128 v[52:55], v13 offset:640
    ds_read_b128 v[64:67], v14 offset:17504
    ds_read_b128 v[68:71], v14 offset:25104
    s_waitcnt lgkmcnt(6)
    v_mfma_f32_32x32x16_bf16 a[16:31], v[72:75], v[84:87], a[16:31]
    v_mfma_f32_32x32x16_bf16 a[16:31], v[72:75], v[88:91], a[16:31]
    ds_read_b128 v[72:75], v13 offset:672
    ds_read_b128 v[84:87], v14 offset:17536
    ds_read_b128 v[88:91], v14 offset:25136
    s_waitcnt lgkmcnt(6)
    v_mfma_f32_32x32x16_bf16 a[16:31], v[32:35], v[44:47], a[16:31]
    v_mfma_f32_32x32x16_bf16 a[16:31], v[32:35], v[48:51], a[16:31]
    ds_read_b128 v[32:35], v13 offset:576
    ds_read_b128 v[44:47], v14 offset:17424
    ds_read_b128 v[48:51], v14 offset:25024
    s_waitcnt lgkmcnt(6)
    v_mfma_f32_32x32x16_bf16 a[16:31], v[52:55], v[64:67], a[16:31]
    v_mfma_f32_32x32x16_bf16 a[16:31], v[52:55], v[68:71], a[16:31]
    ds_read_b128 v[52:55], v13 offset:608
    ds_read_b128 v[64:67], v14 offset:17456
    ds_read_b128 v[68:71], v14 offset:25056
    s_waitcnt lgkmcnt(6)
    v_mfma_f32_32x32x16_bf16 a[16:31], v[72:75], v[84:87], a[16:31]
    v_mfma_f32_32x32x16_bf16 a[16:31], v[72:75], v[88:91], a[16:31]
    ds_read_b128 v[72:75], v13 offset:512
    ds_read_b128 v[84:87], v14 offset:17344
    ds_read_b128 v[88:91], v14 offset:24944
    s_waitcnt lgkmcnt(6)
    v_mfma_f32_32x32x16_bf16 a[16:31], v[32:35], v[44:47], a[16:31]
    v_mfma_f32_32x32x16_bf16 a[16:31], v[32:35], v[48:51], a[16:31]
    ds_read_b128 v[32:35], v13 offset:544
    ds_read_b128 v[44:47], v14 offset:17376
    ds_read_b128 v[48:51], v14 offset:24976
    s_waitcnt lgkmcnt(6)
    v_mfma_f32_32x32x16_bf16 a[16:31], v[52:55], v[64:67], a[16:31]
    v_mfma_f32_32x32x16_bf16 a[16:31], v[52:55], v[68:71], a[16:31]
    ds_read_b128 v[52:55], v13 offset:448
    ds_read_b128 v[64:67], v14 offset:17264
    ds_read_b128 v[68:71], v14 offset:24864
    s_waitcnt lgkmcnt(6)
    v_mfma_f32_32x32x16_bf16 a[16:31], v[72:75], v[84:87], a[16:31]
    v_mfma_f32_32x32x16_bf16 a[16:31], v[72:75], v[88:91], a[16:31]
    ds_read_b128 v[72:75], v13 offset:480
    ds_read_b128 v[84:87], v14 offset:17296
    ds_read_b128 v[88:91], v14 offset:24896
    s_waitcnt lgkmcnt(6)
    v_mfma_f32_32x32x16_bf16 a[16:31], v[32:35], v[44:47], a[16:31]
    v_mfma_f32_32x32x16_bf16 a[16:31], v[32:35], v[48:51], a[16:31]
    ds_read_b128 v[32:35], v13 offset:384
    ds_read_b128 v[44:47], v14 offset:17184
    ds_read_b128 v[48:51], v14 offset:24784
    s_waitcnt lgkmcnt(6)
    v_mfma_f32_32x32x16_bf16 a[16:31], v[52:55], v[64:67], a[16:31]
    v_mfma_f32_32x32x16_bf16 a[16:31], v[52:55], v[68:71], a[16:31]
    ds_read_b128 v[52:55], v13 offset:416
    ds_read_b128 v[64:67], v14 offset:17216
    ds_read_b128 v[68:71], v14 offset:24816
    s_waitcnt lgkmcnt(6)
    v_mfma_f32_32x32x16_bf16 a[16:31], v[72:75], v[84:87], a[16:31]
    v_mfma_f32_32x32x16_bf16 a[16:31], v[72:75], v[88:91], a[16:31]
    ds_read_b128 v[72:75], v13 offset:320
    ds_read_b128 v[84:87], v14 offset:17104
    ds_read_b128 v[88:91], v14 offset:24704
    s_waitcnt lgkmcnt(6)
    v_mfma_f32_32x32x16_bf16 a[16:31], v[32:35], v[44:47], a[16:31]
    v_mfma_f32_32x32x16_bf16 a[16:31], v[32:35], v[48:51], a[16:31]
    ds_read_b128 v[32:35], v13 offset:352
    ds_read_b128 v[44:47], v14 offset:17136
    ds_read_b128 v[48:51], v14 offset:24736
    s_waitcnt lgkmcnt(6)
    v_mfma_f32_32x32x16_bf16 a[16:31], v[52:55], v[64:67], a[16:31]
    v_mfma_f32_32x32x16_bf16 a[16:31], v[52:55], v[68:71], a[16:31]
    ds_read_b128 v[52:55], v13 offset:256
    ds_read_b128 v[64:67], v14 offset:17024
    ds_read_b128 v[68:71], v14 offset:24624
    s_waitcnt lgkmcnt(6)
    v_mfma_f32_32x32x16_bf16 a[16:31], v[72:75], v[84:87], a[16:31]
    v_mfma_f32_32x32x16_bf16 a[16:31], v[72:75], v[88:91], a[16:31]
    ds_read_b128 v[72:75], v13 offset:288
    ds_read_b128 v[84:87], v14 offset:17056
    ds_read_b128 v[88:91], v14 offset:24656
    s_waitcnt lgkmcnt(6)
    v_mfma_f32_32x32x16_bf16 a[16:31], v[32:35], v[44:47], a[16:31]
    v_mfma_f32_32x32x16_bf16 a[16:31], v[32:35], v[48:51], a[16:31]
    ds_read_b128 v[32:35], v13 offset:192
    ds_read_b128 v[44:47], v14 offset:16944
    ds_read_b128 v[48:51], v14 offset:24544
    s_waitcnt lgkmcnt(6)
    v_mfma_f32_32x32x16_bf16 a[16:31], v[52:55], v[64:67], a[16:31]
    v_mfma_f32_32x32x16_bf16 a[16:31], v[52:55], v[68:71], a[16:31]
    ds_read_b128 v[52:55], v13 offset:224
    ds_read_b128 v[64:67], v14 offset:16976
    ds_read_b128 v[68:71], v14 offset:24576
    s_waitcnt lgkmcnt(6)
    v_mfma_f32_32x32x16_bf16 a[16:31], v[72:75], v[84:87], a[16:31]
    v_mfma_f32_32x32x16_bf16 a[16:31], v[72:75], v[88:91], a[16:31]
    ds_read_b128 v[72:75], v13 offset:128
    ds_read_b128 v[84:87], v14 offset:16864
    ds_read_b128 v[88:91], v14 offset:24464
    s_waitcnt lgkmcnt(6)
    v_mfma_f32_32x32x16_bf16 a[16:31], v[32:35], v[44:47], a[16:31]
    v_mfma_f32_32x32x16_bf16 a[16:31], v[32:35], v[48:51], a[16:31]
    ds_read_b128 v[32:35], v13 offset:160
    ds_read_b128 v[44:47], v14 offset:16896
    ds_read_b128 v[48:51], v14 offset:24496
    s_waitcnt lgkmcnt(6)
    v_mfma_f32_32x32x16_bf16 a[16:31], v[52:55], v[64:67], a[16:31]
    v_mfma_f32_32x32x16_bf16 a[16:31], v[52:55], v[68:71], a[16:31]
    ds_read_b128 v[52:55], v13 offset:64
    ds_read_b128 v[64:67], v14 offset:16784
    ds_read_b128 v[68:71], v14 offset:24384
    s_waitcnt lgkmcnt(6)
    v_mfma_f32_32x32x16_bf16 a[16:31], v[72:75], v[84:87], a[16:31]
    v_mfma_f32_32x32x16_bf16 a[16:31], v[72:75], v[88:91], a[16:31]
    ds_read_b128 v[72:75], v13 offset:96
    ds_read_b128 v[84:87], v14 offset:16816
    ds_read_b128 v[88:91], v14 offset:24416
    s_waitcnt lgkmcnt(6)
    v_mfma_f32_32x32x16_bf16 a[16:31], v[32:35], v[44:47], a[16:31]
    v_mfma_f32_32x32x16_bf16 a[16:31], v[32:35], v[48:51], a[16:31]
    ds_read_b128 v[32:35], v13 offset:0
    ds_read_b128 v[44:47], v14 offset:16704
    ds_read_b128 v[48:51], v14 offset:24304
    s_waitcnt lgkmcnt(6)
    v_mfma_f32_32x32x16_bf16 a[16:31], v[52:55], v[64:67], a[16:31]
    v_mfma_f32_32x32x16_bf16 a[16:31], v[52:55], v[68:71], a[16:31]
    ds_read_b128 v[52:55], v13 offset:32
    ds_read_b128 v[64:67], v14 offset:16736
    ds_read_b128 v[68:71], v14 offset:24336
    s_waitcnt lgkmcnt(6)
    v_mfma_f32_32x32x16_bf16 a[16:31], v[72:75], v[84:87], a[16:31]
    v_mfma_f32_32x32x16_bf16 a[16:31], v[72:75], v[88:91], a[16:31]
    s_waitcnt lgkmcnt(3)
    v_mfma_f32_32x32x16_bf16 a[16:31], v[32:35], v[44:47], a[16:31]
    v_mfma_f32_32x32x16_bf16 a[16:31], v[32:35], v[48:51], a[16:31]
    s_waitcnt lgkmcnt(0)
    v_mfma_f32_32x32x16_bf16 a[16:31], v[52:55], v[64:67], a[16:31]
    v_mfma_f32_32x32x16_bf16 a[16:31], v[52:55], v[68:71], a[16:31]
    s_nop 15
    v_lshlrev_b32 v12, 6, v10
    v_lshl_add_u32 v12, v11, 3, v12
    s_lshl_b32 s35, s42, 12
    s_add_u32 s35, s35, 83886080
    v_accvgpr_read_b32 v32, a0
    v_accvgpr_read_b32 v33, a1
    v_accvgpr_read_b32 v34, a2
    v_accvgpr_read_b32 v35, a3
    v_accvgpr_read_b32 v36, a4
    v_accvgpr_read_b32 v37, a5
    v_accvgpr_read_b32 v38, a6
    v_accvgpr_read_b32 v39, a7
    v_accvgpr_read_b32 v40, a8
    v_accvgpr_read_b32 v41, a9
    v_accvgpr_read_b32 v42, a10
    v_accvgpr_read_b32 v43, a11
    v_accvgpr_read_b32 v44, a12
    v_accvgpr_read_b32 v45, a13
    v_accvgpr_read_b32 v46, a14
    v_accvgpr_read_b32 v47, a15
    v_cvt_pk_bf16_f32 v48, v32, v33
    v_cvt_pk_bf16_f32 v49, v34, v35
    buffer_store_dwordx2 v[48:49], v12, s[4:7], s35 offen offset:0 sc1
    v_cvt_pk_bf16_f32 v50, v36, v37
    v_cvt_pk_bf16_f32 v51, v38, v39
    buffer_store_dwordx2 v[50:51], v12, s[4:7], s35 offen offset:16 sc1
    v_cvt_pk_bf16_f32 v52, v40, v41
    v_cvt_pk_bf16_f32 v53, v42, v43
    buffer_store_dwordx2 v[52:53], v12, s[4:7], s35 offen offset:32 sc1
    v_cvt_pk_bf16_f32 v54, v44, v45
    v_cvt_pk_bf16_f32 v55, v46, v47
    buffer_store_dwordx2 v[54:55], v12, s[4:7], s35 offen offset:48 sc1
    v_accvgpr_read_b32 v32, a16
    v_accvgpr_read_b32 v33, a17
    v_accvgpr_read_b32 v34, a18
    v_accvgpr_read_b32 v35, a19
    v_accvgpr_read_b32 v36, a20
    v_accvgpr_read_b32 v37, a21
    v_accvgpr_read_b32 v38, a22
    v_accvgpr_read_b32 v39, a23
    v_accvgpr_read_b32 v40, a24
    v_accvgpr_read_b32 v41, a25
    v_accvgpr_read_b32 v42, a26
    v_accvgpr_read_b32 v43, a27
    v_accvgpr_read_b32 v44, a28
    v_accvgpr_read_b32 v45, a29
    v_accvgpr_read_b32 v46, a30
    v_accvgpr_read_b32 v47, a31
    v_cvt_pk_bf16_f32 v56, v32, v33
    v_cvt_pk_bf16_f32 v57, v34, v35
    buffer_store_dwordx2 v[56:57], v12, s[4:7], s35 offen offset:2048 sc1
    v_cvt_pk_bf16_f32 v58, v36, v37
    v_cvt_pk_bf16_f32 v59, v38, v39
    buffer_store_dwordx2 v[58:59], v12, s[4:7], s35 offen offset:2064 sc1
    v_cvt_pk_bf16_f32 v60, v40, v41
    v_cvt_pk_bf16_f32 v61, v42, v43
    buffer_store_dwordx2 v[60:61], v12, s[4:7], s35 offen offset:2080 sc1
    v_cvt_pk_bf16_f32 v62, v44, v45
    v_cvt_pk_bf16_f32 v63, v46, v47
    buffer_store_dwordx2 v[62:63], v12, s[4:7], s35 offen offset:2096 sc1
    s_waitcnt vmcnt(0)
    v_mov_b32 v8, 1
    v_mov_b32 v9, 8192
    s_mov_b64 exec, 1
    buffer_atomic_add v8, v9, s[4:7], 0 offen
    s_mov_b64 exec, -1
    s_barrier
S4_DONE:
    s_cmp_ge_u32 s33, 180
    s_cbranch_scc1 ATT
OPJ:
    v_and_b32 v1, 63, v0
    v_and_b32 v3, 15, v1
    v_lshrrev_b32 v20, 4, v1
    v_lshlrev_b32 v4, 2, v20
    s_mul_i32 s44, s33, 3641
    s_lshr_b32 s44, s44, 16
    s_mul_i32 s35, s44, 18
    s_sub_u32 s43, s33, s35
    s_load_dwordx2 s[52:53], s[0:1], 64
    v_lshlrev_b32 v21, 4, v1
    s_lshl_b32 s35, s32, 15
    v_add_u32 v2, s35, v21
    v_lshrrev_b32 v21, 2, v1
    v_mul_u32_u24 v21, 1152, v21
    v_and_b32 v22, 3, v1
    v_lshl_add_u32 v21, v22, 4, v21
    s_lshl_b32 s35, s32, 14
    v_lshlrev_b32 v22, 4, v1
    v_add_u32 v22, s35, v22
    v_bfe_u32 v23, v1, 2, 2
    v_add_u32 v23, v23, v4
    v_lshlrev_b32 v23, 6, v23
    v_and_b32 v24, 3, v1
    v_lshl_add_u32 v23, v24, 3, v23
    v_add_u32 v23, s35, v23
    s_mul_i32 s36, s32, 1179648
    s_lshl_b32 s37, s43, 6
    s_add_u32 s36, s36, s37
    s_waitcnt lgkmcnt(0)
    s_and_b32 s53, s53, 0xffff
    s_mov_b32 s54, 1152
    s_mov_b32 s55, 0x00020000
    buffer_load_dwordx4 v[32:35], v21, s[24:27], s36 offen
    s_add_u32 s36, s36, 18432
    buffer_load_dwordx4 v[36:39], v21, s[24:27], s36 offen
    s_add_u32 s36, s36, 18432
    buffer_load_dwordx4 v[40:43], v21, s[24:27], s36 offen
    s_add_u32 s36, s36, 18432
    buffer_load_dwordx4 v[44:47], v21, s[24:27], s36 offen
    s_add_u32 s36, s36, 18432
    buffer_load_dwordx4 v[48:51], v21, s[24:27], s36 offen
    s_add_u32 s36, s36, 18432
    buffer_load_dwordx4 v[52:55], v21, s[24:27], s36 offen
    s_add_u32 s36, s36, 18432
    buffer_load_dwordx4 v[56:59], v21, s[24:27], s36 offen
    s_add_u32 s36, s36, 18432
    buffer_load_dwordx4 v[60:63], v21, s[24:27], s36 offen
    s_add_u32 s36, s36, 18432
    buffer_load_dwordx4 v[64:67], v21, s[24:27], s36 offen
    s_add_u32 s36, s36, 18432
    buffer_load_dwordx4 v[68:71], v21, s[24:27], s36 offen
    s_add_u32 s36, s36, 18432
    buffer_load_dwordx4 v[72:75], v21, s[24:27], s36 offen
    s_add_u32 s36, s36, 18432
    buffer_load_dwordx4 v[76:79], v21, s[24:27], s36 offen
    s_add_u32 s36, s36, 18432
    buffer_load_dwordx4 v[80:83], v21, s[24:27], s36 offen
    s_add_u32 s36, s36, 18432
    buffer_load_dwordx4 v[84:87], v21, s[24:27], s36 offen
    s_add_u32 s36, s36, 18432
    buffer_load_dwordx4 v[88:91], v21, s[24:27], s36 offen
    s_add_u32 s36, s36, 18432
    buffer_load_dwordx4 v[92:95], v21, s[24:27], s36 offen
    s_add_u32 s36, s36, 18432
    s_waitcnt vmcnt(15)
    ds_write_b128 v22, v[32:35] offset:0
    s_waitcnt vmcnt(14)
    ds_write_b128 v22, v[36:39] offset:1024
    s_waitcnt vmcnt(13)
    ds_write_b128 v22, v[40:43] offset:2048
    s_waitcnt vmcnt(12)
    ds_write_b128 v22, v[44:47] offset:3072
    s_waitcnt vmcnt(11)
    ds_write_b128 v22, v[48:51] offset:4096
    s_waitcnt vmcnt(10)
    ds_write_b128 v22, v[52:55] offset:5120
    s_waitcnt vmcnt(9)
    ds_write_b128 v22, v[56:59] offset:6144
    s_waitcnt vmcnt(8)
    ds_write_b128 v22, v[60:63] offset:7168
    s_waitcnt vmcnt(7)
    ds_write_b128 v22, v[64:67] offset:8192
    s_waitcnt vmcnt(6)
    ds_write_b128 v22, v[68:71] offset:9216
    s_waitcnt vmcnt(5)
    ds_write_b128 v22, v[72:75] offset:10240
    s_waitcnt vmcnt(4)
    ds_write_b128 v22, v[76:79] offset:11264
    s_waitcnt vmcnt(3)
    ds_write_b128 v22, v[80:83] offset:12288
    s_waitcnt vmcnt(2)
    ds_write_b128 v22, v[84:87] offset:13312
    s_waitcnt vmcnt(1)
    ds_write_b128 v22, v[88:91] offset:14336
    s_waitcnt vmcnt(0)
    ds_write_b128 v22, v[92:95] offset:15360
    s_waitcnt lgkmcnt(0)
    ds_read_b64_tr_b16 a[0:1], v23 offset:0
    ds_read_b64_tr_b16 a[2:3], v23 offset:1024
    ds_read_b64_tr_b16 a[4:5], v23 offset:32
    ds_read_b64_tr_b16 a[6:7], v23 offset:1056
    ds_read_b64_tr_b16 a[8:9], v23 offset:2048
    ds_read_b64_tr_b16 a[10:11], v23 offset:3072
    ds_read_b64_tr_b16 a[12:13], v23 offset:2080
    ds_read_b64_tr_b16 a[14:15], v23 offset:3104
    s_waitcnt lgkmcnt(0)
    ds_read_b64_tr_b16 a[16:17], v23 offset:4096
    ds_read_b64_tr_b16 a[18:19], v23 offset:5120
    ds_read_b64_tr_b16 a[20:21], v23 offset:4128
    ds_read_b64_tr_b16 a[22:23], v23 offset:5152
    ds_read_b64_tr_b16 a[24:25], v23 offset:6144
    ds_read_b64_tr_b16 a[26:27], v23 offset:7168
    ds_read_b64_tr_b16 a[28:29], v23 offset:6176
    ds_read_b64_tr_b16 a[30:31], v23 offset:7200
    s_waitcnt lgkmcnt(0)
    ds_read_b64_tr_b16 a[32:33], v23 offset:8192
    ds_read_b64_tr_b16 a[34:35], v23 offset:9216
    ds_read_b64_tr_b16 a[36:37], v23 offset:8224
    ds_read_b64_tr_b16 a[38:39], v23 offset:9248
    ds_read_b64_tr_b16 a[40:41], v23 offset:10240
    ds_read_b64_tr_b16 a[42:43], v23 offset:11264
    ds_read_b64_tr_b16 a[44:45], v23 offset:10272
    ds_read_b64_tr_b16 a[46:47], v23 offset:11296
    s_waitcnt lgkmcnt(0)
    ds_read_b64_tr_b16 a[48:49], v23 offset:12288
    ds_read_b64_tr_b16 a[50:51], v23 offset:13312
    ds_read_b64_tr_b16 a[52:53], v23 offset:12320
    ds_read_b64_tr_b16 a[54:55], v23 offset:13344
    ds_read_b64_tr_b16 a[56:57], v23 offset:14336
    ds_read_b64_tr_b16 a[58:59], v23 offset:15360
    ds_read_b64_tr_b16 a[60:61], v23 offset:14368
    ds_read_b64_tr_b16 a[62:63], v23 offset:15392
    s_waitcnt lgkmcnt(0)
    buffer_load_dwordx4 v[32:35], v21, s[24:27], s36 offen
    s_add_u32 s36, s36, 18432
    buffer_load_dwordx4 v[36:39], v21, s[24:27], s36 offen
    s_add_u32 s36, s36, 18432
    buffer_load_dwordx4 v[40:43], v21, s[24:27], s36 offen
    s_add_u32 s36, s36, 18432
    buffer_load_dwordx4 v[44:47], v21, s[24:27], s36 offen
    s_add_u32 s36, s36, 18432
    buffer_load_dwordx4 v[48:51], v21, s[24:27], s36 offen
    s_add_u32 s36, s36, 18432
    buffer_load_dwordx4 v[52:55], v21, s[24:27], s36 offen
    s_add_u32 s36, s36, 18432
    buffer_load_dwordx4 v[56:59], v21, s[24:27], s36 offen
    s_add_u32 s36, s36, 18432
    buffer_load_dwordx4 v[60:63], v21, s[24:27], s36 offen
    s_add_u32 s36, s36, 18432
    buffer_load_dwordx4 v[64:67], v21, s[24:27], s36 offen
    s_add_u32 s36, s36, 18432
    buffer_load_dwordx4 v[68:71], v21, s[24:27], s36 offen
    s_add_u32 s36, s36, 18432
    buffer_load_dwordx4 v[72:75], v21, s[24:27], s36 offen
    s_add_u32 s36, s36, 18432
    buffer_load_dwordx4 v[76:79], v21, s[24:27], s36 offen
    s_add_u32 s36, s36, 18432
    buffer_load_dwordx4 v[80:83], v21, s[24:27], s36 offen
    s_add_u32 s36, s36, 18432
    buffer_load_dwordx4 v[84:87], v21, s[24:27], s36 offen
    s_add_u32 s36, s36, 18432
    buffer_load_dwordx4 v[88:91], v21, s[24:27], s36 offen
    s_add_u32 s36, s36, 18432
    buffer_load_dwordx4 v[92:95], v21, s[24:27], s36 offen
    s_add_u32 s36, s36, 18432
    s_waitcnt vmcnt(15)
    ds_write_b128 v22, v[32:35] offset:0
    s_waitcnt vmcnt(14)
    ds_write_b128 v22, v[36:39] offset:1024
    s_waitcnt vmcnt(13)
    ds_write_b128 v22, v[40:43] offset:2048
    s_waitcnt vmcnt(12)
    ds_write_b128 v22, v[44:47] offset:3072
    s_waitcnt vmcnt(11)
    ds_write_b128 v22, v[48:51] offset:4096
    s_waitcnt vmcnt(10)
    ds_write_b128 v22, v[52:55] offset:5120
    s_waitcnt vmcnt(9)
    ds_write_b128 v22, v[56:59] offset:6144
    s_waitcnt vmcnt(8)
    ds_write_b128 v22, v[60:63] offset:7168
    s_waitcnt vmcnt(7)
    ds_write_b128 v22, v[64:67] offset:8192
    s_waitcnt vmcnt(6)
    ds_write_b128 v22, v[68:71] offset:9216
    s_waitcnt vmcnt(5)
    ds_write_b128 v22, v[72:75] offset:10240
    s_waitcnt vmcnt(4)
    ds_write_b128 v22, v[76:79] offset:11264
    s_waitcnt vmcnt(3)
    ds_write_b128 v22, v[80:83] offset:12288
    s_waitcnt vmcnt(2)
    ds_write_b128 v22, v[84:87] offset:13312
    s_waitcnt vmcnt(1)
    ds_write_b128 v22, v[88:91] offset:14336
    s_waitcnt vmcnt(0)
    ds_write_b128 v22, v[92:95] offset:15360
    s_waitcnt lgkmcnt(0)
    ds_read_b64_tr_b16 a[64:65], v23 offset:0
    ds_read_b64_tr_b16 a[66:67], v23 offset:1024
    ds_read_b64_tr_b16 a[68:69], v23 offset:32
    ds_read_b64_tr_b16 a[70:71], v23 offset:1056
    ds_read_b64_tr_b16 a[72:73], v23 offset:2048
    ds_read_b64_tr_b16 a[74:75], v23 offset:3072
    ds_read_b64_tr_b16 a[76:77], v23 offset:2080
    ds_read_b64_tr_b16 a[78:79], v23 offset:3104
    s_waitcnt lgkmcnt(0)
    ds_read_b64_tr_b16 a[80:81], v23 offset:4096
    ds_read_b64_tr_b16 a[82:83], v23 offset:5120
    ds_read_b64_tr_b16 a[84:85], v23 offset:4128
    ds_read_b64_tr_b16 a[86:87], v23 offset:5152
    ds_read_b64_tr_b16 a[88:89], v23 offset:6144
    ds_read_b64_tr_b16 a[90:91], v23 offset:7168
    ds_read_b64_tr_b16 a[92:93], v23 offset:6176
    ds_read_b64_tr_b16 a[94:95], v23 offset:7200
    s_waitcnt lgkmcnt(0)
    ds_read_b64_tr_b16 a[96:97], v23 offset:8192
    ds_read_b64_tr_b16 a[98:99], v23 offset:9216
    ds_read_b64_tr_b16 a[100:101], v23 offset:8224
    ds_read_b64_tr_b16 a[102:103], v23 offset:9248
    ds_read_b64_tr_b16 a[104:105], v23 offset:10240
    ds_read_b64_tr_b16 a[106:107], v23 offset:11264
    ds_read_b64_tr_b16 a[108:109], v23 offset:10272
    ds_read_b64_tr_b16 a[110:111], v23 offset:11296
    s_waitcnt lgkmcnt(0)
    ds_read_b64_tr_b16 a[112:113], v23 offset:12288
    ds_read_b64_tr_b16 a[114:115], v23 offset:13312
    ds_read_b64_tr_b16 a[116:117], v23 offset:12320
    ds_read_b64_tr_b16 a[118:119], v23 offset:13344
    ds_read_b64_tr_b16 a[120:121], v23 offset:14336
    ds_read_b64_tr_b16 a[122:123], v23 offset:15360
    ds_read_b64_tr_b16 a[124:125], v23 offset:14368
    ds_read_b64_tr_b16 a[126:127], v23 offset:15392
    s_waitcnt lgkmcnt(0)
    buffer_load_dwordx4 v[32:35], v21, s[24:27], s36 offen
    s_add_u32 s36, s36, 18432
    buffer_load_dwordx4 v[36:39], v21, s[24:27], s36 offen
    s_add_u32 s36, s36, 18432
    buffer_load_dwordx4 v[40:43], v21, s[24:27], s36 offen
    s_add_u32 s36, s36, 18432
    buffer_load_dwordx4 v[44:47], v21, s[24:27], s36 offen
    s_add_u32 s36, s36, 18432
    buffer_load_dwordx4 v[48:51], v21, s[24:27], s36 offen
    s_add_u32 s36, s36, 18432
    buffer_load_dwordx4 v[52:55], v21, s[24:27], s36 offen
    s_add_u32 s36, s36, 18432
    buffer_load_dwordx4 v[56:59], v21, s[24:27], s36 offen
    s_add_u32 s36, s36, 18432
    buffer_load_dwordx4 v[60:63], v21, s[24:27], s36 offen
    s_add_u32 s36, s36, 18432
    buffer_load_dwordx4 v[64:67], v21, s[24:27], s36 offen
    s_add_u32 s36, s36, 18432
    buffer_load_dwordx4 v[68:71], v21, s[24:27], s36 offen
    s_add_u32 s36, s36, 18432
    buffer_load_dwordx4 v[72:75], v21, s[24:27], s36 offen
    s_add_u32 s36, s36, 18432
    buffer_load_dwordx4 v[76:79], v21, s[24:27], s36 offen
    s_add_u32 s36, s36, 18432
    buffer_load_dwordx4 v[80:83], v21, s[24:27], s36 offen
    s_add_u32 s36, s36, 18432
    buffer_load_dwordx4 v[84:87], v21, s[24:27], s36 offen
    s_add_u32 s36, s36, 18432
    buffer_load_dwordx4 v[88:91], v21, s[24:27], s36 offen
    s_add_u32 s36, s36, 18432
    buffer_load_dwordx4 v[92:95], v21, s[24:27], s36 offen
    s_add_u32 s36, s36, 18432
    s_waitcnt vmcnt(15)
    ds_write_b128 v22, v[32:35] offset:0
    s_waitcnt vmcnt(14)
    ds_write_b128 v22, v[36:39] offset:1024
    s_waitcnt vmcnt(13)
    ds_write_b128 v22, v[40:43] offset:2048
    s_waitcnt vmcnt(12)
    ds_write_b128 v22, v[44:47] offset:3072
    s_waitcnt vmcnt(11)
    ds_write_b128 v22, v[48:51] offset:4096
    s_waitcnt vmcnt(10)
    ds_write_b128 v22, v[52:55] offset:5120
    s_waitcnt vmcnt(9)
    ds_write_b128 v22, v[56:59] offset:6144
    s_waitcnt vmcnt(8)
    ds_write_b128 v22, v[60:63] offset:7168
    s_waitcnt vmcnt(7)
    ds_write_b128 v22, v[64:67] offset:8192
    s_waitcnt vmcnt(6)
    ds_write_b128 v22, v[68:71] offset:9216
    s_waitcnt vmcnt(5)
    ds_write_b128 v22, v[72:75] offset:10240
    s_waitcnt vmcnt(4)
    ds_write_b128 v22, v[76:79] offset:11264
    s_waitcnt vmcnt(3)
    ds_write_b128 v22, v[80:83] offset:12288
    s_waitcnt vmcnt(2)
    ds_write_b128 v22, v[84:87] offset:13312
    s_waitcnt vmcnt(1)
    ds_write_b128 v22, v[88:91] offset:14336
    s_waitcnt vmcnt(0)
    ds_write_b128 v22, v[92:95] offset:15360
    s_waitcnt lgkmcnt(0)
    ds_read_b64_tr_b16 a[128:129], v23 offset:0
    ds_read_b64_tr_b16 a[130:131], v23 offset:1024
    ds_read_b64_tr_b16 a[132:133], v23 offset:32
    ds_read_b64_tr_b16 a[134:135], v23 offset:1056
    ds_read_b64_tr_b16 a[136:137], v23 offset:2048
    ds_read_b64_tr_b16 a[138:139], v23 offset:3072
    ds_read_b64_tr_b16 a[140:141], v23 offset:2080
    ds_read_b64_tr_b16 a[142:143], v23 offset:3104
    s_waitcnt lgkmcnt(0)
    ds_read_b64_tr_b16 a[144:145], v23 offset:4096
    ds_read_b64_tr_b16 a[146:147], v23 offset:5120
    ds_read_b64_tr_b16 a[148:149], v23 offset:4128
    ds_read_b64_tr_b16 a[150:151], v23 offset:5152
    ds_read_b64_tr_b16 a[152:153], v23 offset:6144
    ds_read_b64_tr_b16 a[154:155], v23 offset:7168
    ds_read_b64_tr_b16 a[156:157], v23 offset:6176
    ds_read_b64_tr_b16 a[158:159], v23 offset:7200
    s_waitcnt lgkmcnt(0)
    ds_read_b64_tr_b16 a[160:161], v23 offset:8192
    ds_read_b64_tr_b16 a[162:163], v23 offset:9216
    ds_read_b64_tr_b16 a[164:165], v23 offset:8224
    ds_read_b64_tr_b16 a[166:167], v23 offset:9248
    ds_read_b64_tr_b16 a[168:169], v23 offset:10240
    ds_read_b64_tr_b16 a[170:171], v23 offset:11264
    ds_read_b64_tr_b16 a[172:173], v23 offset:10272
    ds_read_b64_tr_b16 a[174:175], v23 offset:11296
    s_waitcnt lgkmcnt(0)
    ds_read_b64_tr_b16 a[176:177], v23 offset:12288
    ds_read_b64_tr_b16 a[178:179], v23 offset:13312
    ds_read_b64_tr_b16 a[180:181], v23 offset:12320
    ds_read_b64_tr_b16 a[182:183], v23 offset:13344
    ds_read_b64_tr_b16 a[184:185], v23 offset:14336
    ds_read_b64_tr_b16 a[186:187], v23 offset:15360
    ds_read_b64_tr_b16 a[188:189], v23 offset:14368
    ds_read_b64_tr_b16 a[190:191], v23 offset:15392
    s_waitcnt lgkmcnt(0)
    buffer_load_dwordx4 v[32:35], v21, s[24:27], s36 offen
    s_add_u32 s36, s36, 18432
    buffer_load_dwordx4 v[36:39], v21, s[24:27], s36 offen
    s_add_u32 s36, s36, 18432
    buffer_load_dwordx4 v[40:43], v21, s[24:27], s36 offen
    s_add_u32 s36, s36, 18432
    buffer_load_dwordx4 v[44:47], v21, s[24:27], s36 offen
    s_add_u32 s36, s36, 18432
    buffer_load_dwordx4 v[48:51], v21, s[24:27], s36 offen
    s_add_u32 s36, s36, 18432
    buffer_load_dwordx4 v[52:55], v21, s[24:27], s36 offen
    s_add_u32 s36, s36, 18432
    buffer_load_dwordx4 v[56:59], v21, s[24:27], s36 offen
    s_add_u32 s36, s36, 18432
    buffer_load_dwordx4 v[60:63], v21, s[24:27], s36 offen
    s_add_u32 s36, s36, 18432
    buffer_load_dwordx4 v[64:67], v21, s[24:27], s36 offen
    s_add_u32 s36, s36, 18432
    buffer_load_dwordx4 v[68:71], v21, s[24:27], s36 offen
    s_add_u32 s36, s36, 18432
    buffer_load_dwordx4 v[72:75], v21, s[24:27], s36 offen
    s_add_u32 s36, s36, 18432
    buffer_load_dwordx4 v[76:79], v21, s[24:27], s36 offen
    s_add_u32 s36, s36, 18432
    buffer_load_dwordx4 v[80:83], v21, s[24:27], s36 offen
    s_add_u32 s36, s36, 18432
    buffer_load_dwordx4 v[84:87], v21, s[24:27], s36 offen
    s_add_u32 s36, s36, 18432
    buffer_load_dwordx4 v[88:91], v21, s[24:27], s36 offen
    s_add_u32 s36, s36, 18432
    buffer_load_dwordx4 v[92:95], v21, s[24:27], s36 offen
    s_add_u32 s36, s36, 18432
    s_waitcnt vmcnt(15)
    ds_write_b128 v22, v[32:35] offset:0
    s_waitcnt vmcnt(14)
    ds_write_b128 v22, v[36:39] offset:1024
    s_waitcnt vmcnt(13)
    ds_write_b128 v22, v[40:43] offset:2048
    s_waitcnt vmcnt(12)
    ds_write_b128 v22, v[44:47] offset:3072
    s_waitcnt vmcnt(11)
    ds_write_b128 v22, v[48:51] offset:4096
    s_waitcnt vmcnt(10)
    ds_write_b128 v22, v[52:55] offset:5120
    s_waitcnt vmcnt(9)
    ds_write_b128 v22, v[56:59] offset:6144
    s_waitcnt vmcnt(8)
    ds_write_b128 v22, v[60:63] offset:7168
    s_waitcnt vmcnt(7)
    ds_write_b128 v22, v[64:67] offset:8192
    s_waitcnt vmcnt(6)
    ds_write_b128 v22, v[68:71] offset:9216
    s_waitcnt vmcnt(5)
    ds_write_b128 v22, v[72:75] offset:10240
    s_waitcnt vmcnt(4)
    ds_write_b128 v22, v[76:79] offset:11264
    s_waitcnt vmcnt(3)
    ds_write_b128 v22, v[80:83] offset:12288
    s_waitcnt vmcnt(2)
    ds_write_b128 v22, v[84:87] offset:13312
    s_waitcnt vmcnt(1)
    ds_write_b128 v22, v[88:91] offset:14336
    s_waitcnt vmcnt(0)
    ds_write_b128 v22, v[92:95] offset:15360
    s_waitcnt lgkmcnt(0)
    ds_read_b64_tr_b16 a[192:193], v23 offset:0
    ds_read_b64_tr_b16 a[194:195], v23 offset:1024
    ds_read_b64_tr_b16 a[196:197], v23 offset:32
    ds_read_b64_tr_b16 a[198:199], v23 offset:1056
    ds_read_b64_tr_b16 a[200:201], v23 offset:2048
    ds_read_b64_tr_b16 a[202:203], v23 offset:3072
    ds_read_b64_tr_b16 a[204:205], v23 offset:2080
    ds_read_b64_tr_b16 a[206:207], v23 offset:3104
    s_waitcnt lgkmcnt(0)
    ds_read_b64_tr_b16 a[208:209], v23 offset:4096
    ds_read_b64_tr_b16 a[210:211], v23 offset:5120
    ds_read_b64_tr_b16 a[212:213], v23 offset:4128
    ds_read_b64_tr_b16 a[214:215], v23 offset:5152
    ds_read_b64_tr_b16 a[216:217], v23 offset:6144
    ds_read_b64_tr_b16 a[218:219], v23 offset:7168
    ds_read_b64_tr_b16 a[220:221], v23 offset:6176
    ds_read_b64_tr_b16 a[222:223], v23 offset:7200
    s_waitcnt lgkmcnt(0)
    ds_read_b64_tr_b16 a[224:225], v23 offset:8192
    ds_read_b64_tr_b16 a[226:227], v23 offset:9216
    ds_read_b64_tr_b16 a[228:229], v23 offset:8224
    ds_read_b64_tr_b16 a[230:231], v23 offset:9248
    ds_read_b64_tr_b16 a[232:233], v23 offset:10240
    ds_read_b64_tr_b16 a[234:235], v23 offset:11264
    ds_read_b64_tr_b16 a[236:237], v23 offset:10272
    ds_read_b64_tr_b16 a[238:239], v23 offset:11296
    s_waitcnt lgkmcnt(0)
    ds_read_b64_tr_b16 a[240:241], v23 offset:12288
    ds_read_b64_tr_b16 a[242:243], v23 offset:13312
    ds_read_b64_tr_b16 a[244:245], v23 offset:12320
    ds_read_b64_tr_b16 a[246:247], v23 offset:13344
    ds_read_b64_tr_b16 a[248:249], v23 offset:14336
    ds_read_b64_tr_b16 a[250:251], v23 offset:15360
    ds_read_b64_tr_b16 a[252:253], v23 offset:14368
    ds_read_b64_tr_b16 a[254:255], v23 offset:15392
    s_waitcnt lgkmcnt(0)
    v_lshlrev_b32 v21, 1, v4
    s_lshl_b32 s35, s43, 6
    buffer_load_dwordx2 v[24:25], v21, s[52:55], s35 offen
    buffer_load_dwordx2 v[26:27], v21, s[52:55], s35 offen offset:32
    v_lshlrev_b32 v6, 5, v1
    s_lshl_b32 s36, s32, 11
    v_add_u32 v5, s36, v6
    v_mul_u32_u24 v7, 1152, v3
    v_add_u32 v7, v7, v21
    v_lshlrev_b32 v8, 12, v4
    v_lshl_add_u32 v8, v3, 1, v8
    s_mov_b32 s59, 0xffff0000
    s_waitcnt vmcnt(0)
    v_lshlrev_b32 v10, 16, v24
    v_and_b32 v11, s59, v24
    v_lshlrev_b32 v12, 16, v25
    v_and_b32 v13, s59, v25
    v_lshlrev_b32 v14, 16, v26
    v_and_b32 v15, s59, v26
    v_lshlrev_b32 v16, 16, v27
    v_and_b32 v17, s59, v27
    v_mov_b32 v20, 8192
OPJ_P0:
    buffer_load_dword v21, v20, s[4:7], 0 offen sc1
    buffer_load_dword v22, v20, s[4:7], 0 offen offset:64 sc1
    s_waitcnt vmcnt(0)
    v_readfirstlane_b32 s36, v21
    v_readfirstlane_b32 s37, v22
    s_cmp_lt_u32 s36, 576
    s_cbranch_scc1 OPJ_P0W
    s_cmp_ge_u32 s37, 64
    s_cbranch_scc1 OPJ_TASK
OPJ_P0W:
    s_sleep 16
    s_branch OPJ_P0
OPJ_TASK:
    s_cmp_ge_u32 s44, 128
    s_cbranch_scc1 OPJ_DONE
    s_lshr_b32 s40, s44, 1
    s_lshl_b32 s35, s40, 6
    v_mov_b32 v20, 4096
    s_mul_i32 s45, s44, 18432
    s_lshl_b32 s36, s43, 6
    s_add_u32 s45, s45, s36
    s_and_b32 s37, s32, 1
    s_lshl_b32 s36, s37, 5
    s_add_u32 s45, s45, s36
    s_lshl_b32 s46, s43, 17
    s_lshl_b32 s36, s37, 16
    s_add_u32 s46, s46, s36
    s_lshl_b32 s36, s44, 5
    s_add_u32 s46, s46, s36
    s_add_u32 s46, s46, 83886080
    s_lshl_b32 s47, s44, 6
    s_add_u32 s47, s47, 88080384
    v_lshlrev_b32 v21, 2, v3
    buffer_load_dwordx2 v[170:171], v7, s[48:51], s45 offen
    buffer_load_dword v172, v21, s[4:7], s47 offen sc1
    s_add_u32 s36, s46, 0
    buffer_load_ushort v174, v8, s[4:7], s36 offen sc1
    s_add_u32 s36, s46, 4096
    buffer_load_ushort v175, v8, s[4:7], s36 offen sc1
    s_add_u32 s36, s46, 8192
    buffer_load_ushort v176, v8, s[4:7], s36 offen sc1
    s_add_u32 s36, s46, 12288
    buffer_load_ushort v177, v8, s[4:7], s36 offen sc1
OPJ_P1:
    buffer_load_dword v21, v20, s[4:7], s35 offen sc1
    s_waitcnt vmcnt(0)
    v_readfirstlane_b32 s36, v21
    s_nop 0
    s_cmp_ge_u32 s36, 32
    s_cbranch_scc1 OPJ_P1OK
    s_sleep 2
    s_branch OPJ_P1
OPJ_P1OK:
    s_lshl_b32 s36, s44, 17
    s_add_u32 s36, s36, 67108864
    buffer_load_dwordx4 v[32:35], v2, s[4:7], s36 offen offset:0 sc1
    buffer_load_dwordx4 v[36:39], v2, s[4:7], s36 offen offset:1024 sc1
    buffer_load_dwordx4 v[40:43], v2, s[4:7], s36 offen offset:2048 sc1
    buffer_load_dwordx4 v[44:47], v2, s[4:7], s36 offen offset:3072 sc1
    s_add_u32 s36, s36, 4096
    buffer_load_dwordx4 v[48:51], v2, s[4:7], s36 offen offset:0 sc1
    buffer_load_dwordx4 v[52:55], v2, s[4:7], s36 offen offset:1024 sc1
    buffer_load_dwordx4 v[56:59], v2, s[4:7], s36 offen offset:2048 sc1
    buffer_load_dwordx4 v[60:63], v2, s[4:7], s36 offen offset:3072 sc1
    s_add_u32 s36, s36, 4096
    buffer_load_dwordx4 v[64:67], v2, s[4:7], s36 offen offset:0 sc1
    buffer_load_dwordx4 v[68:71], v2, s[4:7], s36 offen offset:1024 sc1
    buffer_load_dwordx4 v[72:75], v2, s[4:7], s36 offen offset:2048 sc1
    buffer_load_dwordx4 v[76:79], v2, s[4:7], s36 offen offset:3072 sc1
    s_add_u32 s36, s36, 4096
    buffer_load_dwordx4 v[80:83], v2, s[4:7], s36 offen offset:0 sc1
    buffer_load_dwordx4 v[84:87], v2, s[4:7], s36 offen offset:1024 sc1
    buffer_load_dwordx4 v[88:91], v2, s[4:7], s36 offen offset:2048 sc1
    buffer_load_dwordx4 v[92:95], v2, s[4:7], s36 offen offset:3072 sc1
    s_add_u32 s36, s36, 4096
    buffer_load_dwordx4 v[96:99], v2, s[4:7], s36 offen offset:0 sc1
    buffer_load_dwordx4 v[100:103], v2, s[4:7], s36 offen offset:1024 sc1
    buffer_load_dwordx4 v[104:107], v2, s[4:7], s36 offen offset:2048 sc1
    buffer_load_dwordx4 v[108:111], v2, s[4:7], s36 offen offset:3072 sc1
    s_add_u32 s36, s36, 4096
    buffer_load_dwordx4 v[112:115], v2, s[4:7], s36 offen offset:0 sc1
    buffer_load_dwordx4 v[116:119], v2, s[4:7], s36 offen offset:1024 sc1
    buffer_load_dwordx4 v[120:123], v2, s[4:7], s36 offen offset:2048 sc1
    buffer_load_dwordx4 v[124:127], v2, s[4:7], s36 offen offset:3072 sc1
    s_add_u32 s36, s36, 4096
    buffer_load_dwordx4 v[128:131], v2, s[4:7], s36 offen offset:0 sc1
    buffer_load_dwordx4 v[132:135], v2, s[4:7], s36 offen offset:1024 sc1
    buffer_load_dwordx4 v[136:139], v2, s[4:7], s36 offen offset:2048 sc1
    buffer_load_dwordx4 v[140:143], v2, s[4:7], s36 offen offset:3072 sc1
    s_add_u32 s36, s36, 4096
    buffer_load_dwordx4 v[144:147], v2, s[4:7], s36 offen offset:0 sc1
    buffer_load_dwordx4 v[148:151], v2, s[4:7], s36 offen offset:1024 sc1
    buffer_load_dwordx4 v[152:155], v2, s[4:7], s36 offen offset:2048 sc1
    buffer_load_dwordx4 v[156:159], v2, s[4:7], s36 offen offset:3072 sc1
    s_add_u32 s36, s36, 4096
    s_waitcnt vmcnt(31)
    v_mfma_f32_16x16x32_bf16 v[160:163], a[0:3], v[32:35], 0
    v_mfma_f32_16x16x32_bf16 v[164:167], a[4:7], v[32:35], 0
    s_waitcnt vmcnt(30)
    v_mfma_f32_16x16x32_bf16 v[160:163], a[8:11], v[36:39], v[160:163]
    v_mfma_f32_16x16x32_bf16 v[164:167], a[12:15], v[36:39], v[164:167]
    s_waitcnt vmcnt(29)
    v_mfma_f32_16x16x32_bf16 v[160:163], a[16:19], v[40:43], v[160:163]
    v_mfma_f32_16x16x32_bf16 v[164:167], a[20:23], v[40:43], v[164:167]
    s_waitcnt vmcnt(28)
    v_mfma_f32_16x16x32_bf16 v[160:163], a[24:27], v[44:47], v[160:163]
    v_mfma_f32_16x16x32_bf16 v[164:167], a[28:31], v[44:47], v[164:167]
    s_waitcnt vmcnt(27)
    v_mfma_f32_16x16x32_bf16 v[160:163], a[32:35], v[48:51], v[160:163]
    v_mfma_f32_16x16x32_bf16 v[164:167], a[36:39], v[48:51], v[164:167]
    s_waitcnt vmcnt(26)
    v_mfma_f32_16x16x32_bf16 v[160:163], a[40:43], v[52:55], v[160:163]
    v_mfma_f32_16x16x32_bf16 v[164:167], a[44:47], v[52:55], v[164:167]
    s_waitcnt vmcnt(25)
    v_mfma_f32_16x16x32_bf16 v[160:163], a[48:51], v[56:59], v[160:163]
    v_mfma_f32_16x16x32_bf16 v[164:167], a[52:55], v[56:59], v[164:167]
    s_waitcnt vmcnt(24)
    v_mfma_f32_16x16x32_bf16 v[160:163], a[56:59], v[60:63], v[160:163]
    v_mfma_f32_16x16x32_bf16 v[164:167], a[60:63], v[60:63], v[164:167]
    s_waitcnt vmcnt(23)
    v_mfma_f32_16x16x32_bf16 v[160:163], a[64:67], v[64:67], v[160:163]
    v_mfma_f32_16x16x32_bf16 v[164:167], a[68:71], v[64:67], v[164:167]
    s_waitcnt vmcnt(22)
    v_mfma_f32_16x16x32_bf16 v[160:163], a[72:75], v[68:71], v[160:163]
    v_mfma_f32_16x16x32_bf16 v[164:167], a[76:79], v[68:71], v[164:167]
    s_waitcnt vmcnt(21)
    v_mfma_f32_16x16x32_bf16 v[160:163], a[80:83], v[72:75], v[160:163]
    v_mfma_f32_16x16x32_bf16 v[164:167], a[84:87], v[72:75], v[164:167]
    s_waitcnt vmcnt(20)
    v_mfma_f32_16x16x32_bf16 v[160:163], a[88:91], v[76:79], v[160:163]
    v_mfma_f32_16x16x32_bf16 v[164:167], a[92:95], v[76:79], v[164:167]
    s_waitcnt vmcnt(19)
    v_mfma_f32_16x16x32_bf16 v[160:163], a[96:99], v[80:83], v[160:163]
    v_mfma_f32_16x16x32_bf16 v[164:167], a[100:103], v[80:83], v[164:167]
    s_waitcnt vmcnt(18)
    v_mfma_f32_16x16x32_bf16 v[160:163], a[104:107], v[84:87], v[160:163]
    v_mfma_f32_16x16x32_bf16 v[164:167], a[108:111], v[84:87], v[164:167]
    s_waitcnt vmcnt(17)
    v_mfma_f32_16x16x32_bf16 v[160:163], a[112:115], v[88:91], v[160:163]
    v_mfma_f32_16x16x32_bf16 v[164:167], a[116:119], v[88:91], v[164:167]
    s_waitcnt vmcnt(16)
    v_mfma_f32_16x16x32_bf16 v[160:163], a[120:123], v[92:95], v[160:163]
    v_mfma_f32_16x16x32_bf16 v[164:167], a[124:127], v[92:95], v[164:167]
    s_waitcnt vmcnt(15)
    v_mfma_f32_16x16x32_bf16 v[160:163], a[128:131], v[96:99], v[160:163]
    v_mfma_f32_16x16x32_bf16 v[164:167], a[132:135], v[96:99], v[164:167]
    s_waitcnt vmcnt(14)
    v_mfma_f32_16x16x32_bf16 v[160:163], a[136:139], v[100:103], v[160:163]
    v_mfma_f32_16x16x32_bf16 v[164:167], a[140:143], v[100:103], v[164:167]
    s_waitcnt vmcnt(13)
    v_mfma_f32_16x16x32_bf16 v[160:163], a[144:147], v[104:107], v[160:163]
    v_mfma_f32_16x16x32_bf16 v[164:167], a[148:151], v[104:107], v[164:167]
    s_waitcnt vmcnt(12)
    v_mfma_f32_16x16x32_bf16 v[160:163], a[152:155], v[108:111], v[160:163]
    v_mfma_f32_16x16x32_bf16 v[164:167], a[156:159], v[108:111], v[164:167]
    s_waitcnt vmcnt(11)
    v_mfma_f32_16x16x32_bf16 v[160:163], a[160:163], v[112:115], v[160:163]
    v_mfma_f32_16x16x32_bf16 v[164:167], a[164:167], v[112:115], v[164:167]
    s_waitcnt vmcnt(10)
    v_mfma_f32_16x16x32_bf16 v[160:163], a[168:171], v[116:119], v[160:163]
    v_mfma_f32_16x16x32_bf16 v[164:167], a[172:175], v[116:119], v[164:167]
    s_waitcnt vmcnt(9)
    v_mfma_f32_16x16x32_bf16 v[160:163], a[176:179], v[120:123], v[160:163]
    v_mfma_f32_16x16x32_bf16 v[164:167], a[180:183], v[120:123], v[164:167]
    s_waitcnt vmcnt(8)
    v_mfma_f32_16x16x32_bf16 v[160:163], a[184:187], v[124:127], v[160:163]
    v_mfma_f32_16x16x32_bf16 v[164:167], a[188:191], v[124:127], v[164:167]
    s_waitcnt vmcnt(7)
    v_mfma_f32_16x16x32_bf16 v[160:163], a[192:195], v[128:131], v[160:163]
    v_mfma_f32_16x16x32_bf16 v[164:167], a[196:199], v[128:131], v[164:167]
    s_waitcnt vmcnt(6)
    v_mfma_f32_16x16x32_bf16 v[160:163], a[200:203], v[132:135], v[160:163]
    v_mfma_f32_16x16x32_bf16 v[164:167], a[204:207], v[132:135], v[164:167]
    s_waitcnt vmcnt(5)
    v_mfma_f32_16x16x32_bf16 v[160:163], a[208:211], v[136:139], v[160:163]
    v_mfma_f32_16x16x32_bf16 v[164:167], a[212:215], v[136:139], v[164:167]
    s_waitcnt vmcnt(4)
    v_mfma_f32_16x16x32_bf16 v[160:163], a[216:219], v[140:143], v[160:163]
    v_mfma_f32_16x16x32_bf16 v[164:167], a[220:223], v[140:143], v[164:167]
    s_waitcnt vmcnt(3)
    v_mfma_f32_16x16x32_bf16 v[160:163], a[224:227], v[144:147], v[160:163]
    v_mfma_f32_16x16x32_bf16 v[164:167], a[228:231], v[144:147], v[164:167]
    s_waitcnt vmcnt(2)
    v_mfma_f32_16x16x32_bf16 v[160:163], a[232:235], v[148:151], v[160:163]
    v_mfma_f32_16x16x32_bf16 v[164:167], a[236:239], v[148:151], v[164:167]
    s_waitcnt vmcnt(1)
    v_mfma_f32_16x16x32_bf16 v[160:163], a[240:243], v[152:155], v[160:163]
    v_mfma_f32_16x16x32_bf16 v[164:167], a[244:247], v[152:155], v[164:167]
    s_waitcnt vmcnt(0)
    v_mfma_f32_16x16x32_bf16 v[160:163], a[248:251], v[156:159], v[160:163]
    v_mfma_f32_16x16x32_bf16 v[164:167], a[252:255], v[156:159], v[164:167]
    s_nop 6
    ds_write_b128 v5, v[160:163]
    ds_write_b128 v5, v[164:167] offset:16
    s_waitcnt lgkmcnt(0)
    s_barrier
    s_cmp_ge_u32 s32, 2
    s_cbranch_scc1 OPJ_NEXT
    s_lshl_b32 s36, s32, 4
    v_add_u32 v21, s36, v6
    ds_read_b128 v[32:35], v21
    ds_read_b128 v[36:39], v21 offset:2048
    ds_read_b128 v[40:43], v21 offset:4096
    ds_read_b128 v[44:47], v21 offset:6144
    s_waitcnt lgkmcnt(0)
    v_add_f32 v32, v32, v36
    v_add_f32 v40, v40, v44
    v_add_f32 v32, v32, v40
    v_add_f32 v33, v33, v37
    v_add_f32 v41, v41, v45
    v_add_f32 v33, v33, v41
    v_add_f32 v34, v34, v38
    v_add_f32 v42, v42, v46
    v_add_f32 v34, v34, v42
    v_add_f32 v35, v35, v39
    v_add_f32 v43, v43, v47
    v_add_f32 v35, v35, v43
    v_cvt_pk_bf16_f32 v60, v32, v33
    v_lshlrev_b32 v32, 16, v60
    v_and_b32 v33, s59, v60
    v_cvt_pk_bf16_f32 v60, v34, v35
    v_lshlrev_b32 v34, 16, v60
    v_and_b32 v35, s59, v60
    v_lshlrev_b32 v36, 16, v170
    v_and_b32 v37, s59, v170
    v_lshlrev_b32 v38, 16, v171
    v_and_b32 v39, s59, v171
    s_cmp_eq_u32 s32, 0
    s_cselect_b64 vcc, -1, 0
    v_cndmask_b32 v40, v14, v10, vcc
    v_cndmask_b32 v41, v15, v11, vcc
    v_cndmask_b32 v42, v16, v12, vcc
    v_cndmask_b32 v43, v17, v13, vcc
    v_mul_f32 v36, v36, v40
    v_mul_f32 v37, v37, v41
    v_mul_f32 v38, v38, v42
    v_mul_f32 v39, v39, v43
    v_cvt_pk_bf16_f32 v60, v36, v37
    v_lshlrev_b32 v36, 16, v60
    v_and_b32 v37, s59, v60
    v_cvt_pk_bf16_f32 v60, v38, v39
    v_lshlrev_b32 v38, 16, v60
    v_and_b32 v39, s59, v60
    v_lshlrev_b32 v174, 16, v174
    v_add_f32 v36, v36, v174
    v_lshlrev_b32 v175, 16, v175
    v_add_f32 v37, v37, v175
    v_lshlrev_b32 v176, 16, v176
    v_add_f32 v38, v38, v176
    v_lshlrev_b32 v177, 16, v177
    v_add_f32 v39, v39, v177
    v_cvt_pk_bf16_f32 v60, v36, v37
    v_lshlrev_b32 v36, 16, v60
    v_and_b32 v37, s59, v60
    v_cvt_pk_bf16_f32 v60, v38, v39
    v_lshlrev_b32 v38, 16, v60
    v_and_b32 v39, s59, v60
    v_sub_f32 v44, 1.0, v172
    v_cvt_pk_bf16_f32 v60, v44, v44
    v_lshlrev_b32 v44, 16, v60
    v_mul_f32 v36, v172, v36
    v_mul_f32 v32, v44, v32
    v_mul_f32 v37, v172, v37
    v_mul_f32 v33, v44, v33
    v_mul_f32 v38, v172, v38
    v_mul_f32 v34, v44, v34
    v_mul_f32 v39, v172, v39
    v_mul_f32 v35, v44, v35
    v_cvt_pk_bf16_f32 v60, v36, v37
    v_lshlrev_b32 v36, 16, v60
    v_and_b32 v37, s59, v60
    v_cvt_pk_bf16_f32 v60, v38, v39
    v_lshlrev_b32 v38, 16, v60
    v_and_b32 v39, s59, v60
    v_cvt_pk_bf16_f32 v60, v32, v33
    v_lshlrev_b32 v32, 16, v60
    v_and_b32 v33, s59, v60
    v_cvt_pk_bf16_f32 v60, v34, v35
    v_lshlrev_b32 v34, 16, v60
    v_and_b32 v35, s59, v60
    v_add_f32 v32, v32, v36
    v_add_f32 v33, v33, v37
    v_add_f32 v34, v34, v38
    v_add_f32 v35, v35, v39
    v_cvt_pk_bf16_f32 v40, v32, v33
    v_cvt_pk_bf16_f32 v41, v34, v35
    buffer_store_dwordx2 v[40:41], v7, s[28:31], s45 offen
OPJ_NEXT:
    s_barrier
    s_add_u32 s44, s44, 10
    s_branch OPJ_TASK
OPJ_DONE:
    s_endpgm
ATT:
    v_and_b32 v1, 63, v0
    v_and_b32 v6, 15, v1
    v_lshrrev_b32 v8, 4, v1
    v_lshlrev_b32 v7, 2, v8
    v_lshlrev_b32 v9, 8, v6
    v_lshl_add_u32 v2, v8, 4, v9
    v_lshlrev_b32 v9, 6, v6
    v_lshl_add_u32 v3, v8, 4, v9
    v_and_b32 v10, 1, v8
    v_lshlrev_b32 v9, 4, v6
    v_lshl_add_u32 v4, v10, 3, v9
    v_lshlrev_b32 v5, 4, v1
    s_sub_u32 s42, s33, 180
    s_mov_b32 s56, 0xce6e6b28
    s_mov_b32 s57, 0x3db504f3
    s_mov_b32 s58, 0x3fb8aa3b
    s_mov_b32 s59, 0xffff0000
ATT_TASK:
    s_cmp_ge_u32 s42, 512
    s_cbranch_scc1 ATT_DONE
    s_lshr_b32 s40, s42, 3
    s_and_b32 s41, s42, 7
    s_lshl_b32 s41, s41, 2
    s_add_u32 s41, s41, s32
    s_lshr_b32 s35, s40, 2
    s_lshl_b32 s35, s35, 6
    v_mov_b32 v8, 1024
ATT_P1:
    buffer_load_dwordx2 v[10:11], v8, s[4:7], s35 offen sc1
    s_waitcnt vmcnt(0)
    v_and_b32 v9, v10, v11
    s_nop 0
    v_readfirstlane_b32 s36, v9
    s_nop 0
    s_lshr_b32 s36, s36, s41
    s_bitcmp1_b32 s36, 0
    s_cbranch_scc1 ATT_P1OK
    s_sleep 8
    s_branch ATT_P1
ATT_P1OK:
    s_lshl_b32 s35, s41, 6
    s_add_u32 s35, s35, s40
    s_lshl_b32 s45, s35, 13
    s_add_u32 s36, s45, 16777216
    buffer_load_dwordx4 v[16:19], v2, s[4:7], s36 offen offset:0 sc1
    buffer_load_dwordx4 v[20:23], v2, s[4:7], s36 offen offset:64 sc1
    buffer_load_dwordx4 v[24:27], v2, s[4:7], s36 offen offset:128 sc1
    buffer_load_dwordx4 v[28:31], v2, s[4:7], s36 offen offset:192 sc1
    s_add_u32 s36, s45, 16781312
    buffer_load_dwordx4 v[32:35], v2, s[4:7], s36 offen offset:0 sc1
    buffer_load_dwordx4 v[36:39], v2, s[4:7], s36 offen offset:64 sc1
    buffer_load_dwordx4 v[40:43], v2, s[4:7], s36 offen offset:128 sc1
    buffer_load_dwordx4 v[44:47], v2, s[4:7], s36 offen offset:192 sc1
    s_add_u32 s36, s45, 33554432
    buffer_load_dwordx4 v[48:51], v2, s[4:7], s36 offen offset:0 sc1
    buffer_load_dwordx4 v[52:55], v2, s[4:7], s36 offen offset:64 sc1
    buffer_load_dwordx4 v[56:59], v2, s[4:7], s36 offen offset:128 sc1
    buffer_load_dwordx4 v[60:63], v2, s[4:7], s36 offen offset:192 sc1
    s_add_u32 s36, s45, 33558528
    buffer_load_dwordx4 v[64:67], v2, s[4:7], s36 offen offset:0 sc1
    buffer_load_dwordx4 v[68:71], v2, s[4:7], s36 offen offset:64 sc1
    buffer_load_dwordx4 v[72:75], v2, s[4:7], s36 offen offset:128 sc1
    buffer_load_dwordx4 v[76:79], v2, s[4:7], s36 offen offset:192 sc1
    s_add_u32 s36, s45, 50331648
    buffer_load_dwordx4 v[96:99], v3, s[4:7], s36 offen offset:0 sc1
    buffer_load_dwordx4 v[100:103], v3, s[4:7], s36 offen offset:1024 sc1
    buffer_load_dwordx4 v[104:107], v3, s[4:7], s36 offen offset:2048 sc1
    buffer_load_dwordx4 v[108:111], v3, s[4:7], s36 offen offset:3072 sc1
    s_add_u32 s36, s45, 50335744
    buffer_load_dwordx4 v[112:115], v3, s[4:7], s36 offen offset:0 sc1
    buffer_load_dwordx4 v[116:119], v3, s[4:7], s36 offen offset:1024 sc1
    buffer_load_dwordx4 v[120:123], v3, s[4:7], s36 offen offset:2048 sc1
    buffer_load_dwordx4 v[124:127], v3, s[4:7], s36 offen offset:3072 sc1
    s_lshl_b32 s37, s41, 4
    v_mov_b32 v8, 0
ATT_P2:
    buffer_load_dwordx4 v[12:15], v8, s[4:7], s37 offen sc1
    s_waitcnt vmcnt(0)
    v_min_u32 v12, v12, v13
    v_min3_u32 v12, v12, v14, v15
    s_nop 0
    v_readfirstlane_b32 s36, v12
    s_nop 0
    s_cmp_gt_u32 s36, s40
    s_cbranch_scc1 ATT_P2OK
    s_sleep 2
    s_branch ATT_P2
ATT_P2OK:
    s_lshl_b32 s36, s35, 12
    s_add_u32 s36, s36, 100663296
    s_lshl_b32 s37, s35, 11
    s_add_u32 s37, s37, 8388608
    buffer_load_dwordx4 v[80:83], v2, s[4:7], s36 offen offset:0 sc1
    buffer_load_dwordx4 v[84:87], v2, s[4:7], s36 offen offset:64 sc1
    buffer_load_dwordx4 v[88:91], v2, s[4:7], s36 offen offset:128 sc1
    buffer_load_dwordx4 v[92:95], v2, s[4:7], s36 offen offset:192 sc1
    buffer_load_dwordx2 v[128:129], v4, s[4:7], s37 offen offset:0 sc1
    buffer_load_dwordx2 v[130:131], v4, s[4:7], s37 offen offset:256 sc1
    buffer_load_dwordx2 v[132:133], v4, s[4:7], s37 offen offset:512 sc1
    buffer_load_dwordx2 v[134:135], v4, s[4:7], s37 offen offset:768 sc1
    buffer_load_dwordx2 v[136:137], v4, s[4:7], s37 offen offset:1024 sc1
    buffer_load_dwordx2 v[138:139], v4, s[4:7], s37 offen offset:1280 sc1
    buffer_load_dwordx2 v[140:141], v4, s[4:7], s37 offen offset:1536 sc1
    buffer_load_dwordx2 v[142:143], v4, s[4:7], s37 offen offset:1792 sc1
    v_mfma_f32_16x16x32_bf16 v[152:155], v[48:51], v[16:19], 0
    v_mfma_f32_16x16x32_bf16 v[152:155], v[52:55], v[20:23], v[152:155]
    v_mfma_f32_16x16x32_bf16 v[152:155], v[56:59], v[24:27], v[152:155]
    v_mfma_f32_16x16x32_bf16 v[152:155], v[60:63], v[28:31], v[152:155]
    v_mfma_f32_16x16x32_bf16 v[156:159], v[48:51], v[32:35], 0
    v_mfma_f32_16x16x32_bf16 v[156:159], v[52:55], v[36:39], v[156:159]
    v_mfma_f32_16x16x32_bf16 v[156:159], v[56:59], v[40:43], v[156:159]
    v_mfma_f32_16x16x32_bf16 v[156:159], v[60:63], v[44:47], v[156:159]
    v_mfma_f32_16x16x32_bf16 v[164:167], v[64:67], v[32:35], 0
    v_mfma_f32_16x16x32_bf16 v[164:167], v[68:71], v[36:39], v[164:167]
    v_mfma_f32_16x16x32_bf16 v[164:167], v[72:75], v[40:43], v[164:167]
    v_mfma_f32_16x16x32_bf16 v[164:167], v[76:79], v[44:47], v[164:167]
    s_waitcnt vmcnt(8)
    v_mfma_f32_16x16x32_bf16 v[144:147], v[80:83], v[16:19], 0
    v_mfma_f32_16x16x32_bf16 v[144:147], v[84:87], v[20:23], v[144:147]
    v_mfma_f32_16x16x32_bf16 v[144:147], v[88:91], v[24:27], v[144:147]
    v_mfma_f32_16x16x32_bf16 v[144:147], v[92:95], v[28:31], v[144:147]
    v_mfma_f32_16x16x32_bf16 v[148:151], v[80:83], v[32:35], 0
    v_mfma_f32_16x16x32_bf16 v[148:151], v[84:87], v[36:39], v[148:151]
    v_mfma_f32_16x16x32_bf16 v[148:151], v[88:91], v[40:43], v[148:151]
    v_mfma_f32_16x16x32_bf16 v[148:151], v[92:95], v[44:47], v[148:151]
    v_cmp_gt_u32 s[60:61], 8, v7
    v_add_u32 v8, 0, v7
    v_cmp_le_u32 s[62:63], v8, v6
    v_add_u32 v8, 1, v7
    v_cmp_le_u32 s[64:65], v8, v6
    v_add_u32 v8, 2, v7
    v_cmp_le_u32 s[66:67], v8, v6
    v_add_u32 v8, 3, v7
    v_cmp_le_u32 s[68:69], v8, v6
    v_mov_b32 v9, s56
    v_cvt_pk_bf16_f32 v244, v144, v145
    v_lshlrev_b32 v144, 16, v244
    v_and_b32 v145, s59, v244
    v_cvt_pk_bf16_f32 v244, v146, v147
    v_lshlrev_b32 v146, 16, v244
    v_and_b32 v147, s59, v244
    v_cvt_pk_bf16_f32 v244, v152, v153
    v_lshlrev_b32 v152, 16, v244
    v_and_b32 v153, s59, v244
    v_cvt_pk_bf16_f32 v244, v154, v155
    v_lshlrev_b32 v154, 16, v244
    v_and_b32 v155, s59, v244
    v_mul_f32 v144, s57, v144
    v_mul_f32 v145, s57, v145
    v_mul_f32 v146, s57, v146
    v_mul_f32 v147, s57, v147
    v_mul_f32 v152, s57, v152
    v_mul_f32 v153, s57, v153
    v_mul_f32 v154, s57, v154
    v_mul_f32 v155, s57, v155
    v_cvt_pk_bf16_f32 v244, v144, v145
    v_lshlrev_b32 v144, 16, v244
    v_and_b32 v145, s59, v244
    v_cvt_pk_bf16_f32 v244, v146, v147
    v_lshlrev_b32 v146, 16, v244
    v_and_b32 v147, s59, v244
    v_cvt_pk_bf16_f32 v244, v152, v153
    v_lshlrev_b32 v152, 16, v244
    v_and_b32 v153, s59, v244
    v_cvt_pk_bf16_f32 v244, v154, v155
    v_lshlrev_b32 v154, 16, v244
    v_and_b32 v155, s59, v244
    v_cndmask_b32 v144, v9, v144, s[60:61]
    v_cndmask_b32 v152, v9, v152, s[62:63]
    v_cndmask_b32 v145, v9, v145, s[60:61]
    v_cndmask_b32 v153, v9, v153, s[64:65]
    v_cndmask_b32 v146, v9, v146, s[60:61]
    v_cndmask_b32 v154, v9, v154, s[66:67]
    v_cndmask_b32 v147, v9, v147, s[60:61]
    v_cndmask_b32 v155, v9, v155, s[68:69]
    v_max3_f32 v245, v144, v145, v146
    v_max3_f32 v245, v245, v147, v152
    v_max3_f32 v245, v245, v153, v154
    v_max_f32 v245, v245, v155
    v_mov_b32 v246, v245
    s_nop 1
    v_permlane16_swap_b32 v246, v245
    v_max_f32 v245, v245, v246
    v_mov_b32 v246, v245
    s_nop 1
    v_permlane32_swap_b32 v246, v245
    v_max_f32 v245, v245, v246
    v_sub_f32 v144, v144, v245
    v_mul_f32 v144, s58, v144
    v_exp_f32 v144, v144
    v_sub_f32 v145, v145, v245
    v_mul_f32 v145, s58, v145
    v_exp_f32 v145, v145
    v_sub_f32 v146, v146, v245
    v_mul_f32 v146, s58, v146
    v_exp_f32 v146, v146
    v_sub_f32 v147, v147, v245
    v_mul_f32 v147, s58, v147
    v_exp_f32 v147, v147
    v_sub_f32 v152, v152, v245
    v_mul_f32 v152, s58, v152
    v_exp_f32 v152, v152
    v_sub_f32 v153, v153, v245
    v_mul_f32 v153, s58, v153
    v_exp_f32 v153, v153
    v_sub_f32 v154, v154, v245
    v_mul_f32 v154, s58, v154
    v_exp_f32 v154, v154
    v_sub_f32 v155, v155, v245
    v_mul_f32 v155, s58, v155
    v_exp_f32 v155, v155
    v_add_f32 v245, v144, v145
    v_add_f32 v245, v245, v146
    v_add_f32 v245, v245, v147
    v_add_f32 v245, v245, v152
    v_add_f32 v245, v245, v153
    v_add_f32 v245, v245, v154
    v_add_f32 v245, v245, v155
    v_mov_b32 v246, v245
    s_nop 1
    v_permlane16_swap_b32 v246, v245
    v_add_f32 v245, v245, v246
    v_mov_b32 v246, v245
    s_nop 1
    v_permlane32_swap_b32 v246, v245
    v_add_f32 v245, v245, v246
    v_rcp_f32 v245, v245
    s_nop 0
    v_mul_f32 v144, v144, v245
    v_mul_f32 v145, v145, v245
    v_mul_f32 v146, v146, v245
    v_mul_f32 v147, v147, v245
    v_mul_f32 v152, v152, v245
    v_mul_f32 v153, v153, v245
    v_mul_f32 v154, v154, v245
    v_mul_f32 v155, v155, v245
    v_cvt_pk_bf16_f32 v176, v144, v145
    v_cvt_pk_bf16_f32 v177, v146, v147
    v_cvt_pk_bf16_f32 v168, v152, v153
    v_cvt_pk_bf16_f32 v169, v154, v155
    v_mov_b32 v170, 0
    v_mov_b32 v171, 0
    v_cvt_pk_bf16_f32 v244, v148, v149
    v_lshlrev_b32 v148, 16, v244
    v_and_b32 v149, s59, v244
    v_cvt_pk_bf16_f32 v244, v150, v151
    v_lshlrev_b32 v150, 16, v244
    v_and_b32 v151, s59, v244
    v_cvt_pk_bf16_f32 v244, v156, v157
    v_lshlrev_b32 v156, 16, v244
    v_and_b32 v157, s59, v244
    v_cvt_pk_bf16_f32 v244, v158, v159
    v_lshlrev_b32 v158, 16, v244
    v_and_b32 v159, s59, v244
    v_cvt_pk_bf16_f32 v244, v164, v165
    v_lshlrev_b32 v164, 16, v244
    v_and_b32 v165, s59, v244
    v_cvt_pk_bf16_f32 v244, v166, v167
    v_lshlrev_b32 v166, 16, v244
    v_and_b32 v167, s59, v244
    v_mul_f32 v148, s57, v148
    v_mul_f32 v149, s57, v149
    v_mul_f32 v150, s57, v150
    v_mul_f32 v151, s57, v151
    v_mul_f32 v156, s57, v156
    v_mul_f32 v157, s57, v157
    v_mul_f32 v158, s57, v158
    v_mul_f32 v159, s57, v159
    v_mul_f32 v164, s57, v164
    v_mul_f32 v165, s57, v165
    v_mul_f32 v166, s57, v166
    v_mul_f32 v167, s57, v167
    v_cvt_pk_bf16_f32 v244, v148, v149
    v_lshlrev_b32 v148, 16, v244
    v_and_b32 v149, s59, v244
    v_cvt_pk_bf16_f32 v244, v150, v151
    v_lshlrev_b32 v150, 16, v244
    v_and_b32 v151, s59, v244
    v_cvt_pk_bf16_f32 v244, v156, v157
    v_lshlrev_b32 v156, 16, v244
    v_and_b32 v157, s59, v244
    v_cvt_pk_bf16_f32 v244, v158, v159
    v_lshlrev_b32 v158, 16, v244
    v_and_b32 v159, s59, v244
    v_cvt_pk_bf16_f32 v244, v164, v165
    v_lshlrev_b32 v164, 16, v244
    v_and_b32 v165, s59, v244
    v_cvt_pk_bf16_f32 v244, v166, v167
    v_lshlrev_b32 v166, 16, v244
    v_and_b32 v167, s59, v244
    v_cndmask_b32 v148, v9, v148, s[60:61]
    v_cndmask_b32 v164, v9, v164, s[62:63]
    v_cndmask_b32 v149, v9, v149, s[60:61]
    v_cndmask_b32 v165, v9, v165, s[64:65]
    v_cndmask_b32 v150, v9, v150, s[60:61]
    v_cndmask_b32 v166, v9, v166, s[66:67]
    v_cndmask_b32 v151, v9, v151, s[60:61]
    v_cndmask_b32 v167, v9, v167, s[68:69]
    v_max3_f32 v245, v148, v149, v150
    v_max3_f32 v245, v245, v151, v156
    v_max3_f32 v245, v245, v157, v158
    v_max3_f32 v245, v245, v159, v164
    v_max3_f32 v245, v245, v165, v166
    v_max_f32 v245, v245, v167
    v_mov_b32 v246, v245
    s_nop 1
    v_permlane16_swap_b32 v246, v245
    v_max_f32 v245, v245, v246
    v_mov_b32 v246, v245
    s_nop 1
    v_permlane32_swap_b32 v246, v245
    v_max_f32 v245, v245, v246
    v_sub_f32 v148, v148, v245
    v_mul_f32 v148, s58, v148
    v_exp_f32 v148, v148
    v_sub_f32 v149, v149, v245
    v_mul_f32 v149, s58, v149
    v_exp_f32 v149, v149
    v_sub_f32 v150, v150, v245
    v_mul_f32 v150, s58, v150
    v_exp_f32 v150, v150
    v_sub_f32 v151, v151, v245
    v_mul_f32 v151, s58, v151
    v_exp_f32 v151, v151
    v_sub_f32 v156, v156, v245
    v_mul_f32 v156, s58, v156
    v_exp_f32 v156, v156
    v_sub_f32 v157, v157, v245
    v_mul_f32 v157, s58, v157
    v_exp_f32 v157, v157
    v_sub_f32 v158, v158, v245
    v_mul_f32 v158, s58, v158
    v_exp_f32 v158, v158
    v_sub_f32 v159, v159, v245
    v_mul_f32 v159, s58, v159
    v_exp_f32 v159, v159
    v_sub_f32 v164, v164, v245
    v_mul_f32 v164, s58, v164
    v_exp_f32 v164, v164
    v_sub_f32 v165, v165, v245
    v_mul_f32 v165, s58, v165
    v_exp_f32 v165, v165
    v_sub_f32 v166, v166, v245
    v_mul_f32 v166, s58, v166
    v_exp_f32 v166, v166
    v_sub_f32 v167, v167, v245
    v_mul_f32 v167, s58, v167
    v_exp_f32 v167, v167
    v_add_f32 v245, v148, v149
    v_add_f32 v245, v245, v150
    v_add_f32 v245, v245, v151
    v_add_f32 v245, v245, v156
    v_add_f32 v245, v245, v157
    v_add_f32 v245, v245, v158
    v_add_f32 v245, v245, v159
    v_add_f32 v245, v245, v164
    v_add_f32 v245, v245, v165
    v_add_f32 v245, v245, v166
    v_add_f32 v245, v245, v167
    v_mov_b32 v246, v245
    s_nop 1
    v_permlane16_swap_b32 v246, v245
    v_add_f32 v245, v245, v246
    v_mov_b32 v246, v245
    s_nop 1
    v_permlane32_swap_b32 v246, v245
    v_add_f32 v245, v245, v246
    v_rcp_f32 v245, v245
    s_nop 0
    v_mul_f32 v148, v148, v245
    v_mul_f32 v149, v149, v245
    v_mul_f32 v150, v150, v245
    v_mul_f32 v151, v151, v245
    v_mul_f32 v156, v156, v245
    v_mul_f32 v157, v157, v245
    v_mul_f32 v158, v158, v245
    v_mul_f32 v159, v159, v245
    v_mul_f32 v164, v164, v245
    v_mul_f32 v165, v165, v245
    v_mul_f32 v166, v166, v245
    v_mul_f32 v167, v167, v245
    v_cvt_pk_bf16_f32 v178, v148, v149
    v_cvt_pk_bf16_f32 v179, v150, v151
    v_cvt_pk_bf16_f32 v172, v156, v157
    v_cvt_pk_bf16_f32 v173, v158, v159
    v_cvt_pk_bf16_f32 v174, v164, v165
    v_cvt_pk_bf16_f32 v175, v166, v167
    s_waitcnt vmcnt(0)
    v_mfma_f32_16x16x32_bf16 v[180:183], v[96:99], v[168:171], 0
    v_mfma_f32_16x16x32_bf16 v[184:187], v[100:103], v[168:171], 0
    v_mfma_f32_16x16x32_bf16 v[188:191], v[104:107], v[168:171], 0
    v_mfma_f32_16x16x32_bf16 v[192:195], v[108:111], v[168:171], 0
    v_mfma_f32_16x16x32_bf16 v[196:199], v[112:115], v[168:171], 0
    v_mfma_f32_16x16x32_bf16 v[200:203], v[116:119], v[168:171], 0
    v_mfma_f32_16x16x32_bf16 v[204:207], v[120:123], v[168:171], 0
    v_mfma_f32_16x16x32_bf16 v[208:211], v[124:127], v[168:171], 0
    v_mfma_f32_16x16x32_bf16 v[212:215], v[96:99], v[172:175], 0
    v_mfma_f32_16x16x32_bf16 v[216:219], v[100:103], v[172:175], 0
    v_mfma_f32_16x16x32_bf16 v[220:223], v[104:107], v[172:175], 0
    v_mfma_f32_16x16x32_bf16 v[224:227], v[108:111], v[172:175], 0
    v_mfma_f32_16x16x32_bf16 v[228:231], v[112:115], v[172:175], 0
    v_mfma_f32_16x16x32_bf16 v[232:235], v[116:119], v[172:175], 0
    v_mfma_f32_16x16x32_bf16 v[236:239], v[120:123], v[172:175], 0
    v_mfma_f32_16x16x32_bf16 v[240:243], v[124:127], v[172:175], 0
    v_mfma_f32_16x16x16_bf16 v[180:183], v[128:129], v[176:177], v[180:183]
    v_mfma_f32_16x16x16_bf16 v[184:187], v[130:131], v[176:177], v[184:187]
    v_mfma_f32_16x16x16_bf16 v[188:191], v[132:133], v[176:177], v[188:191]
    v_mfma_f32_16x16x16_bf16 v[192:195], v[134:135], v[176:177], v[192:195]
    v_mfma_f32_16x16x16_bf16 v[196:199], v[136:137], v[176:177], v[196:199]
    v_mfma_f32_16x16x16_bf16 v[200:203], v[138:139], v[176:177], v[200:203]
    v_mfma_f32_16x16x16_bf16 v[204:207], v[140:141], v[176:177], v[204:207]
    v_mfma_f32_16x16x16_bf16 v[208:211], v[142:143], v[176:177], v[208:211]
    v_mfma_f32_16x16x16_bf16 v[212:215], v[128:129], v[178:179], v[212:215]
    v_mfma_f32_16x16x16_bf16 v[216:219], v[130:131], v[178:179], v[216:219]
    v_mfma_f32_16x16x16_bf16 v[220:223], v[132:133], v[178:179], v[220:223]
    v_mfma_f32_16x16x16_bf16 v[224:227], v[134:135], v[178:179], v[224:227]
    v_mfma_f32_16x16x16_bf16 v[228:231], v[136:137], v[178:179], v[228:231]
    v_mfma_f32_16x16x16_bf16 v[232:235], v[138:139], v[178:179], v[232:235]
    v_mfma_f32_16x16x16_bf16 v[236:239], v[140:141], v[178:179], v[236:239]
    v_mfma_f32_16x16x16_bf16 v[240:243], v[142:143], v[178:179], v[240:243]
    s_lshl_b32 s36, s40, 18
    s_lshl_b32 s37, s41, 12
    s_add_u32 s36, s36, s37
    s_add_u32 s36, s36, 67108864
    s_add_u32 s37, s36, 131072
    v_cvt_pk_bf16_f32 v16, v180, v181
    v_cvt_pk_bf16_f32 v17, v182, v183
    v_cvt_pk_bf16_f32 v18, v184, v185
    v_cvt_pk_bf16_f32 v19, v186, v187
    buffer_store_dwordx4 v[16:19], v5, s[4:7], s36 offen offset:0 sc1
    v_cvt_pk_bf16_f32 v20, v188, v189
    v_cvt_pk_bf16_f32 v21, v190, v191
    v_cvt_pk_bf16_f32 v22, v192, v193
    v_cvt_pk_bf16_f32 v23, v194, v195
    buffer_store_dwordx4 v[20:23], v5, s[4:7], s36 offen offset:1024 sc1
    v_cvt_pk_bf16_f32 v24, v196, v197
    v_cvt_pk_bf16_f32 v25, v198, v199
    v_cvt_pk_bf16_f32 v26, v200, v201
    v_cvt_pk_bf16_f32 v27, v202, v203
    buffer_store_dwordx4 v[24:27], v5, s[4:7], s36 offen offset:2048 sc1
    v_cvt_pk_bf16_f32 v28, v204, v205
    v_cvt_pk_bf16_f32 v29, v206, v207
    v_cvt_pk_bf16_f32 v30, v208, v209
    v_cvt_pk_bf16_f32 v31, v210, v211
    buffer_store_dwordx4 v[28:31], v5, s[4:7], s36 offen offset:3072 sc1
    v_cvt_pk_bf16_f32 v32, v212, v213
    v_cvt_pk_bf16_f32 v33, v214, v215
    v_cvt_pk_bf16_f32 v34, v216, v217
    v_cvt_pk_bf16_f32 v35, v218, v219
    buffer_store_dwordx4 v[32:35], v5, s[4:7], s37 offen offset:0 sc1
    v_cvt_pk_bf16_f32 v36, v220, v221
    v_cvt_pk_bf16_f32 v37, v222, v223
    v_cvt_pk_bf16_f32 v38, v224, v225
    v_cvt_pk_bf16_f32 v39, v226, v227
    buffer_store_dwordx4 v[36:39], v5, s[4:7], s37 offen offset:1024 sc1
    v_cvt_pk_bf16_f32 v40, v228, v229
    v_cvt_pk_bf16_f32 v41, v230, v231
    v_cvt_pk_bf16_f32 v42, v232, v233
    v_cvt_pk_bf16_f32 v43, v234, v235
    buffer_store_dwordx4 v[40:43], v5, s[4:7], s37 offen offset:2048 sc1
    v_cvt_pk_bf16_f32 v44, v236, v237
    v_cvt_pk_bf16_f32 v45, v238, v239
    v_cvt_pk_bf16_f32 v46, v240, v241
    v_cvt_pk_bf16_f32 v47, v242, v243
    buffer_store_dwordx4 v[44:47], v5, s[4:7], s37 offen offset:3072 sc1
    s_waitcnt vmcnt(0)
    s_lshl_b32 s36, s40, 6
    s_add_u32 s36, s36, 4096
    v_mov_b32 v8, 1
    v_mov_b32 v9, s36
    s_mov_b64 exec, 1
    buffer_atomic_add v8, v9, s[4:7], 0 offen
    s_mov_b64 exec, -1
    s_add_u32 s42, s42, 44
    s_branch ATT_TASK
ATT_DONE:
    s_endpgm
EXIT:
    s_endpgm
TEAM:
    v_and_b32 v9, 63, v0
    v_mov_b32 v79, v0
    v_and_b32 v12, 15, v9
    v_lshrrev_b32 v13, 4, v9
    v_and_b32 v14, 7, v9
    v_bfe_u32 v15, v9, 3, 1
    v_lshrrev_b32 v16, 5, v9
    v_and_b32 v17, 1, v13
    v_and_b32 v22, 1, v9
    v_lshrrev_b32 v23, 1, v12
    s_mul_i32 s35, s32, 1792
    s_add_u32 s35, s35, 156672
    v_mov_b32 v18, 1145307136
    v_mov_b32 v19, 4008574976
    v_cmp_lt_u32 vcc, 0, v22
    s_nop 1
    v_cndmask_b32 v0, v18, v19, vcc
    s_mul_i32 s36, s32, 36864
    v_lshlrev_b32 v18, 4, v9
    v_add_u32 v1, s36, v18
    v_lshlrev_b32 v20, 8, v13
    v_lshl_add_u32 v20, v22, 7, v20
    v_lshl_add_u32 v20, v23, 4, v20
    v_add_u32 v2, 147456, v20
    v_lshlrev_b32 v20, 5, v12
    v_lshl_add_u32 v20, v13, 2, v20
    v_add_u32 v3, s35, v20
    v_bfe_u32 v20, v9, 2, 2
    v_lshl_add_u32 v20, v13, 3, v20
    v_lshlrev_b32 v20, 5, v20
    v_and_b32 v21, 3, v9
    v_lshl_add_u32 v20, v21, 3, v20
    v_add_u32 v4, s35, v20
    v_lshl_add_u32 v20, v13, 3, v14
    v_lshlrev_b32 v20, 4, v20
    v_add_u32 v21, s35, v20
    v_mov_b32 v19, 0x40000
    v_cmp_lt_u32 vcc, 0, v15
    s_nop 1
    v_cndmask_b32 v5, v19, v21, vcc
    v_mov_b32 v19, 1280
    v_mov_b32 v21, 768
    v_cndmask_b32 v19, v19, v21, vcc
    v_add3_u32 v6, v20, v19, 0
    v_add_u32 v6, 156672, v6
    v_lshl_add_u32 v20, v16, 3, v14
    v_lshlrev_b32 v20, 4, v20
    v_lshl_add_u32 v20, v17, 3, v20
    v_add_u32 v7, 156672, v20
    v_lshl_add_u32 v20, v17, 1, v22
    v_lshl_add_u32 v20, v20, 3, v23
    v_lshlrev_b32 v20, 4, v20
    v_mul_u32_u24 v21, 1792, v16
    v_add3_u32 v8, v20, v21, 0
    v_add_u32 v8, 156928, v8
    s_mul_i32 s36, s32, 18
    v_lshrrev_b32 v20, 2, v12
    v_add_u32 v20, s36, v20
    v_lshlrev_b32 v20, 12, v20
    v_bfe_u32 v21, v12, 1, 1
    v_lshl_add_u32 v20, v21, 6, v20
    v_lshl_add_u32 v20, v13, 4, v20
    v_lshl_add_u32 v10, v22, 3, v20
    v_lshlrev_b32 v20, 8, v12
    v_lshl_add_u32 v20, v13, 4, v20
    s_lshl_b32 s36, s32, 6
    v_add_u32 v11, s36, v20
    s_mov_b32 s40, 0x00f000f0
    s_mov_b32 s41, 0x00f000f0
    s_mov_b32 s50, 0x3e0293ee
    v_lshrrev_b32 v24, 4, v79
    v_and_b32 v25, 15, v79
    v_and_b32 v26, 7, v24
    v_bfe_u32 v27, v24, 3, 1
    v_lshlrev_b32 v27, 1, v27
    v_xor_b32 v26, v26, v27
    v_lshlrev_b32 v26, 1, v26
    v_xor_b32 v26, v25, v26
    v_lshlrev_b32 v26, 4, v26
    v_lshl_add_u32 v26, v24, 8, v26
    v_add_u32 v28, 147456, v26
    v_and_b32 v27, 1, v24
    v_bfe_u32 v26, v24, 2, 1
    v_lshl_add_u32 v27, v26, 1, v27
    v_lshlrev_b32 v27, 1, v27
    v_xor_b32 v26, v25, v27
    v_lshlrev_b32 v26, 4, v26
    v_lshl_add_u32 v26, v24, 8, v26
    v_add_u32 v29, 147456, v26
    v_xor_b32 v30, 128, v29
    v_and_b32 v26, 12, v25
    v_bfe_u32 v31, v25, 1, 1
    v_or_b32 v26, v26, v31
    v_xor_b32 v26, v26, v27
    v_lshlrev_b32 v26, 4, v26
    v_and_b32 v31, 1, v25
    v_lshl_add_u32 v26, v31, 3, v26
    v_lshl_add_u32 v26, v24, 8, v26
    v_add_u32 v18, 147456, v26
    v_xor_b32 v19, 32, v18
    v_xor_b32 v20, 128, v18
    v_xor_b32 v21, 160, v18
    v_lshlrev_b32 v31, 13, v24
    v_lshl_add_u32 v31, v25, 4, v31
    v_mul_u32_u24 v26, 1152, v24
    v_lshrrev_b32 v27, 2, v25
    v_mul_u32_u24 v27, 288, v27
    v_and_b32 v25, 3, v25
    v_lshl_add_u32 v27, v25, 4, v27
    v_add_u32 v79, v26, v27
    v_bfe_u32 v32, v9, 2, 2
    v_and_b32 v33, 3, v9
    v_lshrrev_b32 v34, 1, v32
    v_and_b32 v35, 1, v32
    v_lshrrev_b32 v36, 1, v13
    s_lshl_b32 s36, s32, 2
    v_lshl_add_u32 v37, v17, 2, v35
    v_add_u32 v37, 0, v37
    v_lshl_add_u32 v38, v34, 3, v37
    v_lshl_add_u32 v38, v36, 4, v38
    v_lshlrev_b32 v39, 1, v34
    v_xor_b32 v37, v37, v39
    v_lshlrev_b32 v37, 1, v37
    v_lshrrev_b32 v39, 1, v33
    v_add_u32 v39, s36, v39
    v_xor_b32 v37, v37, v39
    v_lshlrev_b32 v37, 4, v37
    v_lshl_add_u32 v37, v38, 8, v37
    v_and_b32 v39, 1, v33
    v_lshl_add_u32 v37, v39, 3, v37
    v_add_u32 v40, 147456, v37
    v_xor_b32 v41, 32, v40
    v_lshl_add_u32 v38, v17, 4, v35
    v_lshl_add_u32 v38, v36, 3, v38
    v_lshl_add_u32 v38, v34, 2, v38
    v_add_u32 v38, 0, v38
    v_lshl_add_u32 v37, v34, 1, v35
    v_lshl_add_u32 v37, v17, 2, v37
    v_lshlrev_b32 v37, 1, v37
    v_lshrrev_b32 v39, 1, v33
    v_add_u32 v39, s36, v39
    v_xor_b32 v37, v37, v39
    v_lshlrev_b32 v37, 4, v37
    v_lshl_add_u32 v37, v38, 8, v37
    v_and_b32 v39, 1, v33
    v_lshl_add_u32 v37, v39, 3, v37
    v_add_u32 v44, 147456, v37
    v_xor_b32 v45, 32, v44
    v_lshl_add_u32 v37, v17, 2, v35
    v_add_u32 v37, 2, v37
    v_lshl_add_u32 v38, v34, 3, v37
    v_lshl_add_u32 v38, v36, 4, v38
    v_lshlrev_b32 v39, 1, v34
    v_xor_b32 v37, v37, v39
    v_lshlrev_b32 v37, 1, v37
    v_lshrrev_b32 v39, 1, v33
    v_add_u32 v39, s36, v39
    v_xor_b32 v37, v37, v39
    v_lshlrev_b32 v37, 4, v37
    v_lshl_add_u32 v37, v38, 8, v37
    v_and_b32 v39, 1, v33
    v_lshl_add_u32 v37, v39, 3, v37
    v_add_u32 v42, 147456, v37
    v_xor_b32 v43, 32, v42
    v_lshl_add_u32 v38, v17, 4, v35
    v_lshl_add_u32 v38, v36, 3, v38
    v_lshl_add_u32 v38, v34, 2, v38
    v_add_u32 v38, 2, v38
    v_lshl_add_u32 v37, v34, 1, v35
    v_lshl_add_u32 v37, v17, 2, v37
    v_lshlrev_b32 v37, 1, v37
    v_lshrrev_b32 v39, 1, v33
    v_add_u32 v39, s36, v39
    v_xor_b32 v37, v37, v39
    v_lshlrev_b32 v37, 4, v37
    v_lshl_add_u32 v37, v38, 8, v37
    v_and_b32 v39, 1, v33
    v_lshl_add_u32 v37, v39, 3, v37
    v_add_u32 v46, 147456, v37
    v_xor_b32 v47, 32, v46
    v_mov_b32 v39, v79
    v_mov_b32 v32, v18
    v_mov_b32 v33, v19
    v_mov_b32 v34, v20
    v_mov_b32 v35, v21
    s_mov_b32 s37, 0x05040100
    s_mov_b32 s38, 0x07060302
    s_lshl_b32 s35, s33, 8
    s_add_u32 s36, s35, 0
    buffer_load_dwordx4 v[112:115], v31, s[12:15], s36 offen
    s_add_u32 s36, s35, 131072
    buffer_load_dwordx4 v[116:119], v31, s[12:15], s36 offen
    s_add_u32 s36, s35, 262144
    buffer_load_dwordx4 v[120:123], v31, s[12:15], s36 offen
    s_add_u32 s36, s35, 393216
    buffer_load_dwordx4 v[124:127], v31, s[12:15], s36 offen
    s_lshl_b32 s35, s33, 8
    s_add_u32 s36, s35, 524288
    buffer_load_dwordx4 v[128:131], v31, s[12:15], s36 offen
    s_add_u32 s36, s35, 655360
    buffer_load_dwordx4 v[132:135], v31, s[12:15], s36 offen
    s_add_u32 s36, s35, 1179648
    buffer_load_dwordx4 v[136:139], v31, s[12:15], s36 offen
    s_add_u32 s36, s35, 1310720
    buffer_load_dwordx4 v[140:143], v31, s[12:15], s36 offen
    s_waitcnt vmcnt(4)
    ds_write_b128 v28, v[112:115] offset:0
    ds_write_b128 v28, v[116:119] offset:4096
    ds_write_b128 v28, v[120:123] offset:8192
    ds_write_b128 v28, v[124:127] offset:12288
    s_waitcnt lgkmcnt(0)
    s_barrier
    s_lshl_b32 s35, s33, 8
    s_add_u32 s36, s35, 1441792
    buffer_load_dwordx4 v[112:115], v31, s[12:15], s36 offen
    s_add_u32 s36, s35, 1572864
    buffer_load_dwordx4 v[116:119], v31, s[12:15], s36 offen
    s_add_u32 s36, s35, 1703936
    buffer_load_dwordx4 v[120:123], v31, s[12:15], s36 offen
    s_add_u32 s36, s35, 1835008
    buffer_load_dwordx4 v[124:127], v31, s[12:15], s36 offen
    ds_read_b64_tr_b16 a[0:1], v40 offset:0
    ds_read_b64_tr_b16 a[2:3], v42 offset:0
    ds_read_b64_tr_b16 a[4:5], v40 offset:8192
    ds_read_b64_tr_b16 a[6:7], v42 offset:8192
    ds_read_b64_tr_b16 a[8:9], v41 offset:0
    ds_read_b64_tr_b16 a[10:11], v43 offset:0
    ds_read_b64_tr_b16 a[12:13], v41 offset:8192
    ds_read_b64_tr_b16 a[14:15], v43 offset:8192
    s_waitcnt lgkmcnt(0)
    s_barrier
    s_waitcnt vmcnt(4)
    ds_write_b128 v28, v[128:131] offset:0
    ds_write_b128 v28, v[132:135] offset:4096
    ds_write_b128 v28, v[136:139] offset:8192
    ds_write_b128 v28, v[140:143] offset:12288
    s_waitcnt lgkmcnt(0)
    s_barrier
    s_lshl_b32 s35, s33, 8
    s_add_u32 s36, s35, 2359296
    buffer_load_dwordx4 v[128:131], v31, s[12:15], s36 offen
    s_add_u32 s36, s35, 2490368
    buffer_load_dwordx4 v[132:135], v31, s[12:15], s36 offen
    s_add_u32 s36, s35, 2621440
    buffer_load_dwordx4 v[136:139], v31, s[12:15], s36 offen
    s_add_u32 s36, s35, 2752512
    buffer_load_dwordx4 v[140:143], v31, s[12:15], s36 offen
    ds_read_b64_tr_b16 a[32:33], v40 offset:0
    ds_read_b64_tr_b16 a[34:35], v42 offset:0
    ds_read_b64_tr_b16 a[36:37], v40 offset:8192
    ds_read_b64_tr_b16 a[38:39], v42 offset:8192
    ds_read_b64_tr_b16 a[40:41], v41 offset:0
    ds_read_b64_tr_b16 a[42:43], v43 offset:0
    ds_read_b64_tr_b16 a[44:45], v41 offset:8192
    ds_read_b64_tr_b16 a[46:47], v43 offset:8192
    s_waitcnt lgkmcnt(0)
    s_barrier
    s_waitcnt vmcnt(4)
    ds_write_b128 v28, v[112:115] offset:0
    ds_write_b128 v28, v[116:119] offset:4096
    ds_write_b128 v28, v[120:123] offset:8192
    ds_write_b128 v28, v[124:127] offset:12288
    s_waitcnt lgkmcnt(0)
    s_barrier
    s_lshl_b32 s35, s33, 8
    s_add_u32 s36, s35, 2883584
    buffer_load_dwordx4 v[112:115], v31, s[12:15], s36 offen
    s_add_u32 s36, s35, 3014656
    buffer_load_dwordx4 v[116:119], v31, s[12:15], s36 offen
    s_add_u32 s36, s35, 3538944
    buffer_load_dwordx4 v[120:123], v31, s[12:15], s36 offen
    s_add_u32 s36, s35, 3670016
    buffer_load_dwordx4 v[124:127], v31, s[12:15], s36 offen
    ds_read_b64_tr_b16 a[64:65], v40 offset:0
    ds_read_b64_tr_b16 a[66:67], v42 offset:0
    ds_read_b64_tr_b16 a[68:69], v40 offset:8192
    ds_read_b64_tr_b16 a[70:71], v42 offset:8192
    ds_read_b64_tr_b16 a[72:73], v41 offset:0
    ds_read_b64_tr_b16 a[74:75], v43 offset:0
    ds_read_b64_tr_b16 a[76:77], v41 offset:8192
    ds_read_b64_tr_b16 a[78:79], v43 offset:8192
    s_waitcnt lgkmcnt(0)
    s_barrier
    s_waitcnt vmcnt(4)
    ds_write_b128 v28, v[128:131] offset:0
    ds_write_b128 v28, v[132:135] offset:4096
    ds_write_b128 v28, v[136:139] offset:8192
    ds_write_b128 v28, v[140:143] offset:12288
    s_waitcnt lgkmcnt(0)
    s_barrier
    s_lshl_b32 s35, s33, 8
    s_add_u32 s36, s35, 3801088
    buffer_load_dwordx4 v[128:131], v31, s[12:15], s36 offen
    s_add_u32 s36, s35, 3932160
    buffer_load_dwordx4 v[132:135], v31, s[12:15], s36 offen
    s_add_u32 s36, s35, 4063232
    buffer_load_dwordx4 v[136:139], v31, s[12:15], s36 offen
    s_add_u32 s36, s35, 4194304
    buffer_load_dwordx4 v[140:143], v31, s[12:15], s36 offen
    ds_read_b64_tr_b16 a[96:97], v40 offset:0
    ds_read_b64_tr_b16 a[98:99], v42 offset:0
    ds_read_b64_tr_b16 a[100:101], v40 offset:8192
    ds_read_b64_tr_b16 a[102:103], v42 offset:8192
    ds_read_b64_tr_b16 a[104:105], v41 offset:0
    ds_read_b64_tr_b16 a[106:107], v43 offset:0
    ds_read_b64_tr_b16 a[108:109], v41 offset:8192
    ds_read_b64_tr_b16 a[110:111], v43 offset:8192
    s_waitcnt lgkmcnt(0)
    s_barrier
    s_waitcnt vmcnt(4)
    ds_write_b128 v28, v[112:115] offset:0
    ds_write_b128 v28, v[116:119] offset:4096
    ds_write_b128 v28, v[120:123] offset:8192
    ds_write_b128 v28, v[124:127] offset:12288
    s_waitcnt lgkmcnt(0)
    s_barrier
    s_lshl_b32 s35, s33, 8
    s_add_u32 s36, s35, 786432
    buffer_load_dwordx4 v[112:115], v31, s[12:15], s36 offen
    s_add_u32 s36, s35, 917504
    buffer_load_dwordx4 v[116:119], v31, s[12:15], s36 offen
    s_add_u32 s36, s35, 1048576
    buffer_load_dwordx4 v[120:123], v31, s[12:15], s36 offen
    s_add_u32 s36, s35, 1966080
    buffer_load_dwordx4 v[124:127], v31, s[12:15], s36 offen
    ds_read_b64_tr_b16 a[128:129], v40 offset:0
    ds_read_b64_tr_b16 a[130:131], v42 offset:0
    ds_read_b64_tr_b16 a[132:133], v40 offset:8192
    ds_read_b64_tr_b16 a[134:135], v42 offset:8192
    ds_read_b64_tr_b16 a[136:137], v41 offset:0
    ds_read_b64_tr_b16 a[138:139], v43 offset:0
    ds_read_b64_tr_b16 a[140:141], v41 offset:8192
    ds_read_b64_tr_b16 a[142:143], v43 offset:8192
    s_waitcnt lgkmcnt(0)
    s_barrier
    s_waitcnt vmcnt(4)
    ds_write_b128 v28, v[128:131] offset:0
    ds_write_b128 v28, v[132:135] offset:4096
    ds_write_b128 v28, v[136:139] offset:8192
    ds_write_b128 v28, v[140:143] offset:12288
    s_waitcnt lgkmcnt(0)
    s_barrier
    s_lshl_b32 s35, s33, 8
    s_add_u32 s36, s35, 2097152
    buffer_load_dwordx4 v[128:131], v31, s[12:15], s36 offen
    s_add_u32 s36, s35, 2228224
    buffer_load_dwordx4 v[132:135], v31, s[12:15], s36 offen
    s_add_u32 s36, s35, 3145728
    buffer_load_dwordx4 v[136:139], v31, s[12:15], s36 offen
    s_add_u32 s36, s35, 3276800
    buffer_load_dwordx4 v[140:143], v31, s[12:15], s36 offen
    ds_read_b64_tr_b16 a[160:161], v40 offset:0
    ds_read_b64_tr_b16 a[162:163], v42 offset:0
    ds_read_b64_tr_b16 a[164:165], v40 offset:8192
    ds_read_b64_tr_b16 a[166:167], v42 offset:8192
    ds_read_b64_tr_b16 a[168:169], v41 offset:0
    ds_read_b64_tr_b16 a[170:171], v43 offset:0
    ds_read_b64_tr_b16 a[172:173], v41 offset:8192
    ds_read_b64_tr_b16 a[174:175], v43 offset:8192
    s_waitcnt lgkmcnt(0)
    s_barrier
    s_waitcnt vmcnt(4)
    ds_write_b128 v28, v[112:115] offset:0
    ds_write_b128 v28, v[116:119] offset:4096
    ds_write_b128 v28, v[120:123] offset:8192
    ds_write_b128 v28, v[124:127] offset:12288
    s_waitcnt lgkmcnt(0)
    s_barrier
    s_lshl_b32 s35, s33, 8
    s_add_u32 s36, s35, 3407872
    buffer_load_dwordx4 v[112:115], v31, s[12:15], s36 offen
    s_add_u32 s36, s35, 4325376
    buffer_load_dwordx4 v[116:119], v31, s[12:15], s36 offen
    s_add_u32 s36, s35, 4456448
    buffer_load_dwordx4 v[120:123], v31, s[12:15], s36 offen
    s_add_u32 s36, s35, 4587520
    buffer_load_dwordx4 v[124:127], v31, s[12:15], s36 offen
    ds_read_b64_tr_b16 a[192:193], v40 offset:0
    ds_read_b64_tr_b16 a[194:195], v42 offset:0
    ds_read_b64_tr_b16 a[196:197], v40 offset:8192
    ds_read_b64_tr_b16 a[198:199], v42 offset:8192
    ds_read_b64_tr_b16 v[20:21], v41 offset:0
    ds_read_b64_tr_b16 v[22:23], v43 offset:0
    ds_read_b64_tr_b16 v[24:25], v41 offset:8192
    ds_read_b64_tr_b16 v[26:27], v43 offset:8192
    s_waitcnt lgkmcnt(0)
    ds_write_b128 v1, v[20:23] offset:24576
    ds_write_b128 v1, v[24:27] offset:25600
    s_barrier
    s_waitcnt vmcnt(4)
    ds_write_b128 v28, v[128:131] offset:0
    ds_write_b128 v28, v[132:135] offset:4096
    ds_write_b128 v28, v[136:139] offset:8192
    ds_write_b128 v28, v[140:143] offset:12288
    s_waitcnt lgkmcnt(0)
    s_barrier
    s_lshl_b32 s35, s33, 8
    s_add_u32 s36, s35, 0
    buffer_load_dwordx4 v[128:131], v31, s[16:19], s36 offen
    s_add_u32 s36, s35, 131072
    buffer_load_dwordx4 v[132:135], v31, s[16:19], s36 offen
    s_add_u32 s36, s35, 262144
    buffer_load_dwordx4 v[136:139], v31, s[16:19], s36 offen
    s_add_u32 s36, s35, 393216
    buffer_load_dwordx4 v[140:143], v31, s[16:19], s36 offen
    ds_read_b64_tr_b16 a[216:217], v40 offset:0
    ds_read_b64_tr_b16 a[218:219], v42 offset:0
    ds_read_b64_tr_b16 a[220:221], v40 offset:8192
    ds_read_b64_tr_b16 a[222:223], v42 offset:8192
    ds_read_b64_tr_b16 a[224:225], v41 offset:0
    ds_read_b64_tr_b16 a[226:227], v43 offset:0
    ds_read_b64_tr_b16 a[228:229], v41 offset:8192
    ds_read_b64_tr_b16 a[230:231], v43 offset:8192
    s_waitcnt lgkmcnt(0)
    s_barrier
    s_waitcnt vmcnt(4)
    ds_write_b128 v28, v[112:115] offset:0
    ds_write_b128 v28, v[116:119] offset:4096
    ds_write_b128 v28, v[120:123] offset:8192
    ds_write_b128 v28, v[124:127] offset:12288
    s_waitcnt lgkmcnt(0)
    s_barrier
    s_lshl_b32 s35, s33, 8
    s_add_u32 s36, s35, 524288
    buffer_load_dwordx4 v[112:115], v31, s[16:19], s36 offen
    s_add_u32 s36, s35, 655360
    buffer_load_dwordx4 v[116:119], v31, s[16:19], s36 offen
    s_add_u32 s36, s35, 1179648
    buffer_load_dwordx4 v[120:123], v31, s[16:19], s36 offen
    s_add_u32 s36, s35, 1310720
    buffer_load_dwordx4 v[124:127], v31, s[16:19], s36 offen
    ds_read_b64_tr_b16 v[12:13], v40 offset:0
    ds_read_b64_tr_b16 v[14:15], v42 offset:0
    ds_read_b64_tr_b16 v[16:17], v40 offset:8192
    ds_read_b64_tr_b16 v[18:19], v42 offset:8192
    ds_read_b64_tr_b16 a[248:249], v41 offset:0
    ds_read_b64_tr_b16 a[250:251], v43 offset:0
    ds_read_b64_tr_b16 a[252:253], v41 offset:8192
    ds_read_b64_tr_b16 a[254:255], v43 offset:8192
    s_waitcnt lgkmcnt(0)
    ds_write_b128 v1, v[12:15] offset:28672
    ds_write_b128 v1, v[16:19] offset:29696
    s_barrier
    s_waitcnt vmcnt(4)
    ds_write_b128 v28, v[128:131] offset:0
    ds_write_b128 v28, v[132:135] offset:4096
    ds_write_b128 v28, v[136:139] offset:8192
    ds_write_b128 v28, v[140:143] offset:12288
    s_waitcnt lgkmcnt(0)
    s_barrier
    s_lshl_b32 s35, s33, 8
    s_add_u32 s36, s35, 1441792
    buffer_load_dwordx4 v[128:131], v31, s[16:19], s36 offen
    s_add_u32 s36, s35, 1572864
    buffer_load_dwordx4 v[132:135], v31, s[16:19], s36 offen
    s_add_u32 s36, s35, 1703936
    buffer_load_dwordx4 v[136:139], v31, s[16:19], s36 offen
    s_add_u32 s36, s35, 1835008
    buffer_load_dwordx4 v[140:143], v31, s[16:19], s36 offen
    ds_read_b64_tr_b16 v[12:13], v40 offset:0
    ds_read_b64_tr_b16 v[14:15], v42 offset:0
    ds_read_b64_tr_b16 v[16:17], v40 offset:8192
    ds_read_b64_tr_b16 v[18:19], v42 offset:8192
    ds_read_b64_tr_b16 a[16:17], v41 offset:0
    ds_read_b64_tr_b16 a[18:19], v43 offset:0
    ds_read_b64_tr_b16 a[20:21], v41 offset:8192
    ds_read_b64_tr_b16 a[22:23], v43 offset:8192
    s_waitcnt lgkmcnt(0)
    ds_write_b128 v1, v[12:15] offset:0
    ds_write_b128 v1, v[16:19] offset:1024
    s_barrier
    s_waitcnt vmcnt(4)
    ds_write_b128 v28, v[112:115] offset:0
    ds_write_b128 v28, v[116:119] offset:4096
    ds_write_b128 v28, v[120:123] offset:8192
    ds_write_b128 v28, v[124:127] offset:12288
    s_waitcnt lgkmcnt(0)
    s_barrier
    s_lshl_b32 s35, s33, 8
    s_add_u32 s36, s35, 2359296
    buffer_load_dwordx4 v[112:115], v31, s[16:19], s36 offen
    s_add_u32 s36, s35, 2490368
    buffer_load_dwordx4 v[116:119], v31, s[16:19], s36 offen
    s_add_u32 s36, s35, 2621440
    buffer_load_dwordx4 v[120:123], v31, s[16:19], s36 offen
    s_add_u32 s36, s35, 2752512
    buffer_load_dwordx4 v[124:127], v31, s[16:19], s36 offen
    ds_read_b64_tr_b16 v[12:13], v40 offset:0
    ds_read_b64_tr_b16 v[14:15], v42 offset:0
    ds_read_b64_tr_b16 v[16:17], v40 offset:8192
    ds_read_b64_tr_b16 v[18:19], v42 offset:8192
    ds_read_b64_tr_b16 a[48:49], v41 offset:0
    ds_read_b64_tr_b16 a[50:51], v43 offset:0
    ds_read_b64_tr_b16 a[52:53], v41 offset:8192
    ds_read_b64_tr_b16 a[54:55], v43 offset:8192
    s_waitcnt lgkmcnt(0)
    ds_write_b128 v1, v[12:15] offset:4096
    ds_write_b128 v1, v[16:19] offset:5120
    s_barrier
    s_waitcnt vmcnt(4)
    ds_write_b128 v28, v[128:131] offset:0
    ds_write_b128 v28, v[132:135] offset:4096
    ds_write_b128 v28, v[136:139] offset:8192
    ds_write_b128 v28, v[140:143] offset:12288
    s_waitcnt lgkmcnt(0)
    s_barrier
    s_lshl_b32 s35, s33, 8
    s_add_u32 s36, s35, 2883584
    buffer_load_dwordx4 v[128:131], v31, s[16:19], s36 offen
    s_add_u32 s36, s35, 3014656
    buffer_load_dwordx4 v[132:135], v31, s[16:19], s36 offen
    s_add_u32 s36, s35, 3538944
    buffer_load_dwordx4 v[136:139], v31, s[16:19], s36 offen
    s_add_u32 s36, s35, 3670016
    buffer_load_dwordx4 v[140:143], v31, s[16:19], s36 offen
    ds_read_b64_tr_b16 v[12:13], v40 offset:0
    ds_read_b64_tr_b16 v[14:15], v42 offset:0
    ds_read_b64_tr_b16 v[16:17], v40 offset:8192
    ds_read_b64_tr_b16 v[18:19], v42 offset:8192
    ds_read_b64_tr_b16 a[80:81], v41 offset:0
    ds_read_b64_tr_b16 a[82:83], v43 offset:0
    ds_read_b64_tr_b16 a[84:85], v41 offset:8192
    ds_read_b64_tr_b16 a[86:87], v43 offset:8192
    s_waitcnt lgkmcnt(0)
    ds_write_b128 v1, v[12:15] offset:8192
    ds_write_b128 v1, v[16:19] offset:9216
    s_barrier
    s_waitcnt vmcnt(4)
    ds_write_b128 v28, v[112:115] offset:0
    ds_write_b128 v28, v[116:119] offset:4096
    ds_write_b128 v28, v[120:123] offset:8192
    ds_write_b128 v28, v[124:127] offset:12288
    s_waitcnt lgkmcnt(0)
    s_barrier
    s_lshl_b32 s35, s33, 8
    s_add_u32 s36, s35, 3801088
    buffer_load_dwordx4 v[112:115], v31, s[16:19], s36 offen
    s_add_u32 s36, s35, 3932160
    buffer_load_dwordx4 v[116:119], v31, s[16:19], s36 offen
    s_add_u32 s36, s35, 4063232
    buffer_load_dwordx4 v[120:123], v31, s[16:19], s36 offen
    s_add_u32 s36, s35, 4194304
    buffer_load_dwordx4 v[124:127], v31, s[16:19], s36 offen
    ds_read_b64_tr_b16 v[12:13], v40 offset:0
    ds_read_b64_tr_b16 v[14:15], v42 offset:0
    ds_read_b64_tr_b16 v[16:17], v40 offset:8192
    ds_read_b64_tr_b16 v[18:19], v42 offset:8192
    ds_read_b64_tr_b16 a[112:113], v41 offset:0
    ds_read_b64_tr_b16 a[114:115], v43 offset:0
    ds_read_b64_tr_b16 a[116:117], v41 offset:8192
    ds_read_b64_tr_b16 a[118:119], v43 offset:8192
    s_waitcnt lgkmcnt(0)
    ds_write_b128 v1, v[12:15] offset:12288
    ds_write_b128 v1, v[16:19] offset:13312
    s_barrier
    s_waitcnt vmcnt(4)
    ds_write_b128 v28, v[128:131] offset:0
    ds_write_b128 v28, v[132:135] offset:4096
    ds_write_b128 v28, v[136:139] offset:8192
    ds_write_b128 v28, v[140:143] offset:12288
    s_waitcnt lgkmcnt(0)
    s_barrier
    s_lshl_b32 s35, s33, 8
    s_add_u32 s36, s35, 786432
    buffer_load_dwordx4 v[128:131], v31, s[16:19], s36 offen
    s_add_u32 s36, s35, 917504
    buffer_load_dwordx4 v[132:135], v31, s[16:19], s36 offen
    s_add_u32 s36, s35, 1048576
    buffer_load_dwordx4 v[136:139], v31, s[16:19], s36 offen
    s_add_u32 s36, s35, 1966080
    buffer_load_dwordx4 v[140:143], v31, s[16:19], s36 offen
    ds_read_b64_tr_b16 v[12:13], v40 offset:0
    ds_read_b64_tr_b16 v[14:15], v42 offset:0
    ds_read_b64_tr_b16 v[16:17], v40 offset:8192
    ds_read_b64_tr_b16 v[18:19], v42 offset:8192
    ds_read_b64_tr_b16 a[144:145], v41 offset:0
    ds_read_b64_tr_b16 a[146:147], v43 offset:0
    ds_read_b64_tr_b16 a[148:149], v41 offset:8192
    ds_read_b64_tr_b16 a[150:151], v43 offset:8192
    s_waitcnt lgkmcnt(0)
    ds_write_b128 v1, v[12:15] offset:16384
    ds_write_b128 v1, v[16:19] offset:17408
    s_barrier
    s_waitcnt vmcnt(4)
    ds_write_b128 v28, v[112:115] offset:0
    ds_write_b128 v28, v[116:119] offset:4096
    ds_write_b128 v28, v[120:123] offset:8192
    ds_write_b128 v28, v[124:127] offset:12288
    s_waitcnt lgkmcnt(0)
    s_barrier
    s_lshl_b32 s35, s33, 8
    s_add_u32 s36, s35, 2097152
    buffer_load_dwordx4 v[112:115], v31, s[16:19], s36 offen
    s_add_u32 s36, s35, 2228224
    buffer_load_dwordx4 v[116:119], v31, s[16:19], s36 offen
    s_add_u32 s36, s35, 3145728
    buffer_load_dwordx4 v[120:123], v31, s[16:19], s36 offen
    s_add_u32 s36, s35, 3276800
    buffer_load_dwordx4 v[124:127], v31, s[16:19], s36 offen
    ds_read_b64_tr_b16 v[12:13], v40 offset:0
    ds_read_b64_tr_b16 v[14:15], v42 offset:0
    ds_read_b64_tr_b16 v[16:17], v40 offset:8192
    ds_read_b64_tr_b16 v[18:19], v42 offset:8192
    ds_read_b64_tr_b16 a[176:177], v41 offset:0
    ds_read_b64_tr_b16 a[178:179], v43 offset:0
    ds_read_b64_tr_b16 a[180:181], v41 offset:8192
    ds_read_b64_tr_b16 a[182:183], v43 offset:8192
    s_waitcnt lgkmcnt(0)
    ds_write_b128 v1, v[12:15] offset:20480
    ds_write_b128 v1, v[16:19] offset:21504
    s_barrier
    s_waitcnt vmcnt(4)
    ds_write_b128 v28, v[128:131] offset:0
    ds_write_b128 v28, v[132:135] offset:4096
    ds_write_b128 v28, v[136:139] offset:8192
    ds_write_b128 v28, v[140:143] offset:12288
    s_waitcnt lgkmcnt(0)
    s_barrier
    s_lshl_b32 s35, s33, 8
    s_add_u32 s36, s35, 3407872
    buffer_load_dwordx4 v[128:131], v31, s[16:19], s36 offen
    s_add_u32 s36, s35, 4325376
    buffer_load_dwordx4 v[132:135], v31, s[16:19], s36 offen
    s_add_u32 s36, s35, 4456448
    buffer_load_dwordx4 v[136:139], v31, s[16:19], s36 offen
    s_add_u32 s36, s35, 4587520
    buffer_load_dwordx4 v[140:143], v31, s[16:19], s36 offen
    ds_read_b64_tr_b16 a[200:201], v40 offset:0
    ds_read_b64_tr_b16 a[202:203], v42 offset:0
    ds_read_b64_tr_b16 a[204:205], v40 offset:8192
    ds_read_b64_tr_b16 a[206:207], v42 offset:8192
    ds_read_b64_tr_b16 a[208:209], v41 offset:0
    ds_read_b64_tr_b16 a[210:211], v43 offset:0
    ds_read_b64_tr_b16 a[212:213], v41 offset:8192
    ds_read_b64_tr_b16 a[214:215], v43 offset:8192
    s_waitcnt lgkmcnt(0)
    s_barrier
    s_waitcnt vmcnt(4)
    ds_write_b128 v28, v[112:115] offset:0
    ds_write_b128 v28, v[116:119] offset:4096
    ds_write_b128 v28, v[120:123] offset:8192
    ds_write_b128 v28, v[124:127] offset:12288
    s_waitcnt lgkmcnt(0)
    s_barrier
    s_lshl_b32 s35, s33, 8
    s_add_u32 s36, s35, 0
    buffer_load_dwordx4 v[112:115], v31, s[20:23], s36 offen
    s_add_u32 s36, s35, 131072
    buffer_load_dwordx4 v[116:119], v31, s[20:23], s36 offen
    s_add_u32 s36, s35, 262144
    buffer_load_dwordx4 v[120:123], v31, s[20:23], s36 offen
    s_add_u32 s36, s35, 393216
    buffer_load_dwordx4 v[124:127], v31, s[20:23], s36 offen
    ds_read_b64_tr_b16 v[12:13], v40 offset:0
    ds_read_b64_tr_b16 v[14:15], v42 offset:0
    ds_read_b64_tr_b16 v[16:17], v40 offset:8192
    ds_read_b64_tr_b16 v[18:19], v42 offset:8192
    ds_read_b64_tr_b16 a[232:233], v41 offset:0
    ds_read_b64_tr_b16 a[234:235], v43 offset:0
    ds_read_b64_tr_b16 a[236:237], v41 offset:8192
    ds_read_b64_tr_b16 a[238:239], v43 offset:8192
    s_waitcnt lgkmcnt(0)
    ds_write_b128 v1, v[12:15] offset:26624
    ds_write_b128 v1, v[16:19] offset:27648
    s_barrier
    s_waitcnt vmcnt(4)
    ds_write_b128 v28, v[128:131] offset:0
    ds_write_b128 v28, v[132:135] offset:4096
    ds_write_b128 v28, v[136:139] offset:8192
    ds_write_b128 v28, v[140:143] offset:12288
    s_waitcnt lgkmcnt(0)
    s_barrier
    s_lshl_b32 s35, s33, 8
    s_add_u32 s36, s35, 524288
    buffer_load_dwordx4 v[128:131], v31, s[20:23], s36 offen
    s_add_u32 s36, s35, 655360
    buffer_load_dwordx4 v[132:135], v31, s[20:23], s36 offen
    s_add_u32 s36, s35, 1179648
    buffer_load_dwordx4 v[136:139], v31, s[20:23], s36 offen
    s_add_u32 s36, s35, 1310720
    buffer_load_dwordx4 v[140:143], v31, s[20:23], s36 offen
    ds_read_b64_tr_b16 a[240:241], v40 offset:0
    ds_read_b64_tr_b16 a[242:243], v42 offset:0
    ds_read_b64_tr_b16 a[244:245], v40 offset:8192
    ds_read_b64_tr_b16 a[246:247], v42 offset:8192
    ds_read_b64_tr_b16 v[20:21], v41 offset:0
    ds_read_b64_tr_b16 v[22:23], v43 offset:0
    ds_read_b64_tr_b16 v[24:25], v41 offset:8192
    ds_read_b64_tr_b16 v[26:27], v43 offset:8192
    s_waitcnt lgkmcnt(0)
    ds_write_b128 v1, v[20:23] offset:30720
    ds_write_b128 v1, v[24:27] offset:31744
    s_barrier
    s_waitcnt vmcnt(4)
    ds_write_b128 v28, v[112:115] offset:0
    ds_write_b128 v28, v[116:119] offset:4096
    ds_write_b128 v28, v[120:123] offset:8192
    ds_write_b128 v28, v[124:127] offset:12288
    s_waitcnt lgkmcnt(0)
    s_barrier
    s_lshl_b32 s35, s33, 8
    s_add_u32 s36, s35, 1441792
    buffer_load_dwordx4 v[112:115], v31, s[20:23], s36 offen
    s_add_u32 s36, s35, 1572864
    buffer_load_dwordx4 v[116:119], v31, s[20:23], s36 offen
    s_add_u32 s36, s35, 1703936
    buffer_load_dwordx4 v[120:123], v31, s[20:23], s36 offen
    s_add_u32 s36, s35, 1835008
    buffer_load_dwordx4 v[124:127], v31, s[20:23], s36 offen
    ds_read_b64_tr_b16 a[24:25], v40 offset:0
    ds_read_b64_tr_b16 a[26:27], v42 offset:0
    ds_read_b64_tr_b16 a[28:29], v40 offset:8192
    ds_read_b64_tr_b16 a[30:31], v42 offset:8192
    ds_read_b64_tr_b16 v[20:21], v41 offset:0
    ds_read_b64_tr_b16 v[22:23], v43 offset:0
    ds_read_b64_tr_b16 v[24:25], v41 offset:8192
    ds_read_b64_tr_b16 v[26:27], v43 offset:8192
    s_waitcnt lgkmcnt(0)
    ds_write_b128 v1, v[20:23] offset:2048
    ds_write_b128 v1, v[24:27] offset:3072
    s_barrier
    s_waitcnt vmcnt(4)
    ds_write_b128 v28, v[128:131] offset:0
    ds_write_b128 v28, v[132:135] offset:4096
    ds_write_b128 v28, v[136:139] offset:8192
    ds_write_b128 v28, v[140:143] offset:12288
    s_waitcnt lgkmcnt(0)
    s_barrier
    s_lshl_b32 s35, s33, 8
    s_add_u32 s36, s35, 2359296
    buffer_load_dwordx4 v[128:131], v31, s[20:23], s36 offen
    s_add_u32 s36, s35, 2490368
    buffer_load_dwordx4 v[132:135], v31, s[20:23], s36 offen
    s_add_u32 s36, s35, 2621440
    buffer_load_dwordx4 v[136:139], v31, s[20:23], s36 offen
    s_add_u32 s36, s35, 2752512
    buffer_load_dwordx4 v[140:143], v31, s[20:23], s36 offen
    ds_read_b64_tr_b16 a[56:57], v40 offset:0
    ds_read_b64_tr_b16 a[58:59], v42 offset:0
    ds_read_b64_tr_b16 a[60:61], v40 offset:8192
    ds_read_b64_tr_b16 a[62:63], v42 offset:8192
    ds_read_b64_tr_b16 v[20:21], v41 offset:0
    ds_read_b64_tr_b16 v[22:23], v43 offset:0
    ds_read_b64_tr_b16 v[24:25], v41 offset:8192
    ds_read_b64_tr_b16 v[26:27], v43 offset:8192
    s_waitcnt lgkmcnt(0)
    ds_write_b128 v1, v[20:23] offset:6144
    ds_write_b128 v1, v[24:27] offset:7168
    s_barrier
    s_waitcnt vmcnt(4)
    ds_write_b128 v28, v[112:115] offset:0
    ds_write_b128 v28, v[116:119] offset:4096
    ds_write_b128 v28, v[120:123] offset:8192
    ds_write_b128 v28, v[124:127] offset:12288
    s_waitcnt lgkmcnt(0)
    s_barrier
    s_lshl_b32 s35, s33, 8
    s_add_u32 s36, s35, 2883584
    buffer_load_dwordx4 v[112:115], v31, s[20:23], s36 offen
    s_add_u32 s36, s35, 3014656
    buffer_load_dwordx4 v[116:119], v31, s[20:23], s36 offen
    s_add_u32 s36, s35, 3538944
    buffer_load_dwordx4 v[120:123], v31, s[20:23], s36 offen
    s_add_u32 s36, s35, 3670016
    buffer_load_dwordx4 v[124:127], v31, s[20:23], s36 offen
    ds_read_b64_tr_b16 a[88:89], v40 offset:0
    ds_read_b64_tr_b16 a[90:91], v42 offset:0
    ds_read_b64_tr_b16 a[92:93], v40 offset:8192
    ds_read_b64_tr_b16 a[94:95], v42 offset:8192
    ds_read_b64_tr_b16 v[20:21], v41 offset:0
    ds_read_b64_tr_b16 v[22:23], v43 offset:0
    ds_read_b64_tr_b16 v[24:25], v41 offset:8192
    ds_read_b64_tr_b16 v[26:27], v43 offset:8192
    s_waitcnt lgkmcnt(0)
    ds_write_b128 v1, v[20:23] offset:10240
    ds_write_b128 v1, v[24:27] offset:11264
    s_barrier
    s_waitcnt vmcnt(4)
    ds_write_b128 v28, v[128:131] offset:0
    ds_write_b128 v28, v[132:135] offset:4096
    ds_write_b128 v28, v[136:139] offset:8192
    ds_write_b128 v28, v[140:143] offset:12288
    s_waitcnt lgkmcnt(0)
    s_barrier
    s_lshl_b32 s35, s33, 8
    s_add_u32 s36, s35, 3801088
    buffer_load_dwordx4 v[128:131], v31, s[20:23], s36 offen
    s_add_u32 s36, s35, 3932160
    buffer_load_dwordx4 v[132:135], v31, s[20:23], s36 offen
    s_add_u32 s36, s35, 4063232
    buffer_load_dwordx4 v[136:139], v31, s[20:23], s36 offen
    s_add_u32 s36, s35, 4194304
    buffer_load_dwordx4 v[140:143], v31, s[20:23], s36 offen
    ds_read_b64_tr_b16 a[120:121], v40 offset:0
    ds_read_b64_tr_b16 a[122:123], v42 offset:0
    ds_read_b64_tr_b16 a[124:125], v40 offset:8192
    ds_read_b64_tr_b16 a[126:127], v42 offset:8192
    ds_read_b64_tr_b16 v[20:21], v41 offset:0
    ds_read_b64_tr_b16 v[22:23], v43 offset:0
    ds_read_b64_tr_b16 v[24:25], v41 offset:8192
    ds_read_b64_tr_b16 v[26:27], v43 offset:8192
    s_waitcnt lgkmcnt(0)
    ds_write_b128 v1, v[20:23] offset:14336
    ds_write_b128 v1, v[24:27] offset:15360
    s_barrier
    s_waitcnt vmcnt(4)
    ds_write_b128 v28, v[112:115] offset:0
    ds_write_b128 v28, v[116:119] offset:4096
    ds_write_b128 v28, v[120:123] offset:8192
    ds_write_b128 v28, v[124:127] offset:12288
    s_waitcnt lgkmcnt(0)
    s_barrier
    s_lshl_b32 s35, s33, 8
    s_add_u32 s36, s35, 786432
    buffer_load_dwordx4 v[112:115], v31, s[20:23], s36 offen
    s_add_u32 s36, s35, 917504
    buffer_load_dwordx4 v[116:119], v31, s[20:23], s36 offen
    s_add_u32 s36, s35, 1048576
    buffer_load_dwordx4 v[120:123], v31, s[20:23], s36 offen
    s_add_u32 s36, s35, 1966080
    buffer_load_dwordx4 v[124:127], v31, s[20:23], s36 offen
    ds_read_b64_tr_b16 a[152:153], v40 offset:0
    ds_read_b64_tr_b16 a[154:155], v42 offset:0
    ds_read_b64_tr_b16 a[156:157], v40 offset:8192
    ds_read_b64_tr_b16 a[158:159], v42 offset:8192
    ds_read_b64_tr_b16 v[20:21], v41 offset:0
    ds_read_b64_tr_b16 v[22:23], v43 offset:0
    ds_read_b64_tr_b16 v[24:25], v41 offset:8192
    ds_read_b64_tr_b16 v[26:27], v43 offset:8192
    s_waitcnt lgkmcnt(0)
    ds_write_b128 v1, v[20:23] offset:18432
    ds_write_b128 v1, v[24:27] offset:19456
    s_barrier
    s_waitcnt vmcnt(4)
    ds_write_b128 v28, v[128:131] offset:0
    ds_write_b128 v28, v[132:135] offset:4096
    ds_write_b128 v28, v[136:139] offset:8192
    ds_write_b128 v28, v[140:143] offset:12288
    s_waitcnt lgkmcnt(0)
    s_barrier
    s_lshl_b32 s35, s33, 8
    s_add_u32 s36, s35, 2097152
    buffer_load_dwordx4 v[128:131], v31, s[20:23], s36 offen
    s_add_u32 s36, s35, 2228224
    buffer_load_dwordx4 v[132:135], v31, s[20:23], s36 offen
    s_add_u32 s36, s35, 3145728
    buffer_load_dwordx4 v[136:139], v31, s[20:23], s36 offen
    s_add_u32 s36, s35, 3276800
    buffer_load_dwordx4 v[140:143], v31, s[20:23], s36 offen
    ds_read_b64_tr_b16 a[184:185], v40 offset:0
    ds_read_b64_tr_b16 a[186:187], v42 offset:0
    ds_read_b64_tr_b16 a[188:189], v40 offset:8192
    ds_read_b64_tr_b16 a[190:191], v42 offset:8192
    ds_read_b64_tr_b16 v[20:21], v41 offset:0
    ds_read_b64_tr_b16 v[22:23], v43 offset:0
    ds_read_b64_tr_b16 v[24:25], v41 offset:8192
    ds_read_b64_tr_b16 v[26:27], v43 offset:8192
    s_waitcnt lgkmcnt(0)
    ds_write_b128 v1, v[20:23] offset:22528
    ds_write_b128 v1, v[24:27] offset:23552
    s_barrier
    s_waitcnt vmcnt(4)
    ds_write_b128 v28, v[112:115] offset:0
    ds_write_b128 v28, v[116:119] offset:4096
    ds_write_b128 v28, v[120:123] offset:8192
    ds_write_b128 v28, v[124:127] offset:12288
    s_waitcnt lgkmcnt(0)
    s_barrier
    s_lshl_b32 s35, s33, 8
    s_add_u32 s36, s35, 3407872
    buffer_load_dwordx4 v[112:115], v31, s[20:23], s36 offen
    s_add_u32 s36, s35, 4325376
    buffer_load_dwordx4 v[116:119], v31, s[20:23], s36 offen
    s_add_u32 s36, s35, 4456448
    buffer_load_dwordx4 v[120:123], v31, s[20:23], s36 offen
    s_add_u32 s36, s35, 4587520
    buffer_load_dwordx4 v[124:127], v31, s[20:23], s36 offen
    ds_read_b64_tr_b16 v[80:81], v40 offset:0
    ds_read_b64_tr_b16 v[82:83], v42 offset:0
    ds_read_b64_tr_b16 v[84:85], v40 offset:8192
    ds_read_b64_tr_b16 v[86:87], v42 offset:8192
    ds_read_b64_tr_b16 v[88:89], v41 offset:0
    ds_read_b64_tr_b16 v[90:91], v43 offset:0
    ds_read_b64_tr_b16 v[92:93], v41 offset:8192
    ds_read_b64_tr_b16 v[94:95], v43 offset:8192
    s_waitcnt lgkmcnt(0)
    s_barrier
    s_waitcnt vmcnt(4)
    ds_write_b128 v28, v[128:131] offset:0
    ds_write_b128 v28, v[132:135] offset:4096
    ds_write_b128 v28, v[136:139] offset:8192
    ds_write_b128 v28, v[140:143] offset:12288
    s_waitcnt lgkmcnt(0)
    s_barrier
    s_mul_i32 s36, s33, 147456
    s_add_u32 s36, s36, 0
    buffer_load_dwordx4 v[128:131], v39, s[24:27], s36 offen
    s_add_u32 s36, s36, 18432
    buffer_load_dwordx4 v[132:135], v39, s[24:27], s36 offen
    s_add_u32 s36, s36, 18432
    buffer_load_dwordx4 v[136:139], v39, s[24:27], s36 offen
    s_add_u32 s36, s36, 18432
    buffer_load_dwordx4 v[140:143], v39, s[24:27], s36 offen
    ds_read_b64_tr_b16 v[12:13], v40 offset:0
    ds_read_b64_tr_b16 v[14:15], v42 offset:0
    ds_read_b64_tr_b16 v[16:17], v40 offset:8192
    ds_read_b64_tr_b16 v[18:19], v42 offset:8192
    ds_read_b64_tr_b16 v[96:97], v41 offset:0
    ds_read_b64_tr_b16 v[98:99], v43 offset:0
    ds_read_b64_tr_b16 v[100:101], v41 offset:8192
    ds_read_b64_tr_b16 v[102:103], v43 offset:8192
    s_waitcnt lgkmcnt(0)
    ds_write_b128 v1, v[12:15] offset:32768
    ds_write_b128 v1, v[16:19] offset:33792
    s_barrier
    s_waitcnt vmcnt(4)
    ds_write_b128 v28, v[112:115] offset:0
    ds_write_b128 v28, v[116:119] offset:4096
    ds_write_b128 v28, v[120:123] offset:8192
    ds_write_b128 v28, v[124:127] offset:12288
    s_waitcnt lgkmcnt(0)
    s_barrier
    s_mul_i32 s36, s33, 147456
    s_add_u32 s36, s36, 73728
    buffer_load_dwordx4 v[144:147], v39, s[24:27], s36 offen
    s_add_u32 s36, s36, 18432
    buffer_load_dwordx4 v[148:151], v39, s[24:27], s36 offen
    s_add_u32 s36, s36, 18432
    buffer_load_dwordx4 v[152:155], v39, s[24:27], s36 offen
    s_add_u32 s36, s36, 18432
    buffer_load_dwordx4 v[156:159], v39, s[24:27], s36 offen
    ds_read_b64_tr_b16 v[104:105], v40 offset:0
    ds_read_b64_tr_b16 v[106:107], v42 offset:0
    ds_read_b64_tr_b16 v[108:109], v40 offset:8192
    ds_read_b64_tr_b16 v[110:111], v42 offset:8192
    ds_read_b64_tr_b16 v[20:21], v41 offset:0
    ds_read_b64_tr_b16 v[22:23], v43 offset:0
    ds_read_b64_tr_b16 v[24:25], v41 offset:8192
    ds_read_b64_tr_b16 v[26:27], v43 offset:8192
    s_waitcnt lgkmcnt(0)
    ds_write_b128 v1, v[20:23] offset:34816
    ds_write_b128 v1, v[24:27] offset:35840
    s_barrier
    s_waitcnt vmcnt(4)
    v_perm_b32 v12, v129, v128, s37
    v_perm_b32 v13, v131, v130, s37
    v_perm_b32 v14, v129, v128, s38
    v_perm_b32 v15, v131, v130, s38
    ds_write_b64 v32, v[12:13] offset:0
    ds_write_b64 v33, v[14:15] offset:0
    v_perm_b32 v12, v133, v132, s37
    v_perm_b32 v13, v135, v134, s37
    v_perm_b32 v14, v133, v132, s38
    v_perm_b32 v15, v135, v134, s38
    ds_write_b64 v34, v[12:13] offset:4096
    ds_write_b64 v35, v[14:15] offset:4096
    v_perm_b32 v12, v137, v136, s37
    v_perm_b32 v13, v139, v138, s37
    v_perm_b32 v14, v137, v136, s38
    v_perm_b32 v15, v139, v138, s38
    ds_write_b64 v32, v[12:13] offset:8192
    ds_write_b64 v33, v[14:15] offset:8192
    v_perm_b32 v12, v141, v140, s37
    v_perm_b32 v13, v143, v142, s37
    v_perm_b32 v14, v141, v140, s38
    v_perm_b32 v15, v143, v142, s38
    ds_write_b64 v34, v[12:13] offset:12288
    ds_write_b64 v35, v[14:15] offset:12288
    s_waitcnt lgkmcnt(0)
    s_barrier
    s_mul_i32 s36, s33, 147456
    s_add_u32 s36, s36, 64
    buffer_load_dwordx4 v[160:163], v39, s[24:27], s36 offen
    s_add_u32 s36, s36, 18432
    buffer_load_dwordx4 v[164:167], v39, s[24:27], s36 offen
    s_add_u32 s36, s36, 18432
    buffer_load_dwordx4 v[168:171], v39, s[24:27], s36 offen
    s_add_u32 s36, s36, 18432
    buffer_load_dwordx4 v[172:175], v39, s[24:27], s36 offen
    ds_read_b64_tr_b16 v[112:113], v44 offset:0
    ds_read_b64_tr_b16 v[114:115], v46 offset:0
    ds_read_b64_tr_b16 v[116:117], v44 offset:8192
    ds_read_b64_tr_b16 v[118:119], v46 offset:8192
    ds_read_b64_tr_b16 v[128:129], v45 offset:0
    ds_read_b64_tr_b16 v[130:131], v47 offset:0
    ds_read_b64_tr_b16 v[132:133], v45 offset:8192
    ds_read_b64_tr_b16 v[134:135], v47 offset:8192
    s_waitcnt lgkmcnt(0)
    s_barrier
    s_waitcnt vmcnt(4)
    v_perm_b32 v12, v145, v144, s37
    v_perm_b32 v13, v147, v146, s37
    v_perm_b32 v14, v145, v144, s38
    v_perm_b32 v15, v147, v146, s38
    ds_write_b64 v32, v[12:13] offset:0
    ds_write_b64 v33, v[14:15] offset:0
    v_perm_b32 v12, v149, v148, s37
    v_perm_b32 v13, v151, v150, s37
    v_perm_b32 v14, v149, v148, s38
    v_perm_b32 v15, v151, v150, s38
    ds_write_b64 v34, v[12:13] offset:4096
    ds_write_b64 v35, v[14:15] offset:4096
    v_perm_b32 v12, v153, v152, s37
    v_perm_b32 v13, v155, v154, s37
    v_perm_b32 v14, v153, v152, s38
    v_perm_b32 v15, v155, v154, s38
    ds_write_b64 v32, v[12:13] offset:8192
    ds_write_b64 v33, v[14:15] offset:8192
    v_perm_b32 v12, v157, v156, s37
    v_perm_b32 v13, v159, v158, s37
    v_perm_b32 v14, v157, v156, s38
    v_perm_b32 v15, v159, v158, s38
    ds_write_b64 v34, v[12:13] offset:12288
    ds_write_b64 v35, v[14:15] offset:12288
    s_waitcnt lgkmcnt(0)
    s_barrier
    s_mul_i32 s36, s33, 147456
    s_add_u32 s36, s36, 73792
    buffer_load_dwordx4 v[176:179], v39, s[24:27], s36 offen
    s_add_u32 s36, s36, 18432
    buffer_load_dwordx4 v[180:183], v39, s[24:27], s36 offen
    s_add_u32 s36, s36, 18432
    buffer_load_dwordx4 v[184:187], v39, s[24:27], s36 offen
    s_add_u32 s36, s36, 18432
    buffer_load_dwordx4 v[188:191], v39, s[24:27], s36 offen
    ds_read_b64_tr_b16 v[120:121], v44 offset:0
    ds_read_b64_tr_b16 v[122:123], v46 offset:0
    ds_read_b64_tr_b16 v[124:125], v44 offset:8192
    ds_read_b64_tr_b16 v[126:127], v46 offset:8192
    ds_read_b64_tr_b16 v[136:137], v45 offset:0
    ds_read_b64_tr_b16 v[138:139], v47 offset:0
    ds_read_b64_tr_b16 v[140:141], v45 offset:8192
    ds_read_b64_tr_b16 v[142:143], v47 offset:8192
    s_waitcnt lgkmcnt(0)
    s_barrier
    s_waitcnt vmcnt(4)
    v_perm_b32 v12, v161, v160, s37
    v_perm_b32 v13, v163, v162, s37
    v_perm_b32 v14, v161, v160, s38
    v_perm_b32 v15, v163, v162, s38
    ds_write_b64 v32, v[12:13] offset:0
    ds_write_b64 v33, v[14:15] offset:0
    v_perm_b32 v12, v165, v164, s37
    v_perm_b32 v13, v167, v166, s37
    v_perm_b32 v14, v165, v164, s38
    v_perm_b32 v15, v167, v166, s38
    ds_write_b64 v34, v[12:13] offset:4096
    ds_write_b64 v35, v[14:15] offset:4096
    v_perm_b32 v12, v169, v168, s37
    v_perm_b32 v13, v171, v170, s37
    v_perm_b32 v14, v169, v168, s38
    v_perm_b32 v15, v171, v170, s38
    ds_write_b64 v32, v[12:13] offset:8192
    ds_write_b64 v33, v[14:15] offset:8192
    v_perm_b32 v12, v173, v172, s37
    v_perm_b32 v13, v175, v174, s37
    v_perm_b32 v14, v173, v172, s38
    v_perm_b32 v15, v175, v174, s38
    ds_write_b64 v34, v[12:13] offset:12288
    ds_write_b64 v35, v[14:15] offset:12288
    s_waitcnt lgkmcnt(0)
    s_barrier
    s_mul_i32 s36, s33, 147456
    s_add_u32 s36, s36, 128
    buffer_load_dwordx4 v[192:195], v39, s[24:27], s36 offen
    s_add_u32 s36, s36, 18432
    buffer_load_dwordx4 v[196:199], v39, s[24:27], s36 offen
    s_add_u32 s36, s36, 18432
    buffer_load_dwordx4 v[200:203], v39, s[24:27], s36 offen
    s_add_u32 s36, s36, 18432
    buffer_load_dwordx4 v[204:207], v39, s[24:27], s36 offen
    ds_read_b64_tr_b16 v[144:145], v44 offset:0
    ds_read_b64_tr_b16 v[146:147], v46 offset:0
    ds_read_b64_tr_b16 v[148:149], v44 offset:8192
    ds_read_b64_tr_b16 v[150:151], v46 offset:8192
    ds_read_b64_tr_b16 v[160:161], v45 offset:0
    ds_read_b64_tr_b16 v[162:163], v47 offset:0
    ds_read_b64_tr_b16 v[164:165], v45 offset:8192
    ds_read_b64_tr_b16 v[166:167], v47 offset:8192
    s_waitcnt lgkmcnt(0)
    s_barrier
    s_waitcnt vmcnt(4)
    v_perm_b32 v12, v177, v176, s37
    v_perm_b32 v13, v179, v178, s37
    v_perm_b32 v14, v177, v176, s38
    v_perm_b32 v15, v179, v178, s38
    ds_write_b64 v32, v[12:13] offset:0
    ds_write_b64 v33, v[14:15] offset:0
    v_perm_b32 v12, v181, v180, s37
    v_perm_b32 v13, v183, v182, s37
    v_perm_b32 v14, v181, v180, s38
    v_perm_b32 v15, v183, v182, s38
    ds_write_b64 v34, v[12:13] offset:4096
    ds_write_b64 v35, v[14:15] offset:4096
    v_perm_b32 v12, v185, v184, s37
    v_perm_b32 v13, v187, v186, s37
    v_perm_b32 v14, v185, v184, s38
    v_perm_b32 v15, v187, v186, s38
    ds_write_b64 v32, v[12:13] offset:8192
    ds_write_b64 v33, v[14:15] offset:8192
    v_perm_b32 v12, v189, v188, s37
    v_perm_b32 v13, v191, v190, s37
    v_perm_b32 v14, v189, v188, s38
    v_perm_b32 v15, v191, v190, s38
    ds_write_b64 v34, v[12:13] offset:12288
    ds_write_b64 v35, v[14:15] offset:12288
    s_waitcnt lgkmcnt(0)
    s_barrier
    s_mul_i32 s36, s33, 147456
    s_add_u32 s36, s36, 73856
    buffer_load_dwordx4 v[208:211], v39, s[24:27], s36 offen
    s_add_u32 s36, s36, 18432
    buffer_load_dwordx4 v[212:215], v39, s[24:27], s36 offen
    s_add_u32 s36, s36, 18432
    buffer_load_dwordx4 v[216:219], v39, s[24:27], s36 offen
    s_add_u32 s36, s36, 18432
    buffer_load_dwordx4 v[220:223], v39, s[24:27], s36 offen
    ds_read_b64_tr_b16 v[152:153], v44 offset:0
    ds_read_b64_tr_b16 v[154:155], v46 offset:0
    ds_read_b64_tr_b16 v[156:157], v44 offset:8192
    ds_read_b64_tr_b16 v[158:159], v46 offset:8192
    ds_read_b64_tr_b16 v[168:169], v45 offset:0
    ds_read_b64_tr_b16 v[170:171], v47 offset:0
    ds_read_b64_tr_b16 v[172:173], v45 offset:8192
    ds_read_b64_tr_b16 v[174:175], v47 offset:8192
    s_waitcnt lgkmcnt(0)
    s_barrier
    s_waitcnt vmcnt(4)
    v_perm_b32 v12, v193, v192, s37
    v_perm_b32 v13, v195, v194, s37
    v_perm_b32 v14, v193, v192, s38
    v_perm_b32 v15, v195, v194, s38
    ds_write_b64 v32, v[12:13] offset:0
    ds_write_b64 v33, v[14:15] offset:0
    v_perm_b32 v12, v197, v196, s37
    v_perm_b32 v13, v199, v198, s37
    v_perm_b32 v14, v197, v196, s38
    v_perm_b32 v15, v199, v198, s38
    ds_write_b64 v34, v[12:13] offset:4096
    ds_write_b64 v35, v[14:15] offset:4096
    v_perm_b32 v12, v201, v200, s37
    v_perm_b32 v13, v203, v202, s37
    v_perm_b32 v14, v201, v200, s38
    v_perm_b32 v15, v203, v202, s38
    ds_write_b64 v32, v[12:13] offset:8192
    ds_write_b64 v33, v[14:15] offset:8192
    v_perm_b32 v12, v205, v204, s37
    v_perm_b32 v13, v207, v206, s37
    v_perm_b32 v14, v205, v204, s38
    v_perm_b32 v15, v207, v206, s38
    ds_write_b64 v34, v[12:13] offset:12288
    ds_write_b64 v35, v[14:15] offset:12288
    s_waitcnt lgkmcnt(0)
    s_barrier
    s_mul_i32 s36, s33, 147456
    s_add_u32 s36, s36, 192
    buffer_load_dwordx4 v[224:227], v39, s[24:27], s36 offen
    s_add_u32 s36, s36, 18432
    buffer_load_dwordx4 v[228:231], v39, s[24:27], s36 offen
    s_add_u32 s36, s36, 18432
    buffer_load_dwordx4 v[232:235], v39, s[24:27], s36 offen
    s_add_u32 s36, s36, 18432
    buffer_load_dwordx4 v[236:239], v39, s[24:27], s36 offen
    ds_read_b64_tr_b16 v[176:177], v44 offset:0
    ds_read_b64_tr_b16 v[178:179], v46 offset:0
    ds_read_b64_tr_b16 v[180:181], v44 offset:8192
    ds_read_b64_tr_b16 v[182:183], v46 offset:8192
    ds_read_b64_tr_b16 v[192:193], v45 offset:0
    ds_read_b64_tr_b16 v[194:195], v47 offset:0
    ds_read_b64_tr_b16 v[196:197], v45 offset:8192
    ds_read_b64_tr_b16 v[198:199], v47 offset:8192
    s_waitcnt lgkmcnt(0)
    s_barrier
    s_waitcnt vmcnt(4)
    v_perm_b32 v12, v209, v208, s37
    v_perm_b32 v13, v211, v210, s37
    v_perm_b32 v14, v209, v208, s38
    v_perm_b32 v15, v211, v210, s38
    ds_write_b64 v32, v[12:13] offset:0
    ds_write_b64 v33, v[14:15] offset:0
    v_perm_b32 v12, v213, v212, s37
    v_perm_b32 v13, v215, v214, s37
    v_perm_b32 v14, v213, v212, s38
    v_perm_b32 v15, v215, v214, s38
    ds_write_b64 v34, v[12:13] offset:4096
    ds_write_b64 v35, v[14:15] offset:4096
    v_perm_b32 v12, v217, v216, s37
    v_perm_b32 v13, v219, v218, s37
    v_perm_b32 v14, v217, v216, s38
    v_perm_b32 v15, v219, v218, s38
    ds_write_b64 v32, v[12:13] offset:8192
    ds_write_b64 v33, v[14:15] offset:8192
    v_perm_b32 v12, v221, v220, s37
    v_perm_b32 v13, v223, v222, s37
    v_perm_b32 v14, v221, v220, s38
    v_perm_b32 v15, v223, v222, s38
    ds_write_b64 v34, v[12:13] offset:12288
    ds_write_b64 v35, v[14:15] offset:12288
    s_waitcnt lgkmcnt(0)
    s_barrier
    v_mov_b32 v16, -1
    v_mov_b32 v17, -1
    v_mov_b32 v18, -1
    v_mov_b32 v19, -1
    v_lshl_add_u32 v21, s32, 6, v9
    v_lshlrev_b32 v20, 4, v21
    s_mul_i32 s36, s33, 18432
    s_add_u32 s36, s36, 2097152
    buffer_store_dwordx4 v[16:19], v20, s[4:7], s36 offen
    s_add_u32 s36, s36, 4096
    buffer_store_dwordx4 v[16:19], v20, s[4:7], s36 offen
    s_add_u32 s36, s36, 4096
    buffer_store_dwordx4 v[16:19], v20, s[4:7], s36 offen
    s_add_u32 s36, s36, 4096
    buffer_store_dwordx4 v[16:19], v20, s[4:7], s36 offen
    s_add_u32 s36, s36, 4096
    v_cmp_gt_u32 vcc, 128, v21
    v_mov_b32 v22, 0x7ff00000
    s_nop 0
    v_cndmask_b32 v22, v22, v20, vcc
    buffer_store_dwordx4 v[16:19], v22, s[4:7], s36 offen
    v_cmp_gt_u32 vcc, 72, v21
    v_mov_b32 v22, 0x7ff00000
    s_nop 0
    v_cndmask_b32 v22, v22, v20, vcc
    s_mul_i32 s36, s33, 1152
    s_add_u32 s36, s36, 1048576
    buffer_store_dwordx4 v[16:19], v22, s[4:7], s36 offen
    s_mul_i32 s36, s33, 147456
    s_add_u32 s36, s36, 73920
    buffer_load_dwordx4 v[240:243], v39, s[24:27], s36 offen
    s_add_u32 s36, s36, 18432
    buffer_load_dwordx4 v[244:247], v39, s[24:27], s36 offen
    s_add_u32 s36, s36, 18432
    buffer_load_dwordx4 v[248:251], v39, s[24:27], s36 offen
    s_add_u32 s36, s36, 18432
    buffer_load_dwordx4 v[252:255], v39, s[24:27], s36 offen
    ds_read_b64_tr_b16 v[184:185], v44 offset:0
    ds_read_b64_tr_b16 v[186:187], v46 offset:0
    ds_read_b64_tr_b16 v[188:189], v44 offset:8192
    ds_read_b64_tr_b16 v[190:191], v46 offset:8192
    ds_read_b64_tr_b16 v[200:201], v45 offset:0
    ds_read_b64_tr_b16 v[202:203], v47 offset:0
    ds_read_b64_tr_b16 v[204:205], v45 offset:8192
    ds_read_b64_tr_b16 v[206:207], v47 offset:8192
    s_waitcnt lgkmcnt(0)
    s_barrier
    s_waitcnt vmcnt(10)
    v_perm_b32 v12, v225, v224, s37
    v_perm_b32 v13, v227, v226, s37
    v_perm_b32 v14, v225, v224, s38
    v_perm_b32 v15, v227, v226, s38
    ds_write_b64 v32, v[12:13] offset:0
    ds_write_b64 v33, v[14:15] offset:0
    v_perm_b32 v12, v229, v228, s37
    v_perm_b32 v13, v231, v230, s37
    v_perm_b32 v14, v229, v228, s38
    v_perm_b32 v15, v231, v230, s38
    ds_write_b64 v34, v[12:13] offset:4096
    ds_write_b64 v35, v[14:15] offset:4096
    v_perm_b32 v12, v233, v232, s37
    v_perm_b32 v13, v235, v234, s37
    v_perm_b32 v14, v233, v232, s38
    v_perm_b32 v15, v235, v234, s38
    ds_write_b64 v32, v[12:13] offset:8192
    ds_write_b64 v33, v[14:15] offset:8192
    v_perm_b32 v12, v237, v236, s37
    v_perm_b32 v13, v239, v238, s37
    v_perm_b32 v14, v237, v236, s38
    v_perm_b32 v15, v239, v238, s38
    ds_write_b64 v34, v[12:13] offset:12288
    ds_write_b64 v35, v[14:15] offset:12288
    s_waitcnt lgkmcnt(0)
    s_barrier
    s_mul_i32 s36, s33, 147456
    s_add_u32 s36, s36, 256
    buffer_load_dwordx4 v[48:51], v39, s[24:27], s36 offen
    s_add_u32 s36, s36, 18432
    buffer_load_dwordx4 v[52:55], v39, s[24:27], s36 offen
    s_add_u32 s36, s36, 18432
    buffer_load_dwordx4 v[56:59], v39, s[24:27], s36 offen
    s_add_u32 s36, s36, 18432
    buffer_load_dwordx4 v[60:63], v39, s[24:27], s36 offen
    ds_read_b64_tr_b16 v[208:209], v44 offset:0
    ds_read_b64_tr_b16 v[210:211], v46 offset:0
    ds_read_b64_tr_b16 v[212:213], v44 offset:8192
    ds_read_b64_tr_b16 v[214:215], v46 offset:8192
    ds_read_b64_tr_b16 v[224:225], v45 offset:0
    ds_read_b64_tr_b16 v[226:227], v47 offset:0
    ds_read_b64_tr_b16 v[228:229], v45 offset:8192
    ds_read_b64_tr_b16 v[230:231], v47 offset:8192
    s_waitcnt lgkmcnt(0)
    s_barrier
    s_waitcnt vmcnt(4)
    v_perm_b32 v12, v241, v240, s37
    v_perm_b32 v13, v243, v242, s37
    v_perm_b32 v14, v241, v240, s38
    v_perm_b32 v15, v243, v242, s38
    ds_write_b64 v32, v[12:13] offset:0
    ds_write_b64 v33, v[14:15] offset:0
    v_perm_b32 v12, v245, v244, s37
    v_perm_b32 v13, v247, v246, s37
    v_perm_b32 v14, v245, v244, s38
    v_perm_b32 v15, v247, v246, s38
    ds_write_b64 v34, v[12:13] offset:4096
    ds_write_b64 v35, v[14:15] offset:4096
    v_perm_b32 v12, v249, v248, s37
    v_perm_b32 v13, v251, v250, s37
    v_perm_b32 v14, v249, v248, s38
    v_perm_b32 v15, v251, v250, s38
    ds_write_b64 v32, v[12:13] offset:8192
    ds_write_b64 v33, v[14:15] offset:8192
    v_perm_b32 v12, v253, v252, s37
    v_perm_b32 v13, v255, v254, s37
    v_perm_b32 v14, v253, v252, s38
    v_perm_b32 v15, v255, v254, s38
    ds_write_b64 v34, v[12:13] offset:12288
    ds_write_b64 v35, v[14:15] offset:12288
    s_waitcnt lgkmcnt(0)
    s_barrier
    s_mul_i32 s36, s33, 147456
    s_add_u32 s36, s36, 73984
    buffer_load_dwordx4 v[64:67], v39, s[24:27], s36 offen
    s_add_u32 s36, s36, 18432
    buffer_load_dwordx4 v[68:71], v39, s[24:27], s36 offen
    s_add_u32 s36, s36, 18432
    buffer_load_dwordx4 v[72:75], v39, s[24:27], s36 offen
    s_add_u32 s36, s36, 18432
    buffer_load_dwordx4 v[76:79], v39, s[24:27], s36 offen
    ds_read_b64_tr_b16 v[216:217], v44 offset:0
    ds_read_b64_tr_b16 v[218:219], v46 offset:0
    ds_read_b64_tr_b16 v[220:221], v44 offset:8192
    ds_read_b64_tr_b16 v[222:223], v46 offset:8192
    ds_read_b64_tr_b16 v[232:233], v45 offset:0
    ds_read_b64_tr_b16 v[234:235], v47 offset:0
    ds_read_b64_tr_b16 v[236:237], v45 offset:8192
    ds_read_b64_tr_b16 v[238:239], v47 offset:8192
    s_waitcnt lgkmcnt(0)
    s_barrier
    s_waitcnt vmcnt(4)
    ds_write_b128 v29, v[48:51] offset:0
    ds_write_b128 v30, v[52:55] offset:4096
    ds_write_b128 v29, v[56:59] offset:8192
    ds_write_b128 v30, v[60:63] offset:12288
    s_waitcnt lgkmcnt(0)
    s_barrier
    ds_read_b64_tr_b16 v[240:241], v44 offset:0
    ds_read_b64_tr_b16 v[242:243], v46 offset:0
    ds_read_b64_tr_b16 v[244:245], v44 offset:8192
    ds_read_b64_tr_b16 v[246:247], v46 offset:8192
    s_waitcnt lgkmcnt(0)
    s_barrier
    s_waitcnt vmcnt(0)
    ds_write_b128 v29, v[64:67] offset:0
    ds_write_b128 v30, v[68:71] offset:4096
    ds_write_b128 v29, v[72:75] offset:8192
    ds_write_b128 v30, v[76:79] offset:12288
    s_waitcnt lgkmcnt(0)
    s_barrier
    s_cmp_lg_u32 s32, 0
    s_cbranch_scc1 TEAM_NOARR
    v_mov_b32 v16, 1
    v_mov_b32 v17, 68
    s_mov_b64 exec, 1
    buffer_atomic_add v16, v17, s[8:11], 0 offen
    s_mov_b64 exec, -1
TEAM_NOARR:
    ds_read_b64_tr_b16 v[248:249], v44 offset:0
    ds_read_b64_tr_b16 v[250:251], v46 offset:0
    ds_read_b64_tr_b16 v[252:253], v44 offset:8192
    ds_read_b64_tr_b16 v[254:255], v46 offset:8192
    s_waitcnt lgkmcnt(0)
    s_barrier
    v_and_b32 v12, 7, v9
    v_mul_u32_u24 v12, 1152, v12
    v_lshrrev_b32 v13, 3, v9
    s_lshl_b32 s36, s32, 4
    v_add_u32 v15, s36, v13
    v_add_u32 v16, 8, v15
    v_add_u32 v17, 64, v13
    s_lshl_b32 s37, s32, 11
    v_lshlrev_b32 v14, 4, v9
    v_add_u32 v14, 147456, v14
    v_add_u32 v13, s37, v14
    s_load_dwordx2 s[12:13], s[0:1], 80
    v_mul_u32_u24 v18, 43, v15
    v_lshrrev_b32 v18, 9, v18
    v_mul_u32_u24 v18, 6, v18
    v_add_u32 v18, v18, v15
    v_subrev_u32 v19, 48, v15
    v_mul_u32_u24 v20, 43, v19
    v_lshrrev_b32 v20, 8, v20
    v_mul_u32_u24 v20, 12, v20
    v_add3_u32 v19, v19, v20, 12
    v_cmp_gt_u32 vcc, 48, v15
    s_nop 1
    v_cndmask_b32 v18, v19, v18, vcc
    v_lshl_add_u32 v15, v18, 4, v12
    v_mul_u32_u24 v18, 43, v16
    v_lshrrev_b32 v18, 9, v18
    v_mul_u32_u24 v18, 6, v18
    v_add_u32 v18, v18, v16
    v_subrev_u32 v19, 48, v16
    v_mul_u32_u24 v20, 43, v19
    v_lshrrev_b32 v20, 8, v20
    v_mul_u32_u24 v20, 12, v20
    v_add3_u32 v19, v19, v20, 12
    v_cmp_gt_u32 vcc, 48, v16
    s_nop 1
    v_cndmask_b32 v18, v19, v18, vcc
    v_lshl_add_u32 v16, v18, 4, v12
    v_mul_u32_u24 v18, 43, v17
    v_lshrrev_b32 v18, 9, v18
    v_mul_u32_u24 v18, 6, v18
    v_add_u32 v18, v18, v17
    v_subrev_u32 v19, 48, v17
    v_mul_u32_u24 v20, 43, v19
    v_lshrrev_b32 v20, 8, v20
    v_mul_u32_u24 v20, 12, v20
    v_add3_u32 v19, v19, v20, 12
    v_cmp_gt_u32 vcc, 48, v17
    s_nop 1
    v_cndmask_b32 v18, v19, v18, vcc
    v_lshl_add_u32 v17, v18, 4, v12
    s_waitcnt lgkmcnt(0)
    s_and_b32 s13, s13, 0xffff
    s_mov_b32 s14, 9216
    s_mov_b32 s15, 0x00020000
    buffer_load_dwordx4 v[28:31], v15, s[12:15], 0 offen
    buffer_load_dwordx4 v[20:23], v16, s[12:15], 0 offen
    buffer_load_dwordx4 v[24:27], v17, s[12:15], 0 offen
    s_waitcnt vmcnt(0)
    ds_write_b128 v13, v[28:31]
    ds_write_b128 v13, v[20:23] offset:1024
    ds_write_b128 v14, v[24:27] offset:8192
    s_waitcnt lgkmcnt(0)
    s_barrier
    s_cmp_lg_u32 s32, 0
    s_cbranch_scc1 TEAM_BAR_DONE
    v_mov_b32 v13, 64
    v_mov_b32 v12, 1024
TEAM_BAR_POLL:
    buffer_load_dwordx4 v[16:19], v13, s[8:11], 0 offen sc1
    s_waitcnt vmcnt(0)
    buffer_load_dword v14, v12, s[4:7], 0 offen sc1
    v_readfirstlane_b32 s36, v17
    v_readfirstlane_b32 s37, v18
    s_waitcnt vmcnt(0)
    s_cmp_lt_u32 s36, 32
    s_cbranch_scc1 TEAM_BAR_POLL
    s_cmp_eq_u32 s37, 0
    s_cbranch_scc1 TEAM_BAR_POLL
    v_readfirstlane_b32 s36, v14
    s_nop 0
    s_lshr_b32 s36, s36, s33
    s_bitcmp1_b32 s36, 0
    s_cbranch_scc0 TEAM_BAR_POLL
TEAM_BAR_DONE:
    s_barrier
    s_mov_b32 s34, 0
    s_lshl_b32 s36, s33, 19
    s_add_u32 s52, s36, 33554432
    s_add_u32 s62, s52, 4096
    s_add_u32 s53, s36, 50331648
    s_lshl_b32 s36, s33, 18
    s_add_u32 s54, s36, 100663296
    s_lshl_b32 s36, s33, 17
    s_add_u32 s55, s36, 8388608
    s_lshl_b32 s36, s33, 7
    s_add_u32 s56, s36, 2097152
    s_add_u32 s42, s56, 16384
    s_add_u32 s43, s56, 32768
    s_add_u32 s44, s56, 49152
    s_mul_i32 s36, s32, 73728
    s_add_u32 s45, s56, 65536
    s_add_u32 s45, s45, s36
    s_mov_b32 s96, 0
    s_mov_b32 s97, 0
    s_lshl_b32 s60, s32, 5
    s_add_u32 s60, s60, s33
    s_mul_i32 s36, s60, 43
    s_lshr_b32 s36, s36, 9
    s_mul_i32 s36, s36, 6
    s_add_u32 s36, s36, s60
    s_sub_u32 s37, s60, 48
    s_mul_i32 s38, s37, 43
    s_lshr_b32 s38, s38, 8
    s_mul_i32 s38, s38, 12
    s_add_u32 s37, s37, s38
    s_add_u32 s37, s37, 12
    s_cmp_lt_u32 s60, 48
    s_cselect_b32 s36, s36, s37
    s_and_b32 s36, s36, 127
    s_lshl_b32 s36, s36, 12
    s_add_u32 s57, s36, 2097152
    s_lshl_b32 s36, s60, 7
    s_add_u32 s51, s36, 1048576
    s_lshl_b32 s46, s32, 11
    s_lshl_b32 s36, s33, 4
    s_lshl_b32 s37, s32, 2
    s_add_u32 s61, s36, s37
    s_add_u32 s61, s61, 0
    buffer_load_dwordx4 v[64:67], v11, s[4:7], s52 offen
    buffer_load_dwordx4 v[68:71], v11, s[4:7], s62 offen
    v_bfe_u32 v12, v1, 4, 4
    v_lshl_add_u32 v12, s32, 5, v12
    v_lshlrev_b32 v12, 6, v12
    v_bfe_u32 v13, v1, 8, 2
    v_lshl_add_u32 v12, v13, 4, v12
    buffer_load_dwordx4 v[72:75], v12, s[4:7], s53 offen
    buffer_load_dwordx4 v[76:79], v12, s[4:7], s53 offen offset:1024
    v_mov_b32 v24, 0
    v_mov_b32 v25, 0
    v_mov_b32 v26, 0
    v_mov_b32 v27, 0
    v_mov_b32 v28, 0
    v_mov_b32 v29, 0
    v_mov_b32 v30, 0
    v_mov_b32 v31, 0
    v_mov_b32 v32, 0
    v_mov_b32 v33, 0
    v_mov_b32 v34, 0
    v_mov_b32 v35, 0
    v_mov_b32 v36, 0
    v_mov_b32 v37, 0
    v_mov_b32 v38, 0
    v_mov_b32 v39, 0
    v_mov_b32 v40, 0
    v_mov_b32 v41, 0
    v_mov_b32 v42, 0
    v_mov_b32 v43, 0
    v_mov_b32 v44, 0
    v_mov_b32 v45, 0
    v_mov_b32 v46, 0
    v_mov_b32 v47, 0
    s_waitcnt vmcnt(0)
    ds_read_b128 v[48:51], v1 offset:0
    ds_read_b128 v[52:55], v1 offset:1024
    ds_read_b128 v[56:59], v1 offset:2048
    ds_read_b128 v[60:63], v1 offset:3072
    s_waitcnt lgkmcnt(0)
    s_mov_b32 s48, 0x7ff00000
    s_mov_b32 s49, 0x7ff00000
    s_cmp_lt_u32 s32, 2
    s_cselect_b32 s47, s52, s53
    s_and_b32 s37, s32, 1
    s_lshl_b32 s37, s37, 12
    s_add_u32 s47, s47, s37
    s_add_u32 s47, s47, 8192
TEAM_STEP:
    ds_read_b128 v[12:15], v2 offset:0
    ds_read_b128 v[16:19], v2 offset:1024
    ds_read_b128 v[20:23], v2 offset:2048
    s_waitcnt lgkmcnt(2)
    v_smfmac_f32_16x16x64_bf16 v[24:27], v[12:15], a[0:7], v0 abid:1
    v_smfmac_f32_16x16x64_bf16 v[28:31], v[12:15], a[8:15], v0 abid:1
    v_smfmac_f32_16x16x64_bf16 v[32:35], v[12:15], v[48:55], v0 abid:1
    ds_read_b128 v[48:51], v1 offset:4096
    ds_read_b128 v[52:55], v1 offset:5120
    v_smfmac_f32_16x16x64_bf16 v[36:39], v[12:15], a[16:23], v0 abid:1
    v_smfmac_f32_16x16x64_bf16 v[40:43], v[12:15], a[24:31], v0 abid:1
    v_smfmac_f32_16x16x64_bf16 v[44:47], v[12:15], v[56:63], v0 abid:1
    ds_read_b128 v[56:59], v1 offset:6144
    ds_read_b128 v[60:63], v1 offset:7168
    ds_read_b128 v[12:15], v2 offset:3072
    s_waitcnt lgkmcnt(6)
    v_smfmac_f32_16x16x64_bf16 v[24:27], v[16:19], a[32:39], v0 abid:1
    v_smfmac_f32_16x16x64_bf16 v[28:31], v[16:19], a[40:47], v0 abid:1
    s_waitcnt lgkmcnt(3)
    v_smfmac_f32_16x16x64_bf16 v[32:35], v[16:19], v[48:55], v0 abid:1
    ds_read_b128 v[48:51], v1 offset:8192
    ds_read_b128 v[52:55], v1 offset:9216
    v_smfmac_f32_16x16x64_bf16 v[36:39], v[16:19], a[48:55], v0 abid:1
    v_smfmac_f32_16x16x64_bf16 v[40:43], v[16:19], a[56:63], v0 abid:1
    s_waitcnt lgkmcnt(3)
    v_smfmac_f32_16x16x64_bf16 v[44:47], v[16:19], v[56:63], v0 abid:1
    ds_read_b128 v[56:59], v1 offset:10240
    ds_read_b128 v[60:63], v1 offset:11264
    ds_read_b128 v[16:19], v2 offset:4096
    v_smfmac_f32_16x16x64_bf16 v[24:27], v[20:23], a[64:71], v0 abid:1
    v_smfmac_f32_16x16x64_bf16 v[28:31], v[20:23], a[72:79], v0 abid:1
    s_waitcnt lgkmcnt(3)
    v_smfmac_f32_16x16x64_bf16 v[32:35], v[20:23], v[48:55], v0 abid:1
    ds_read_b128 v[48:51], v1 offset:12288
    ds_read_b128 v[52:55], v1 offset:13312
    v_smfmac_f32_16x16x64_bf16 v[36:39], v[20:23], a[80:87], v0 abid:1
    v_smfmac_f32_16x16x64_bf16 v[40:43], v[20:23], a[88:95], v0 abid:1
    s_waitcnt lgkmcnt(3)
    v_smfmac_f32_16x16x64_bf16 v[44:47], v[20:23], v[56:63], v0 abid:1
    ds_read_b128 v[56:59], v1 offset:14336
    ds_read_b128 v[60:63], v1 offset:15360
    ds_read_b128 v[20:23], v2 offset:5120
    v_smfmac_f32_16x16x64_bf16 v[24:27], v[12:15], a[96:103], v0 abid:1
    v_smfmac_f32_16x16x64_bf16 v[28:31], v[12:15], a[104:111], v0 abid:1
    s_waitcnt lgkmcnt(3)
    v_smfmac_f32_16x16x64_bf16 v[32:35], v[12:15], v[48:55], v0 abid:1
    ds_read_b128 v[48:51], v1 offset:16384
    ds_read_b128 v[52:55], v1 offset:17408
    v_smfmac_f32_16x16x64_bf16 v[36:39], v[12:15], a[112:119], v0 abid:1
    v_smfmac_f32_16x16x64_bf16 v[40:43], v[12:15], a[120:127], v0 abid:1
    s_waitcnt lgkmcnt(3)
    v_smfmac_f32_16x16x64_bf16 v[44:47], v[12:15], v[56:63], v0 abid:1
    ds_read_b128 v[56:59], v1 offset:18432
    ds_read_b128 v[60:63], v1 offset:19456
    ds_read_b128 v[12:15], v2 offset:6144
    v_smfmac_f32_16x16x64_bf16 v[24:27], v[16:19], a[128:135], v0 abid:1
    v_smfmac_f32_16x16x64_bf16 v[28:31], v[16:19], a[136:143], v0 abid:1
    s_waitcnt lgkmcnt(3)
    v_smfmac_f32_16x16x64_bf16 v[32:35], v[16:19], v[48:55], v0 abid:1
    ds_read_b128 v[48:51], v1 offset:20480
    ds_read_b128 v[52:55], v1 offset:21504
    v_smfmac_f32_16x16x64_bf16 v[36:39], v[16:19], a[144:151], v0 abid:1
    v_smfmac_f32_16x16x64_bf16 v[40:43], v[16:19], a[152:159], v0 abid:1
    s_waitcnt lgkmcnt(3)
    v_smfmac_f32_16x16x64_bf16 v[44:47], v[16:19], v[56:63], v0 abid:1
    ds_read_b128 v[56:59], v1 offset:22528
    ds_read_b128 v[60:63], v1 offset:23552
    ds_read_b128 v[16:19], v2 offset:7168
    v_smfmac_f32_16x16x64_bf16 v[24:27], v[20:23], a[160:167], v0 abid:1
    v_smfmac_f32_16x16x64_bf16 v[28:31], v[20:23], a[168:175], v0 abid:1
    s_waitcnt lgkmcnt(3)
    v_smfmac_f32_16x16x64_bf16 v[32:35], v[20:23], v[48:55], v0 abid:1
    ds_read_b128 v[48:51], v1 offset:24576
    ds_read_b128 v[52:55], v1 offset:25600
    v_smfmac_f32_16x16x64_bf16 v[36:39], v[20:23], a[176:183], v0 abid:1
    v_smfmac_f32_16x16x64_bf16 v[40:43], v[20:23], a[184:191], v0 abid:1
    s_waitcnt lgkmcnt(3)
    v_smfmac_f32_16x16x64_bf16 v[44:47], v[20:23], v[56:63], v0 abid:1
    ds_read_b128 v[56:59], v1 offset:26624
    ds_read_b128 v[60:63], v1 offset:27648
    ds_read_b128 v[20:23], v2 offset:8192
    v_smfmac_f32_16x16x64_bf16 v[24:27], v[12:15], a[192:199], v0 abid:1
    v_smfmac_f32_16x16x64_bf16 v[32:35], v[12:15], a[200:207], v0 abid:1
    s_waitcnt lgkmcnt(3)
    v_smfmac_f32_16x16x64_bf16 v[28:31], v[12:15], v[48:55], v0 abid:1
    ds_read_b128 v[48:51], v1 offset:28672
    ds_read_b128 v[52:55], v1 offset:29696
    v_smfmac_f32_16x16x64_bf16 v[36:39], v[12:15], a[208:215], v0 abid:1
    v_smfmac_f32_16x16x64_bf16 v[24:27], v[16:19], a[216:223], v0 abid:1
    s_waitcnt lgkmcnt(3)
    v_smfmac_f32_16x16x64_bf16 v[32:35], v[16:19], v[56:63], v0 abid:1
    ds_read_b128 v[56:59], v1 offset:30720
    ds_read_b128 v[60:63], v1 offset:31744
    v_smfmac_f32_16x16x64_bf16 v[28:31], v[16:19], a[224:231], v0 abid:1
    v_smfmac_f32_16x16x64_bf16 v[36:39], v[16:19], a[232:239], v0 abid:1
    s_waitcnt lgkmcnt(2)
    v_smfmac_f32_16x16x64_bf16 v[24:27], v[20:23], v[48:55], v0 abid:1
    ds_read_b128 v[48:51], v1 offset:32768
    ds_read_b128 v[52:55], v1 offset:33792
    v_smfmac_f32_16x16x64_bf16 v[32:35], v[20:23], a[240:247], v0 abid:1
    v_smfmac_f32_16x16x64_bf16 v[28:31], v[20:23], a[248:255], v0 abid:1
    s_waitcnt lgkmcnt(2)
    v_smfmac_f32_16x16x64_bf16 v[36:39], v[20:23], v[56:63], v0 abid:1
    ds_read_b128 v[56:59], v1 offset:34816
    ds_read_b128 v[60:63], v1 offset:35840
    v_smfmac_f32_16x16x64_bf16 v[40:43], v[12:15], v[80:87], v0 abid:1
    v_smfmac_f32_16x16x64_bf16 v[44:47], v[12:15], v[88:95], v0 abid:1
    v_add_f32 v24, v24, v25
    v_add_f32 v26, v26, v27
    v_add_f32 v32, v32, v33
    v_add_f32 v34, v34, v35
    v_cvt_pk_bf16_f32 v24, v24, v26
    v_cvt_pk_bf16_f32 v32, v32, v34
    ds_write2_b32 v3, v32, v24 offset0:0 offset1:4
    v_add_f32 v28, v28, v29
    v_add_f32 v30, v30, v31
    v_add_f32 v36, v36, v37
    v_add_f32 v38, v38, v39
    v_cvt_pk_bf16_f32 v28, v28, v30
    v_cvt_pk_bf16_f32 v36, v36, v38
    ds_write2_b32 v3, v36, v28 offset0:128 offset1:132
    ds_read_b64_tr_b16 v[28:29], v4
    ds_read_b64_tr_b16 v[30:31], v4 offset:128
    s_waitcnt lgkmcnt(6)
    v_smfmac_f32_16x16x64_bf16 v[40:43], v[16:19], v[48:55], v0 abid:1
    v_smfmac_f32_16x16x64_bf16 v[44:47], v[16:19], v[96:103], v0 abid:1
    v_smfmac_f32_16x16x64_bf16 v[40:43], v[20:23], v[104:111], v0 abid:1
    s_waitcnt lgkmcnt(4)
    v_smfmac_f32_16x16x64_bf16 v[44:47], v[20:23], v[56:63], v0 abid:1
    v_bfe_u32 v61, v1, 4, 4
    v_lshl_add_u32 v61, s32, 5, v61
    v_bfe_u32 v60, v1, 8, 2
    v_lshlrev_b32 v61, 4, v61
    v_lshl_add_u32 v61, v60, 2, v61
    v_mov_b32 v49, 0
    v_mov_b32 v51, 0
    s_waitcnt lgkmcnt(0)
    v_mfma_f32_16x16x32_bf16 v[32:35], v[64:67], v[28:31], 0
    v_mfma_f32_16x16x32_bf16 v[36:39], v[68:71], v[28:31], 0
    v_mfma_f32_16x16x32_bf16 v[24:27], v[28:31], v[28:31], 0
    v_add_f32 v40, v40, v41
    v_add_f32 v42, v42, v43
    v_add_f32 v44, v44, v45
    v_add_f32 v46, v46, v47
    v_cvt_pk_bf16_f32 v48, v40, v42
    v_cvt_pk_bf16_f32 v50, v44, v46
    ds_write_b128 v5, v[32:35] offset:768
    ds_write_b128 v5, v[36:39] offset:1280
    ds_write_b128 v5, v[24:27]
    buffer_store_dwordx4 v[28:31], v11, s[4:7], s54 offen sc1
    buffer_store_dword v48, v61, s[4:7], s55 offen sc1
    buffer_store_dword v50, v61, s[4:7], s55 offen offset:256 sc1
    s_cmp_eq_u32 s34, 63
    s_cbranch_scc1 TEAM_LAST
    s_waitcnt lgkmcnt(0)
    s_barrier
    ds_read_b128 v[12:15], v6 offset:0
    ds_read_b64 v[28:29], v7 offset:0
    ds_read_b128 v[16:19], v6 offset:1792
    ds_read_b64 v[30:31], v7 offset:1792
    ds_read_b128 v[20:23], v6 offset:3584
    ds_read_b64 v[32:33], v7 offset:3584
    ds_read_b128 v[24:27], v6 offset:5376
    ds_read_b64 v[34:35], v7 offset:5376
    ds_read_b128 v[36:39], v0
    ds_read_b128 v[40:43], v0
    ds_read_b128 v[44:47], v0
    s_add_u32 s36, s52, 8192
    s_add_u32 s37, s62, 8192
    s_add_u32 s38, s53, 8192
    buffer_load_dwordx4 v[64:67], v11, s[4:7], s36 offen
    buffer_load_dwordx4 v[68:71], v11, s[4:7], s37 offen
    v_lshlrev_b32 v60, 2, v61
    s_waitcnt lgkmcnt(7)
    v_pk_add_f32 v[12:13], v[12:13], v[16:17]
    v_pk_add_f32 v[14:15], v[14:15], v[18:19]
    v_pk_add_f32 v[28:29], v[28:29], v[30:31]
    s_waitcnt lgkmcnt(3)
    v_pk_add_f32 v[20:21], v[20:21], v[24:25]
    v_pk_add_f32 v[22:23], v[22:23], v[26:27]
    v_pk_add_f32 v[32:33], v[32:33], v[34:35]
    v_pk_add_f32 v[12:13], v[12:13], v[20:21]
    v_pk_add_f32 v[14:15], v[14:15], v[22:23]
    v_pk_add_f32 v[16:17], v[28:29], v[32:33]
    v_max3_f32 v18, v12, v13, v14
    v_max3_f32 v19, v15, v16, v17
    v_max_f32 v18, v18, v19
    ds_read_b128 v[20:23], v0
    ds_read_b128 v[24:27], v0
    v_max_f32_dpp v18, v18, v18 row_ror:8 row_mask:0xf bank_mask:0xf
    v_mov_b32 v19, v18
    v_mov_b32 v33, 0
    s_nop 0
    v_permlane16_swap_b32 v19, v18
    v_max_f32 v18, v18, v19
    v_mov_b32 v19, v18
    s_nop 1
    v_permlane32_swap_b32 v19, v18
    v_max_f32 v18, v18, v19
    v_mul_f32 v18, s50, v18
    v_fma_f32 v16, v16, s50, -v18
    v_fma_f32 v17, v17, s50, -v18
    v_fma_f32 v12, v12, s50, -v18
    v_fma_f32 v13, v13, s50, -v18
    v_fma_f32 v14, v14, s50, -v18
    v_fma_f32 v15, v15, s50, -v18
    v_exp_f32 v16, v16
    v_exp_f32 v17, v17
    v_exp_f32 v12, v12
    v_exp_f32 v13, v13
    v_exp_f32 v14, v14
    v_exp_f32 v15, v15
    v_cvt_pk_bf16_f32 v32, v16, v17
    v_cvt_pk_bf16_f32 v28, v12, v13
    v_cvt_pk_bf16_f32 v29, v14, v15
    v_add_f32 v18, v16, v17
    v_mfma_f32_16x16x16_bf16 v[52:55], v[48:49], v[32:33], 0
    v_mov_b32_dpp v30, v28 row_ror:8 row_mask:0xf bank_mask:0xf
    v_mov_b32_dpp v31, v29 row_ror:8 row_mask:0xf bank_mask:0xf
    v_mfma_f32_16x16x16_bf16 v[56:59], v[50:51], v[32:33], 0
    v_add_f32 v19, v12, v13
    v_fma_f32 v18, v18, 0.5, v19
    v_add_f32 v19, v14, v15
    v_add_f32 v18, v18, v19
    v_mfma_f32_16x16x32_bf16 v[52:55], v[72:75], v[28:31], v[52:55]
    v_mfma_f32_16x16x32_bf16 v[56:59], v[76:79], v[28:31], v[56:59]
    v_add_f32_dpp v18, v18, v18 row_ror:8 row_mask:0xf bank_mask:0xf
    v_mov_b32 v19, v18
    ds_read_b128 v[12:15], v0
    ds_read_b128 v[48:51], v0
    v_permlane16_swap_b32 v19, v18
    v_add_f32 v18, v18, v19
    v_mov_b32 v19, v18
    buffer_load_dwordx4 v[72:75], v60, s[4:7], s38 offen
    buffer_load_dwordx4 v[76:79], v60, s[4:7], s38 offen offset:1024
    v_permlane32_swap_b32 v19, v18
    v_add_f32 v18, v18, v19
    v_rcp_f32 v18, v18
    s_nop 0
    v_mov_b32 v19, v18
    v_pk_mul_f32 v[52:53], v[52:53], v[18:19]
    v_pk_mul_f32 v[54:55], v[54:55], v[18:19]
    v_pk_mul_f32 v[56:57], v[56:57], v[18:19]
    v_pk_mul_f32 v[58:59], v[58:59], v[18:19]
    v_cvt_pk_bf16_f32 v60, v52, v53
    v_cvt_pk_bf16_f32 v61, v54, v55
    v_cvt_pk_bf16_f32 v62, v56, v57
    v_cvt_pk_bf16_f32 v63, v58, v59
    ds_write_b128 v5, v[60:63] offset:256
    ds_read_b128 v[16:19], v0
    ds_read_b128 v[52:55], v0
    s_waitcnt lgkmcnt(0)
    s_barrier
    ds_read_b128 v[56:59], v8
    ds_read_b128 v[60:63], v8 offset:3584
    v_bfe_u32 v28, v1, 7, 1
    v_lshlrev_b32 v28, 12, v28
    v_bfe_u32 v29, v1, 6, 1
    v_lshl_add_u32 v28, v29, 6, v28
    v_bfe_u32 v29, v1, 8, 2
    v_lshl_add_u32 v28, v29, 4, v28
    v_bfe_u32 v29, v1, 5, 1
    v_lshl_add_u32 v28, v29, 3, v28
    v_bfe_u32 v29, v1, 4, 1
    v_lshl_add_u32 v28, v29, 30, v28
    v_and_b32 v35, 0x70, v1
    v_bfe_u32 v29, v1, 7, 3
    v_lshl_add_u32 v35, v29, 9, v35
    s_waitcnt lgkmcnt(1)
    v_smfmac_f32_16x16x64_bf16 v[36:39], v[56:59], v[112:119], v0 abid:1
    s_waitcnt lgkmcnt(0)
    v_smfmac_f32_16x16x64_bf16 v[36:39], v[60:63], v[120:127], v0 abid:1
    v_smfmac_f32_16x16x64_bf16 v[40:43], v[56:59], v[128:135], v0 abid:1
    v_smfmac_f32_16x16x64_bf16 v[40:43], v[60:63], v[136:143], v0 abid:1
    v_smfmac_f32_16x16x64_bf16 v[44:47], v[56:59], v[144:151], v0 abid:1
    v_smfmac_f32_16x16x64_bf16 v[44:47], v[60:63], v[152:159], v0 abid:1
    v_smfmac_f32_16x16x64_bf16 v[12:15], v[56:59], v[160:167], v0 abid:1
    s_nop 2
    v_add_f32 v36, v36, v37
    v_add_f32 v38, v38, v39
    v_smfmac_f32_16x16x64_bf16 v[12:15], v[60:63], v[168:175], v0 abid:1
    v_add_f32 v40, v40, v41
    v_add_f32 v42, v42, v43
    v_smfmac_f32_16x16x64_bf16 v[16:19], v[56:59], v[176:183], v0 abid:1
    v_cvt_pk_bf16_f32 v36, v36, v40
    v_cvt_pk_bf16_f32 v37, v38, v42
    v_smfmac_f32_16x16x64_bf16 v[16:19], v[60:63], v[184:191], v0 abid:1
    buffer_store_dwordx2 v[36:37], v10, s[4:7], s56 offen
    v_smfmac_f32_16x16x64_bf16 v[20:23], v[56:59], v[192:199], v0 abid:1
    v_add_f32 v44, v44, v45
    v_add_f32 v46, v46, v47
    v_smfmac_f32_16x16x64_bf16 v[20:23], v[60:63], v[200:207], v0 abid:1
    v_add_f32 v12, v12, v13
    v_add_f32 v14, v14, v15
    v_smfmac_f32_16x16x64_bf16 v[52:55], v[56:59], v[240:247], v0 abid:1
    v_cvt_pk_bf16_f32 v44, v44, v12
    v_cvt_pk_bf16_f32 v45, v46, v14
    v_smfmac_f32_16x16x64_bf16 v[52:55], v[60:63], v[248:255], v0 abid:1
    buffer_store_dwordx2 v[44:45], v10, s[4:7], s42 offen
    v_smfmac_f32_16x16x64_bf16 v[24:27], v[56:59], v[208:215], v0 abid:1
    v_add_f32 v16, v16, v17
    v_add_f32 v18, v18, v19
    v_smfmac_f32_16x16x64_bf16 v[24:27], v[60:63], v[216:223], v0 abid:1
    v_add_f32 v20, v20, v21
    v_add_f32 v22, v22, v23
    v_smfmac_f32_16x16x64_bf16 v[48:51], v[56:59], v[224:231], v0 abid:1
    v_cvt_pk_bf16_f32 v16, v16, v20
    v_cvt_pk_bf16_f32 v17, v18, v22
    v_smfmac_f32_16x16x64_bf16 v[48:51], v[60:63], v[232:239], v0 abid:1
    buffer_store_dwordx2 v[16:17], v10, s[4:7], s43 offen
    v_add_f32 v52, v52, v53
    v_add_f32 v53, v54, v55
    s_add_u32 s34, s34, 1
    v_mov_b32_dpp v54, v52 quad_perm:[1,0,3,2] row_mask:0xf bank_mask:0xf
    v_mov_b32_dpp v55, v53 quad_perm:[1,0,3,2] row_mask:0xf bank_mask:0xf
    v_cvt_pk_bf16_f32 v52, v52, v54
    v_cvt_pk_bf16_f32 v53, v53, v55
    buffer_store_dwordx2 v[52:53], v28, s[4:7], s45 offen
    v_add_f32 v24, v24, v25
    v_add_f32 v26, v26, v27
    v_add_f32 v48, v48, v49
    v_add_f32 v50, v50, v51
    v_cvt_pk_bf16_f32 v24, v24, v48
    v_cvt_pk_bf16_f32 v25, v26, v50
    buffer_store_dwordx2 v[24:25], v10, s[4:7], s44 offen
    s_add_u32 s54, s54, 4096
    s_add_u32 s55, s55, 2048
    s_add_u32 s52, s52, 8192
    s_add_u32 s62, s62, 8192
    s_add_u32 s53, s53, 8192
    s_mov_b32 s37, 294912
    s_sub_u32 s38, 0, s37
    s_bitcmp1_b32 s34, 0
    s_cselect_b32 s35, s37, s38
    s_add_u32 s56, s56, s35
    s_add_u32 s42, s42, s35
    s_add_u32 s43, s43, s35
    s_add_u32 s44, s44, s35
    s_add_u32 s45, s45, s35
    v_and_b32 v38, 0x3f0, v1
    s_add_u32 s38, s46, 147456
    v_add_u32 v39, s38, v38
    s_add_u32 s47, s47, 8192
    s_cmp_ge_u32 s34, 63
    s_cselect_b32 s47, 0x7ff00000, s47
    s_and_b32 s37, s34, 3
    s_mul_i32 s37, s37, 9216
    s_add_u32 s58, s51, s37
    s_add_u32 s63, s37, 1056768
    s_add_u32 s59, s37, s46
    s_add_u32 s59, s59, 1048576
    s_add_u32 s37, s34, 3
    s_and_b32 s37, s37, 3
    s_mul_i32 s37, s37, 9216
    s_add_u32 s48, s51, s37
    v_and_b32 v33, 240, v38
    s_lshl_b32 s38, s32, 8
    s_add_u32 s63, s63, s38
    s_add_u32 s38, s38, 155648
    v_add_u32 v34, s38, v33
    s_cmp_ge_u32 s60, 72
    s_cbranch_scc1 TEAM_NOJOB
    v_and_b32 v46, 16, v1
    v_mov_b32 v36, 0x3f80
    v_lshlrev_b32 v46, v46, v36
    v_bfe_u32 v36, v1, 5, 3
    v_cmp_eq_u32 vcc, 0, v36
    v_cmp_eq_u32 s[98:99], 1, v36
    v_cmp_eq_u32 s[100:101], 2, v36
    v_cndmask_b32 v28, 0, v46, vcc
    v_cmp_eq_u32 vcc, 3, v36
    v_cndmask_b32 v29, 0, v46, s[98:99]
    v_cndmask_b32 v30, 0, v46, s[100:101]
    v_cndmask_b32 v31, 0, v46, vcc
    v_bfe_u32 v46, v1, 6, 1
    v_lshlrev_b32 v46, 3, v46
    v_bfe_u32 v36, v1, 8, 1
    v_lshl_add_u32 v46, v36, 2, v46
    v_bfe_u32 v36, v1, 4, 2
    v_lshl_add_u32 v46, v36, 5, v46
    v_and_b32 v36, 0x280, v1
    v_lshl_add_u32 v46, v36, 21, v46
    buffer_load_dwordx4 v[12:15], v35, s[4:7], s57 offen offset:0 sc1
    buffer_load_dwordx4 v[16:19], v35, s[4:7], s57 offen offset:128 sc1
    buffer_load_dwordx4 v[20:23], v35, s[4:7], s57 offen offset:256 sc1
    buffer_load_dwordx4 v[24:27], v35, s[4:7], s57 offen offset:384 sc1
TEAM_W1:
    s_waitcnt vmcnt(3)
    v_mfma_f32_16x16x32_bf16 v[40:43], v[28:31], v[12:15], 0
    s_waitcnt vmcnt(2)
    v_mfma_f32_16x16x32_bf16 v[40:43], v[28:31], v[16:19], v[40:43]
    s_waitcnt vmcnt(1)
    v_mfma_f32_16x16x32_bf16 v[40:43], v[28:31], v[20:23], v[40:43]
    s_waitcnt vmcnt(0)
    v_mfma_f32_16x16x32_bf16 v[40:43], v[28:31], v[24:27], v[40:43]
    v_max3_u32 v48, v12, v13, v14
    v_max_u32 v48, v48, v15
    v_max3_u32 v49, v16, v17, v18
    v_max_u32 v49, v49, v19
    v_max3_u32 v50, v20, v21, v22
    v_max_u32 v50, v50, v23
    v_max3_u32 v51, v24, v25, v26
    v_max_u32 v51, v51, v27
    v_cmp_eq_u32 s[84:85], -1, v48
    v_cmp_eq_u32 s[86:87], -1, v49
    v_cmp_eq_u32 s[88:89], -1, v50
    v_cmp_eq_u32 s[90:91], -1, v51
    v_add_f32_dpp v40, v40, v40 row_ror:8 row_mask:0xf bank_mask:0xf
    v_add_f32_dpp v41, v41, v41 row_ror:8 row_mask:0xf bank_mask:0xf
    v_add_f32_dpp v42, v42, v42 row_ror:8 row_mask:0xf bank_mask:0xf
    v_add_f32_dpp v43, v43, v43 row_ror:8 row_mask:0xf bank_mask:0xf
    v_cvt_pk_bf16_f32 v44, v40, v41
    v_cvt_pk_bf16_f32 v45, v42, v43
    s_or_b64 s[92:93], s[84:85], s[86:87]
    s_or_b64 s[94:95], s[88:89], s[90:91]
    s_or_b64 s[92:93], s[92:93], s[94:95]
    s_cbranch_scc0 TEAM_W1_OK
    s_mov_b64 exec, s[84:85]
    buffer_load_dwordx4 v[12:15], v35, s[4:7], s57 offen offset:0 sc1
    s_mov_b64 exec, s[86:87]
    buffer_load_dwordx4 v[16:19], v35, s[4:7], s57 offen offset:128 sc1
    s_mov_b64 exec, s[88:89]
    buffer_load_dwordx4 v[20:23], v35, s[4:7], s57 offen offset:256 sc1
    s_mov_b64 exec, s[90:91]
    buffer_load_dwordx4 v[24:27], v35, s[4:7], s57 offen offset:384 sc1
    s_mov_b64 exec, -1
    s_waitcnt vmcnt(0)
    s_branch TEAM_W1
TEAM_W1_OK:
    buffer_store_dword v44, v46, s[4:7], s58 offen
    buffer_store_dword v45, v46, s[4:7], s58 offen offset:16
    s_mov_b32 s49, s57
    s_branch TEAM_W2PRE
TEAM_NOJOB:
    s_mov_b32 s48, 0x7ff00000
    s_cmp_lg_u32 s32, 3
    s_cbranch_scc1 TEAM_W2PRE
    s_add_u32 s36, s34, 2
    s_and_b32 s37, s36, 3
    s_cmp_lg_u32 s37, 0
    s_cbranch_scc1 TEAM_W2PRE
    s_cmp_ge_u32 s36, 64
    s_cbranch_scc1 TEAM_W2PRE
    s_lshl_b32 s36, s36, 4
    v_mov_b32 v12, 1024
TEAM_KVP:
    buffer_load_dword v13, v12, s[4:7], s36 offen sc1
    s_waitcnt vmcnt(0)
    v_readfirstlane_b32 s37, v13
    s_nop 0
    s_lshr_b32 s37, s37, s33
    s_bitcmp1_b32 s37, 0
    s_cbranch_scc0 TEAM_KVP
TEAM_W2PRE:
    ds_read_b128 v[24:27], v0
    ds_read_b128 v[28:31], v0
    ds_read_b128 v[48:51], v1 offset:0
    ds_read_b128 v[52:55], v1 offset:1024
    ds_read_b128 v[56:59], v1 offset:2048
    ds_read_b128 v[60:63], v1 offset:3072
    s_add_u32 s57, s57, s35
    v_mov_b32 v40, -1
    v_mov_b32 v41, -1
    v_mov_b32 v42, -1
    v_mov_b32 v43, -1
    v_mov_b32 v44, s34
    v_mov_b32 v45, s61
    v_lshlrev_b32 v47, 2, v38
    v_mov_b32 v46, 0x7ff00000
    v_cmp_gt_u32 vcc, 0x80, v38
    s_nop 1
    v_cndmask_b32 v46, v46, v38, vcc
    s_sleep 5
    buffer_load_dwordx4 v[12:15], v38, s[4:7], s59 offen sc1
    buffer_load_dwordx4 v[16:19], v38, s[4:7], s59 offen offset:1024 sc1
    buffer_load_dwordx4 v[20:23], v33, s[4:7], s63 offen sc1
TEAM_W2:
    s_waitcnt vmcnt(2)
    ds_write_b128 v39, v[12:15]
    v_max3_u32 v36, v12, v13, v14
    v_max_u32 v36, v36, v15
    v_cmp_eq_u32 s[84:85], -1, v36
    s_waitcnt vmcnt(1)
    ds_write_b128 v39, v[16:19] offset:1024
    v_max3_u32 v36, v16, v17, v18
    v_max_u32 v36, v36, v19
    v_cmp_eq_u32 s[86:87], -1, v36
    s_waitcnt vmcnt(0)
    ds_write_b128 v34, v[20:23]
    v_max3_u32 v36, v20, v21, v22
    v_max_u32 v36, v36, v23
    v_cmp_eq_u32 s[88:89], -1, v36
    s_or_b64 s[92:93], s[84:85], s[86:87]
    s_or_b64 s[92:93], s[92:93], s[88:89]
    s_cbranch_scc0 TEAM_W2_OK
    s_and_b64 s[94:95], s[84:85], s[86:87]
    s_cmp_eq_u64 s[94:95], -1
    s_cbranch_scc0 TEAM_W2_RE
    s_sleep 1
TEAM_W2_RE:
    s_mov_b64 exec, s[84:85]
    buffer_load_dwordx4 v[12:15], v38, s[4:7], s59 offen sc1
    s_mov_b64 exec, s[86:87]
    buffer_load_dwordx4 v[16:19], v38, s[4:7], s59 offen offset:1024 sc1
    s_mov_b64 exec, s[88:89]
    buffer_load_dwordx4 v[20:23], v33, s[4:7], s63 offen sc1
    s_mov_b64 exec, -1
    s_waitcnt vmcnt(0)
    s_branch TEAM_W2
TEAM_W2_OK:
    s_cmp_ge_u32 s60, 72
    s_waitcnt lgkmcnt(0)
    s_barrier
    s_cbranch_scc1 TEAM_NORESET
    buffer_store_dwordx4 v[40:43], v35, s[4:7], s49 offen
    buffer_store_dwordx4 v[40:43], v35, s[4:7], s49 offen offset:128
    buffer_store_dwordx4 v[40:43], v35, s[4:7], s49 offen offset:256
    buffer_store_dwordx4 v[40:43], v35, s[4:7], s49 offen offset:384
    s_mov_b64 exec, 0xff
    buffer_store_dwordx4 v[40:43], v35, s[4:7], s48 offen
    s_mov_b64 exec, -1
TEAM_NORESET:
    buffer_store_dword v44, v45, s[4:7], 0 offen sc1
    buffer_load_dword v9, v47, s[4:7], s47 offen
    ds_read_b128 v[32:35], v0
    ds_read_b128 v[36:39], v0
    ds_read_b128 v[40:43], v0
    ds_read_b128 v[44:47], v0
    s_branch TEAM_STEP
TEAM_LAST:
    s_waitcnt vmcnt(0) lgkmcnt(0)
    v_mov_b32 v28, 64
    v_mov_b32 v29, s61
    buffer_store_dword v28, v29, s[4:7], 0 offen sc1
    s_endpgm
.section .rodata,"a"
.p2align 6
.amdhsa_kernel gated_mix__ssm_conv_s4__memory_aug_recurrent_mem_tr__prompt_kernel
  .amdhsa_next_free_vgpr 512
  .amdhsa_next_free_sgpr 102
  .amdhsa_accum_offset 256
  .amdhsa_group_segment_fixed_size 0
  .amdhsa_kernarg_size 160
  .amdhsa_user_sgpr_count 2
  .amdhsa_user_sgpr_kernarg_segment_ptr 1
  .amdhsa_system_sgpr_workgroup_id_x 1
.end_amdhsa_kernel
```
